```python
import torch

def _softmax(x, axis=-1):
    return torch.softmax(x, dim=axis)
def _gelu(x):
    return torch.nn.functional.gelu(x, approximate="tanh")
def _silu(x):
    return torch.nn.functional.silu(x)
def _sigmoid(x):
    return torch.sigmoid(x)
def _layernorm(x, axis=-1, eps=1e-5):
    m = x.mean(dim=axis, keepdim=True)
    v = x.var(dim=axis, keepdim=True, unbiased=False)
    return (x - m) / torch.sqrt(v + eps)
def _scatter_add(tgt, idx, src, axis=0):
    return tgt.clone().index_add_(axis, idx, src)
def _segment_sum(src, seg, n):
    out = torch.zeros((n,) + src.shape[1:], dtype=src.dtype)
    return out.index_add_(0, seg, src)
def _pad(x, pw):
    flat = tuple(v for pair in reversed(pw) for v in pair)
    return torch.nn.functional.pad(x, flat)

kernel_name = 'sequential_preLN__linear_attn_block__geglu_ffn__prompt'

def setup_inputs():

    _w = (lambda a: (lambda t: t.to(torch.bfloat16) if t.is_floating_point() else t)(torch.as_tensor(a)))
    def _A_setup():
        B, S, D = 1, 2048, 640
        return {
            "x": _w((lambda *s: torch.randn(*s, dtype=torch.bfloat16) * 0.05)(B, S, D)),
            "wqkv": _w((lambda *s: torch.randn(*s, dtype=torch.bfloat16) * 0.05)(D, 3 * D)),
            "wo": _w((lambda *s: torch.randn(*s, dtype=torch.bfloat16) * 0.05)(D, D)),
        }
    _A_in = _A_setup()

    def _B_setup():
        B, S, D, F = 1, 2048, 640, 1728
        return {
            "x": _w((lambda *s: torch.randn(*s, dtype=torch.bfloat16) * 0.05)(B, S, D)),
            "w_gate": _w((lambda *s: torch.randn(*s, dtype=torch.bfloat16) * 0.05)(D, F)),
            "w_up": _w((lambda *s: torch.randn(*s, dtype=torch.bfloat16) * 0.05)(D, F)),
            "w_down": _w((lambda *s: torch.randn(*s, dtype=torch.bfloat16) * 0.05)(F, D)),
        }
    _B_in = _B_setup()

    return {
        "A_x": _A_in["x"],
        "A_wqkv": _A_in["wqkv"],
        "A_wo": _A_in["wo"],
        "B_x": _B_in["x"],
        "B_w_gate": _B_in["w_gate"],
        "B_w_up": _B_in["w_up"],
        "B_w_down": _B_in["w_down"],
    }

def reference(A_x, A_wqkv, A_wo, B_x, B_w_gate, B_w_up, B_w_down):
    def _A_ref(x, wqkv, wo):
        B, S, D = x.shape
        H = 32; Dh = D // H
        qkv = (lambda x, *d: x.permute(*d))((x @ wqkv).reshape(B, S, 3, H, Dh), 2, 0, 3, 1, 4)
        q, k, v = qkv[0], qkv[1], qkv[2]
        phi = lambda t: torch.where(t > 0, t + 1, torch.exp(t)) + 1e-6
        pq, pk = phi(q), phi(k)
        kv = torch.einsum("bhsd,bhse->bhde", pk, v)
        z = torch.einsum("bhsd->bhd", pk)
        num = torch.einsum("bhqd,bhde->bhqe", pq, kv)
        den = torch.einsum("bhqd,bhd->bhq", pq, z)[..., None] + 1e-6
        o = num / den
        return (lambda x, *d: x.permute(*d))(o, 0, 2, 1, 3).reshape(B, S, D) @ wo

    def _B_ref(x, w_gate, w_up, w_down):
        return (_gelu(x @ w_gate) * (x @ w_up)) @ w_down

    x = A_x
    h = x + _A_ref(_layernorm(x, axis=-1), A_wqkv, A_wo)
    h2 = h + _B_ref(_layernorm(h, axis=-1), B_w_gate, B_w_up, B_w_down)
    return h2
```

```asm
; @launch grid=(256,1,1) block=(256,1,1) lds=163840
.amdgcn_target "amdgcn-amd-amdhsa--gfx950"
.text
.globl sequential_preLN__linear_attn_block__geglu_ffn__prompt_kernel
.p2align 8
.type sequential_preLN__linear_attn_block__geglu_ffn__prompt_kernel,@function
sequential_preLN__linear_attn_block__geglu_ffn__prompt_kernel:
s_cmp_ge_u32 s2, 256
s_cbranch_scc1 L_end
s_load_dwordx16 s[64:79], s[0:1], 0
s_load_dwordx4 s[80:83], s[0:1], 64
v_and_b32 v1, 63, v0
v_and_b32 v2, 15, v0
v_bfe_u32 v3, v0, 4, 2
v_lshlrev_b32 v4, 4, v1
v_lshrrev_b32 v60, 6, v0
s_nop 0
v_readfirstlane_b32 s40, v60
s_getpc_b64 s[50:51]
L_pc:
s_lshr_b32 s52, s2, 3
s_lshl_b32 s52, s52, 4
v_add_u32 v60, s52, v0
v_lshlrev_b32 v60, 7, v60
v_mov_b32 v62, L_code_end-L_pc
v_cmp_lt_u32 vcc, v60, v62
v_cmp_gt_u32 s[52:53], 16, v0
s_nop 0
s_and_b64 vcc, vcc, s[52:53]
v_mov_b32 v61, s51
v_add_co_u32 v62, s[52:53], s50, v60
s_nop 1
v_addc_co_u32 v63, s[52:53], 0, v61, s[52:53]
s_mov_b64 exec, vcc
s_nop 3
s_cbranch_execz L_nocpf
global_load_dword v255, v[62:63], off
L_nocpf:
s_mov_b64 exec, -1
s_and_b32 s41, s2, 7
s_lshr_b32 s42, s2, 3
s_nop 0
s_lshr_b32 s43, s42, 4
s_and_b32 s44, s42, 15
v_and_b32 v60, 7, v1
v_xor_b32 v60, v60, v3
v_lshlrev_b32 v60, 4, v60
v_lshrrev_b32 v61, 3, v1
v_mul_u32_u24 v5, 1280, v61
v_add_u32 v5, v5, v60
v_xor_b32 v6, 64, v5
s_lshl_b32 s50, s41, 8
s_lshl_b32 s51, s43, 7
s_add_u32 s50, s50, s51
s_lshl_b32 s51, s40, 5
s_add_u32 s50, s50, s51
s_mul_i32 s53, s50, 1280
v_add_u32 v5, s53, v5
v_add_u32 v6, s53, v6
v_add_u32 v6, 10240, v6
v_add_u32 v249, 20480, v5
v_add_u32 v250, 20480, v6
s_mul_i32 s57, s40, 12288
s_add_u32 s57, s57, 102400
s_lshl_b32 s54, s2, 2
s_add_u32 s54, s54, s40
s_add_u32 s50, s54, 0
s_mul_i32 s51, s50, 1311
s_lshr_b32 s51, s51, 17
s_mul_i32 s52, s51, 100
s_sub_u32 s50, s50, s52
s_mul_i32 s52, s50, 205
s_lshr_b32 s52, s52, 10
s_mul_i32 s53, s52, 5
s_sub_u32 s50, s50, s53
s_lshl_b32 s90, s51, 8
s_lshl_b32 s50, s50, 6
v_add_u32 v60, s50, v1
v_mul_u32_u24 v61, 6554, v60
v_lshrrev_b32 v61, 16, v61
v_mul_u32_u24 v62, 10, v61
v_sub_u32 v62, v60, v62
v_and_b32 v63, 0x13, v61
v_and_b32 v59, 4, v61
v_lshl_or_b32 v63, v59, 1, v63
v_bfe_u32 v59, v61, 3, 1
v_lshl_or_b32 v63, v59, 2, v63
s_mul_i32 s52, s52, 122880
s_mul_i32 s51, s51, 80
s_add_u32 s52, s52, s51
s_add_u32 s52, s52, 1280
v_mul_u32_u24 v63, 3840, v63
v_add_u32 v63, s52, v63
v_cmp_lt_u32 vcc, 4, v62
v_mov_b32 v59, 1200
s_nop 0
v_cndmask_b32 v59, 0, v59, vcc
v_add_u32 v63, v63, v59
v_min_u32 v62, 9, v62
v_lshl_add_u32 v76, v62, 4, v63
v_lshlrev_b32 v254, 7, v1
s_waitcnt lgkmcnt(0)
s_mov_b32 s8, s66
s_mov_b32 s9, s67
s_mov_b32 s10, 2457600
s_mov_b32 s11, 0x20000
s_mov_b32 s4, s64
s_mov_b32 s5, s65
s_mov_b32 s6, 2621440
s_mov_b32 s7, 0x20000
s_mov_b32 s32, s82
s_mov_b32 s33, s83
s_mov_b32 s34, 17825792
s_mov_b32 s35, 0x20000
s_mov_b32 s36, s80
s_mov_b32 s37, s81
s_mov_b32 s38, 256
s_mov_b32 s39, 0x20000
s_getreg_b32 s3, hwreg(HW_REG_XCC_ID, 0, 4)
s_add_u32 s3, s3, 1
s_cmp_lg_u32 s54, 3
s_cbranch_scc1 L_noz
v_lshlrev_b32 v60, 8, v1
v_mov_b32 v56, 0
v_mov_b32 v57, 0
v_mov_b32 v58, 0
v_mov_b32 v59, 0
buffer_store_dword v56, v60, s[32:35], 0 offen sc1
s_mov_b32 s50, 20480
s_mov_b32 exec_hi, 0
buffer_store_dword v56, v60, s[32:35], s50 offen sc1
s_mov_b64 exec, -1
s_mov_b32 s50, 16384
buffer_store_dwordx4 v[56:59], v4, s[32:35], s50 offen offset:0 sc1
buffer_store_dwordx4 v[56:59], v4, s[32:35], s50 offen offset:1024 sc1
buffer_store_dwordx4 v[56:59], v4, s[32:35], s50 offen offset:2048 sc1
s_nop 1
L_noz:
buffer_load_dwordx4 v[64:67], v76, s[8:11], 0 offen
s_add_u32 s50, s54, 1024
s_mov_b32 s51, 0
s_mov_b32 s94, 1311
s_mov_b32 s95, 100
s_mov_b32 s96, 205
s_mov_b32 s97, 5
s_mov_b32 s84, 6554
s_mov_b32 s85, 10
s_mov_b32 s86, 1280
s_mov_b32 s87, 9
s_mov_b32 s88, 1200
s_mov_b32 s89, 0
s_cmp_lt_u32 s50, 1600
s_cbranch_scc1 L_rpkv
s_mov_b32 s51, 1600
s_mov_b32 s94, 2185
s_mov_b32 s95, 60
s_mov_b32 s96, 342
s_mov_b32 s97, 3
s_mov_b32 s84, 10923
s_mov_b32 s85, 6
s_mov_b32 s86, 0
s_mov_b32 s87, 4
s_mov_b32 s88, 0
s_mov_b32 s89, 4096
L_rpkv:
s_sub_u32 s50, s50, s51
s_mul_i32 s51, s50, s94
s_lshr_b32 s51, s51, 17
s_mul_i32 s52, s51, s95
s_sub_u32 s50, s50, s52
s_mul_i32 s52, s50, s96
s_lshr_b32 s52, s52, 10
s_mul_i32 s53, s52, s97
s_sub_u32 s50, s50, s53
s_lshl_b32 s91, s51, 8
s_add_u32 s91, s91, s89
s_lshl_b32 s50, s50, 6
v_add_u32 v60, s50, v1
v_mul_u32_u24 v61, s84, v60
v_lshrrev_b32 v61, 16, v61
v_mul_u32_u24 v62, s85, v61
v_sub_u32 v62, v60, v62
v_and_b32 v63, 0x13, v61
v_and_b32 v59, 4, v61
v_lshl_or_b32 v63, v59, 1, v63
v_bfe_u32 v59, v61, 3, 1
v_lshl_or_b32 v63, v59, 2, v63
s_mul_i32 s52, s52, 122880
s_mul_i32 s51, s51, 80
s_add_u32 s52, s52, s51
s_add_u32 s52, s52, s86
v_mul_u32_u24 v63, 3840, v63
v_add_u32 v63, s52, v63
v_cmp_lt_u32 vcc, 4, v62
v_mov_b32 v59, s88
s_nop 0
v_cndmask_b32 v59, 0, v59, vcc
v_add_u32 v63, v63, v59
v_min_u32 v62, s87, v62
v_lshl_add_u32 v77, v62, 4, v63
buffer_load_dwordx4 v[68:71], v77, s[8:11], 0 offen
s_add_u32 s50, s54, 2048
s_sub_u32 s50, s50, 1600
s_mul_i32 s51, s50, 2185
s_lshr_b32 s51, s51, 17
s_mul_i32 s52, s51, 60
s_sub_u32 s50, s50, s52
s_mul_i32 s52, s50, 342
s_lshr_b32 s52, s52, 10
s_mul_i32 s53, s52, 3
s_sub_u32 s50, s50, s53
s_lshl_b32 s92, s51, 8
s_add_u32 s92, s92, 4096
s_lshl_b32 s50, s50, 6
v_add_u32 v60, s50, v1
v_mul_u32_u24 v61, 10923, v60
v_lshrrev_b32 v61, 16, v61
v_mul_u32_u24 v62, 6, v61
v_sub_u32 v62, v60, v62
v_and_b32 v63, 0x13, v61
v_and_b32 v59, 4, v61
v_lshl_or_b32 v63, v59, 1, v63
v_bfe_u32 v59, v61, 3, 1
v_lshl_or_b32 v63, v59, 2, v63
s_mul_i32 s52, s52, 122880
s_mul_i32 s51, s51, 80
s_add_u32 s52, s52, s51
v_mul_u32_u24 v63, 3840, v63
v_add_u32 v63, s52, v63
v_min_u32 v62, 4, v62
v_lshl_add_u32 v78, v62, 4, v63
s_cmp_lt_u32 s54, 512
s_cselect_b64 s[94:95], -1, 0
s_mov_b64 exec, s[94:95]
buffer_load_dwordx4 v[72:75], v78, s[8:11], 0 offen
s_mov_b64 exec, -1
s_lshl_b32 s50, s41, 1
s_add_u32 s50, s50, s43
s_lshl_b32 s50, s50, 4
s_add_u32 s50, s50, s44
s_mul_i32 s50, s50, 80
s_mul_i32 s51, s40, 20
s_add_u32 s50, s50, s51
s_lshl_b32 s50, s50, 7
s_mov_b64 exec, 0xfffff
buffer_load_dword v255, v254, s[4:7], s50 offen
s_mov_b64 exec, -1
s_add_u32 m0, s57, 0x0
s_nop 0
buffer_load_dwordx4 v5, s[4:7], 0 offen offset:0 lds
s_add_u32 m0, s57, 0x400
s_nop 0
buffer_load_dwordx4 v6, s[4:7], 0 offen offset:0 lds
s_add_u32 m0, s57, 0x800
s_nop 0
buffer_load_dwordx4 v249, s[4:7], 0 offen offset:0 lds
s_add_u32 m0, s57, 0xc00
s_nop 0
buffer_load_dwordx4 v250, s[4:7], 0 offen offset:0 lds
s_mul_i32 s101, s41, 1581056
s_add_u32 s101, s101, 2097152
s_cmp_lg_u32 s54, 3
s_cbranch_scc1 L_noinit
s_waitcnt vmcnt(8)
s_lshl_b32 s50, s41, 5
s_add_u32 s50, s50, s42
v_mov_b32 v60, 0
v_mov_b32 v61, s3
s_mov_b64 exec, 1
buffer_store_byte v61, v60, s[36:39], s50 offen sc1
s_mov_b64 exec, -1
L_noinit:
s_mov_b32 s12, s68
s_mov_b32 s13, s69
s_mov_b32 s14, 819200
s_mov_b32 s15, 0x20000
s_mov_b32 s16, s72
s_mov_b32 s17, s73
s_mov_b32 s18, 2211840
s_mov_b32 s19, 0x20000
s_mov_b32 s20, s74
s_mov_b32 s21, s75
s_mov_b32 s22, 2211840
s_mov_b32 s23, 0x20000
s_mov_b32 s24, s76
s_mov_b32 s25, s77
s_mov_b32 s26, 2211840
s_mov_b32 s27, 0x20000
s_mov_b32 s28, s78
s_mov_b32 s29, s79
s_mov_b32 s30, 2621440
s_mov_b32 s31, 0x20000
s_lshl_b32 s55, s54, 10
s_add_u32 s55, s55, 14811136
s_add_u32 s56, s55, 1048576
s_add_u32 s58, s55, 2097152
v_lshrrev_b32 v60, 1, v2
v_xor_b32 v60, v60, v3
v_lshlrev_b32 v60, 4, v60
v_lshl_add_u32 v7, v2, 7, v60
v_add_u32 v7, s57, v7
v_xor_b32 v8, 64, v7
v_mov_b32 v140, 0x3f803f80
v_mov_b32 v141, 0x3f803f80
v_mov_b32 v142, 0x3f803f80
v_mov_b32 v143, 0x3f803f80
v_mov_b32 v47, 0
v_lshrrev_b32 v58, 2, v2
v_and_b32 v60, 1, v3
v_lshl_add_u32 v58, v60, 2, v58
v_lshrrev_b32 v60, 1, v3
v_lshl_add_u32 v58, v60, 4, v58
v_and_b32 v59, 3, v2
v_mul_u32_u24 v60, 160, v58
v_lshl_add_u32 v14, v59, 3, v60
v_and_b32 v61, 1, v59
v_mul_u32_u24 v61, 40, v61
v_lshrrev_b32 v62, 1, v59
v_mul_u32_u24 v62, 80, v62
v_add_u32 v15, 112, v60
v_add_u32 v15, v15, v61
v_sub_u32 v15, v15, v62
v_mul_u32_u24 v60, 96, v58
v_add_u32 v60, 102400, v60
v_lshl_add_u32 v16, v59, 3, v60
v_cmp_eq_u32 vcc, 3, v59
v_mov_b32 v61, 32
v_mov_b32 v62, 72
v_cndmask_b32 v61, v61, v62, vcc
v_add_u32 v17, v60, v61
s_mul_i32 s46, s42, 26
s_lshr_b32 s46, s46, 8
s_mul_i32 s52, s46, 10
s_sub_u32 s45, s42, s52
s_lshr_b32 s47, s40, 1
s_and_b32 s48, s40, 1
s_lshl_b32 s61, s40, 10
s_lshl_b32 s62, s45, 7
s_lshl_b32 s63, s42, 7
v_and_b32 v57, 7, v1
v_lshlrev_b32 v60, 1, v3
v_xor_b32 v57, v57, v60
v_lshlrev_b32 v57, 4, v57
s_lshl_b32 s52, s40, 3
v_lshrrev_b32 v56, 3, v1
v_add_u32 v56, s52, v56
v_mul_u32_u24 v22, 3456, v56
v_add3_u32 v22, v22, v57, s63
v_add_u32 v57, s62, v57
v_mul_u32_u24 v21, 1280, v56
v_add_u32 v21, v21, v57
s_lshr_b32 s52, s40, 1
s_mul_i32 s52, s52, 5120
v_add_u32 v23, s52, v21
v_bfe_u32 v60, v56, 2, 2
v_mul_u32_u24 v60, 40, v60
v_and_b32 v61, 3, v56
v_add_u32 v60, v60, v61
v_lshrrev_b32 v61, 4, v56
v_mul_u32_u24 v61, 20, v61
v_add3_u32 v60, v60, v61, 16
v_mul_u32_u24 v24, 1280, v60
v_add_u32 v24, v24, v57
s_waitcnt vmcnt(5)
buffer_store_dwordx4 v[64:67], v4, s[32:35], s55 offen sc1
buffer_store_dwordx4 v[68:71], v4, s[32:35], s56 offen sc1
s_mov_b64 exec, s[94:95]
buffer_store_dwordx4 v[72:75], v4, s[32:35], s58 offen sc1
s_mov_b64 exec, -1
buffer_load_ubyte v33, v47, s[36:39], 0 offen sc1
s_add_u32 m0, s57, 0xf80
s_nop 0
buffer_load_dwordx4 v5, s[4:7], 0 offen offset:128 lds
s_add_u32 m0, s57, 0x1380
s_nop 0
buffer_load_dwordx4 v6, s[4:7], 0 offen offset:128 lds
s_add_u32 m0, s57, 0x1780
s_nop 0
buffer_load_dwordx4 v249, s[4:7], 0 offen offset:128 lds
s_add_u32 m0, s57, 0x1b80
s_nop 0
buffer_load_dwordx4 v250, s[4:7], 0 offen offset:128 lds
s_add_u32 m0, s57, 0x1f00
s_nop 0
buffer_load_dwordx4 v5, s[4:7], 0 offen offset:256 lds
s_add_u32 m0, s57, 0x2300
s_nop 0
buffer_load_dwordx4 v6, s[4:7], 0 offen offset:256 lds
s_add_u32 m0, s57, 0x2700
s_nop 0
buffer_load_dwordx4 v249, s[4:7], 0 offen offset:256 lds
s_add_u32 m0, s57, 0x2b00
s_nop 0
buffer_load_dwordx4 v250, s[4:7], 0 offen offset:256 lds
s_waitcnt vmcnt(12)
ds_read_b128 a[0:3], v7 offset:0
ds_read_b128 a[4:7], v7 offset:2048
ds_read_b128 a[8:11], v8 offset:0
ds_read_b128 a[12:15], v8 offset:2048
v_lshrrev_b32 v60, 2, v2
v_lshl_add_u32 v61, v3, 2, v60
v_lshlrev_b32 v25, 7, v61
v_bfe_u32 v61, v61, 1, 2
v_lshl_or_b32 v25, v61, 5, v25
v_lshl_or_b32 v25, v59, 3, v25
v_mul_u32_u24 v46, 1280, v2
v_and_b32 v60, 1, v3
v_lshl_add_u32 v46, v60, 5, v46
v_lshrrev_b32 v60, 1, v3
v_lshl_add_u32 v46, v60, 4, v46
v_lshlrev_b32 v32, 4, v0
s_lshl_b32 s49, s41, 4
s_mul_i32 s52, s46, 5
s_add_u32 s49, s49, s52
s_mul_i32 s52, s47, 3
s_add_u32 s49, s49, s52
s_mul_i32 s60, s49, 20480
s_add_u32 s60, s60, s62
s_lshl_b32 s52, s48, 6
s_add_u32 s60, s60, s52
v_lshlrev_b32 v60, 2, v3
v_sub_u32 v251, v2, v60
s_mov_b32 s96, 0x3fb8aa3b
s_mov_b32 s97, 0x3fb8aa3b
s_mov_b32 s98, 0x358637bd
s_mov_b32 s99, 0x358637bd
s_mul_i32 s59, s40, 5120
s_mul_i32 s58, s44, 102400
s_add_u32 s58, s58, s59
s_add_u32 s58, s58, 14811136
s_mul_i32 s100, s40, 3072
s_mul_i32 s83, s44, 61440
s_add_u32 s83, s83, s100
s_add_u32 s83, s83, 16449536
s_add_u32 s100, s100, 102400
s_lshl_b32 s82, s44, 8
s_add_u32 s82, s82, 20480
v_lshrrev_b32 v60, 5, v1
v_lshlrev_b32 v253, 12, v60
v_mul_u32_u24 v252, 10, v60
v_sub_u32 v252, 25, v252
s_waitcnt lgkmcnt(0)
s_add_u32 m0, s57, 0xfffffe80
s_nop 0
buffer_load_dwordx4 v5, s[4:7], 0 offen offset:384 lds
v_mfma_f32_16x16x32_bf16 v[124:127], a[0:3], v[140:143], 0
s_add_u32 m0, s57, 0x280
s_nop 0
buffer_load_dwordx4 v6, s[4:7], 0 offen offset:384 lds
v_mfma_f32_16x16x32_bf16 v[132:135], a[0:3], a[0:3], 0
s_add_u32 m0, s57, 0x680
s_nop 0
buffer_load_dwordx4 v249, s[4:7], 0 offen offset:384 lds
v_mfma_f32_16x16x32_bf16 v[164:167], v[140:143], a[0:3], 0
s_add_u32 m0, s57, 0xa80
s_nop 0
buffer_load_dwordx4 v250, s[4:7], 0 offen offset:384 lds
v_mfma_f32_16x16x32_bf16 v[128:131], a[4:7], v[140:143], 0
v_mfma_f32_16x16x32_bf16 v[136:139], a[4:7], a[4:7], 0
v_mfma_f32_16x16x32_bf16 v[168:171], v[140:143], a[4:7], 0
v_mfma_f32_16x16x32_bf16 v[124:127], a[8:11], v[140:143], v[124:127]
v_mfma_f32_16x16x32_bf16 v[132:135], a[8:11], a[8:11], v[132:135]
v_mfma_f32_16x16x32_bf16 v[164:167], v[140:143], a[8:11], v[164:167]
v_mfma_f32_16x16x32_bf16 v[128:131], a[12:15], v[140:143], v[128:131]
v_mfma_f32_16x16x32_bf16 v[136:139], a[12:15], a[12:15], v[136:139]
v_mfma_f32_16x16x32_bf16 v[168:171], v[140:143], a[12:15], v[168:171]
s_waitcnt vmcnt(12)
s_barrier
s_cmp_lg_u32 s40, 0
s_nop 4
s_cbranch_scc1 L_nw1
s_mov_b32 s51, 400000
L_f12:
v_readfirstlane_b32 s52, v33
s_nop 0
s_cmp_lg_u32 s52, 0
s_nop 2
s_cbranch_scc1 L_f13
buffer_load_ubyte v33, v47, s[36:39], 0 offen sc1
s_waitcnt vmcnt(0)
s_sub_u32 s51, s51, 1
s_cmp_lg_u32 s51, 0
s_cbranch_scc1 L_f12
L_f13:
v_mov_b32 v60, s90
v_writelane_b32 v60, s91, 1
v_writelane_b32 v60, s92, 2
v_mov_b32 v61, 1
s_mov_b32 s50, 20480
s_and_b32 s51, s94, 4
s_or_b32 exec_lo, s51, 3
s_mov_b32 exec_hi, 0
buffer_atomic_add v61, v60, s[32:35], s50 offen sc1
s_mov_b64 exec, -1
v_lshlrev_b32 v60, 3, v254
s_lshl_b32 s50, s41, 7
s_add_u32 s50, s50, 16384
s_mov_b64 exec, 7
buffer_load_dword v255, v60, s[32:35], s50 offen
s_mov_b64 exec, -1
L_nw1:
s_waitcnt vmcnt(8)
ds_read_b128 a[16:19], v7 offset:4096
ds_read_b128 a[20:23], v7 offset:6144
ds_read_b128 a[24:27], v8 offset:4096
ds_read_b128 a[28:31], v8 offset:6144
s_cmp_eq_u32 s40, 2
s_cbranch_scc1 L_im2
s_cmp_eq_u32 s40, 3
s_cbranch_scc1 L_im3
v_add_u32 v26, s61, v4
s_mul_i32 s50, s40, 2056
s_add_u32 s50, s50, 81920
v_add_u32 v27, s50, v4
s_nop 1
s_branch L_imd
L_im2:
v_lshl_add_u32 v60, v3, 4, v2
v_add_u32 v60, 32, v60
v_lshrrev_b32 v61, 2, v2
v_lshl_add_u32 v61, v61, 4, v59
v_and_b32 v62, 1, v3
v_lshl_add_u32 v61, v62, 2, v61
v_cmp_gt_u32 vcc, 2, v3
s_nop 1
v_cndmask_b32 v60, v61, v60, vcc
v_lshlrev_b32 v60, 4, v60
v_add_u32 v61, 2, v3
v_lshl_add_u32 v26, v61, 10, v60
v_lshlrev_b32 v61, 11, v3
v_add_u32 v61, 1024, v61
v_lshlrev_b32 v62, 3, v62
v_add_u32 v62, 4096, v62
v_cndmask_b32 v61, v62, v61, vcc
v_add_u32 v61, 81920, v61
v_add_u32 v27, v61, v60
s_nop 1
s_branch L_imd
L_im3:
v_bfe_u32 v61, v2, 2, 1
v_lshl_add_u32 v60, v61, 4, v2
v_add_u32 v60, 32, v60
v_mul_u32_u24 v62, 17, v61
v_lshl_add_u32 v62, v59, 2, v62
v_add_u32 v62, 32, v62
v_cmp_gt_u32 vcc, 8, v2
s_nop 1
v_cndmask_b32 v60, v62, v60, vcc
v_mov_b32 v61, 9216
v_mov_b32 v62, 6144
v_cndmask_b32 v61, v61, v62, vcc
v_mov_b32 v62, 7168
v_mov_b32 v63, 5120
v_cndmask_b32 v62, v62, v63, vcc
v_lshrrev_b32 v63, 2, v2
v_lshlrev_b32 v63, 4, v63
v_lshl_add_u32 v63, v59, 2, v63
v_lshrrev_b32 v57, 1, v3
v_add_u32 v63, v63, v57
v_add_u32 v56, 6, v3
v_lshlrev_b32 v56, 10, v56
v_lshlrev_b32 v57, 3, v57
v_add_u32 v57, 6144, v57
v_cmp_eq_u32 vcc, 0, v3
s_nop 1
v_cndmask_b32 v60, v63, v60, vcc
v_cndmask_b32 v61, v56, v61, vcc
v_cndmask_b32 v62, v57, v62, vcc
v_lshlrev_b32 v60, 4, v60
v_add_u32 v26, v61, v60
v_add_u32 v27, v62, v60
v_add_u32 v27, 81920, v27
v_cmp_eq_u32 vcc, 3, v3
v_mov_b32 v60, 90112
v_lshl_add_u32 v60, v2, 3, v60
v_cndmask_b32 v27, v27, v60, vcc
v_cndmask_b32 v26, v26, v4, vcc
s_nop 1
L_imd:
s_waitcnt lgkmcnt(0)
s_add_u32 m0, s57, 0xe00
s_nop 0
buffer_load_dwordx4 v5, s[4:7], 0 offen offset:512 lds
v_mfma_f32_16x16x32_bf16 v[124:127], a[16:19], v[140:143], v[124:127]
s_add_u32 m0, s57, 0x1200
s_nop 0
buffer_load_dwordx4 v6, s[4:7], 0 offen offset:512 lds
v_mfma_f32_16x16x32_bf16 v[132:135], a[16:19], a[16:19], v[132:135]
s_add_u32 m0, s57, 0x1600
s_nop 0
buffer_load_dwordx4 v249, s[4:7], 0 offen offset:512 lds
v_mfma_f32_16x16x32_bf16 v[164:167], v[140:143], a[16:19], v[164:167]
s_add_u32 m0, s57, 0x1a00
s_nop 0
buffer_load_dwordx4 v250, s[4:7], 0 offen offset:512 lds
v_mfma_f32_16x16x32_bf16 v[128:131], a[20:23], v[140:143], v[128:131]
v_mfma_f32_16x16x32_bf16 v[136:139], a[20:23], a[20:23], v[136:139]
v_mfma_f32_16x16x32_bf16 v[168:171], v[140:143], a[20:23], v[168:171]
v_mfma_f32_16x16x32_bf16 v[124:127], a[24:27], v[140:143], v[124:127]
v_mfma_f32_16x16x32_bf16 v[132:135], a[24:27], a[24:27], v[132:135]
v_mfma_f32_16x16x32_bf16 v[164:167], v[140:143], a[24:27], v[164:167]
v_mfma_f32_16x16x32_bf16 v[128:131], a[28:31], v[140:143], v[128:131]
v_mfma_f32_16x16x32_bf16 v[136:139], a[28:31], a[28:31], v[136:139]
v_mfma_f32_16x16x32_bf16 v[168:171], v[140:143], a[28:31], v[168:171]
s_waitcnt vmcnt(8)
ds_read_b128 a[32:35], v7 offset:8192
ds_read_b128 a[36:39], v7 offset:10240
ds_read_b128 a[40:43], v8 offset:8192
ds_read_b128 a[44:47], v8 offset:10240
s_waitcnt lgkmcnt(0)
s_add_u32 m0, s57, 0x1d80
s_nop 0
buffer_load_dwordx4 v5, s[4:7], 0 offen offset:640 lds
v_mfma_f32_16x16x32_bf16 v[124:127], a[32:35], v[140:143], v[124:127]
s_add_u32 m0, s57, 0x2180
s_nop 0
buffer_load_dwordx4 v6, s[4:7], 0 offen offset:640 lds
v_mfma_f32_16x16x32_bf16 v[132:135], a[32:35], a[32:35], v[132:135]
s_add_u32 m0, s57, 0x2580
s_nop 0
buffer_load_dwordx4 v249, s[4:7], 0 offen offset:640 lds
v_mfma_f32_16x16x32_bf16 v[164:167], v[140:143], a[32:35], v[164:167]
s_add_u32 m0, s57, 0x2980
s_nop 0
buffer_load_dwordx4 v250, s[4:7], 0 offen offset:640 lds
v_mfma_f32_16x16x32_bf16 v[128:131], a[36:39], v[140:143], v[128:131]
v_mfma_f32_16x16x32_bf16 v[136:139], a[36:39], a[36:39], v[136:139]
v_mfma_f32_16x16x32_bf16 v[168:171], v[140:143], a[36:39], v[168:171]
v_mfma_f32_16x16x32_bf16 v[124:127], a[40:43], v[140:143], v[124:127]
v_mfma_f32_16x16x32_bf16 v[132:135], a[40:43], a[40:43], v[132:135]
v_mfma_f32_16x16x32_bf16 v[164:167], v[140:143], a[40:43], v[164:167]
v_mfma_f32_16x16x32_bf16 v[128:131], a[44:47], v[140:143], v[128:131]
v_mfma_f32_16x16x32_bf16 v[136:139], a[44:47], a[44:47], v[136:139]
v_mfma_f32_16x16x32_bf16 v[168:171], v[140:143], a[44:47], v[168:171]
s_waitcnt vmcnt(8)
ds_read_b128 a[48:51], v7 offset:0
ds_read_b128 a[52:55], v7 offset:2048
ds_read_b128 a[56:59], v8 offset:0
ds_read_b128 a[60:63], v8 offset:2048
s_waitcnt lgkmcnt(0)
s_add_u32 m0, s57, 0xfffffd00
s_nop 0
buffer_load_dwordx4 v5, s[4:7], 0 offen offset:768 lds
v_mfma_f32_16x16x32_bf16 v[124:127], a[48:51], v[140:143], v[124:127]
s_add_u32 m0, s57, 0x100
s_nop 0
buffer_load_dwordx4 v6, s[4:7], 0 offen offset:768 lds
v_mfma_f32_16x16x32_bf16 v[132:135], a[48:51], a[48:51], v[132:135]
s_add_u32 m0, s57, 0x500
s_nop 0
buffer_load_dwordx4 v249, s[4:7], 0 offen offset:768 lds
v_mfma_f32_16x16x32_bf16 v[164:167], v[140:143], a[48:51], v[164:167]
s_add_u32 m0, s57, 0x900
s_nop 0
buffer_load_dwordx4 v250, s[4:7], 0 offen offset:768 lds
v_mfma_f32_16x16x32_bf16 v[128:131], a[52:55], v[140:143], v[128:131]
v_mfma_f32_16x16x32_bf16 v[136:139], a[52:55], a[52:55], v[136:139]
v_mfma_f32_16x16x32_bf16 v[168:171], v[140:143], a[52:55], v[168:171]
v_mfma_f32_16x16x32_bf16 v[124:127], a[56:59], v[140:143], v[124:127]
v_mfma_f32_16x16x32_bf16 v[132:135], a[56:59], a[56:59], v[132:135]
v_mfma_f32_16x16x32_bf16 v[164:167], v[140:143], a[56:59], v[164:167]
v_mfma_f32_16x16x32_bf16 v[128:131], a[60:63], v[140:143], v[128:131]
v_mfma_f32_16x16x32_bf16 v[136:139], a[60:63], a[60:63], v[136:139]
v_mfma_f32_16x16x32_bf16 v[168:171], v[140:143], a[60:63], v[168:171]
s_waitcnt vmcnt(8)
ds_read_b128 a[64:67], v7 offset:4096
ds_read_b128 a[68:71], v7 offset:6144
ds_read_b128 a[72:75], v8 offset:4096
ds_read_b128 a[76:79], v8 offset:6144
s_waitcnt lgkmcnt(0)
s_add_u32 m0, s57, 0xc80
s_nop 0
buffer_load_dwordx4 v5, s[4:7], 0 offen offset:896 lds
v_mfma_f32_16x16x32_bf16 v[124:127], a[64:67], v[140:143], v[124:127]
s_add_u32 m0, s57, 0x1080
s_nop 0
buffer_load_dwordx4 v6, s[4:7], 0 offen offset:896 lds
v_mfma_f32_16x16x32_bf16 v[132:135], a[64:67], a[64:67], v[132:135]
s_add_u32 m0, s57, 0x1480
s_nop 0
buffer_load_dwordx4 v249, s[4:7], 0 offen offset:896 lds
v_mfma_f32_16x16x32_bf16 v[164:167], v[140:143], a[64:67], v[164:167]
s_add_u32 m0, s57, 0x1880
s_nop 0
buffer_load_dwordx4 v250, s[4:7], 0 offen offset:896 lds
v_mfma_f32_16x16x32_bf16 v[128:131], a[68:71], v[140:143], v[128:131]
v_mfma_f32_16x16x32_bf16 v[136:139], a[68:71], a[68:71], v[136:139]
v_mfma_f32_16x16x32_bf16 v[168:171], v[140:143], a[68:71], v[168:171]
v_mfma_f32_16x16x32_bf16 v[124:127], a[72:75], v[140:143], v[124:127]
v_mfma_f32_16x16x32_bf16 v[132:135], a[72:75], a[72:75], v[132:135]
v_mfma_f32_16x16x32_bf16 v[164:167], v[140:143], a[72:75], v[164:167]
v_mfma_f32_16x16x32_bf16 v[128:131], a[76:79], v[140:143], v[128:131]
v_mfma_f32_16x16x32_bf16 v[136:139], a[76:79], a[76:79], v[136:139]
v_mfma_f32_16x16x32_bf16 v[168:171], v[140:143], a[76:79], v[168:171]
s_waitcnt vmcnt(8)
ds_read_b128 a[80:83], v7 offset:8192
ds_read_b128 a[84:87], v7 offset:10240
ds_read_b128 a[88:91], v8 offset:8192
ds_read_b128 a[92:95], v8 offset:10240
s_waitcnt lgkmcnt(0)
s_add_u32 m0, s57, 0x1c00
s_nop 0
buffer_load_dwordx4 v5, s[4:7], 0 offen offset:1024 lds
v_mfma_f32_16x16x32_bf16 v[124:127], a[80:83], v[140:143], v[124:127]
s_add_u32 m0, s57, 0x2000
s_nop 0
buffer_load_dwordx4 v6, s[4:7], 0 offen offset:1024 lds
v_mfma_f32_16x16x32_bf16 v[132:135], a[80:83], a[80:83], v[132:135]
s_add_u32 m0, s57, 0x2400
s_nop 0
buffer_load_dwordx4 v249, s[4:7], 0 offen offset:1024 lds
v_mfma_f32_16x16x32_bf16 v[164:167], v[140:143], a[80:83], v[164:167]
s_add_u32 m0, s57, 0x2800
s_nop 0
buffer_load_dwordx4 v250, s[4:7], 0 offen offset:1024 lds
v_mfma_f32_16x16x32_bf16 v[128:131], a[84:87], v[140:143], v[128:131]
v_mfma_f32_16x16x32_bf16 v[136:139], a[84:87], a[84:87], v[136:139]
v_mfma_f32_16x16x32_bf16 v[168:171], v[140:143], a[84:87], v[168:171]
v_mfma_f32_16x16x32_bf16 v[124:127], a[88:91], v[140:143], v[124:127]
v_mfma_f32_16x16x32_bf16 v[132:135], a[88:91], a[88:91], v[132:135]
v_mfma_f32_16x16x32_bf16 v[164:167], v[140:143], a[88:91], v[164:167]
v_mfma_f32_16x16x32_bf16 v[128:131], a[92:95], v[140:143], v[128:131]
v_mfma_f32_16x16x32_bf16 v[136:139], a[92:95], a[92:95], v[136:139]
v_mfma_f32_16x16x32_bf16 v[168:171], v[140:143], a[92:95], v[168:171]
s_cmp_eq_u32 s40, 0
s_cselect_b64 exec, -1, 0
buffer_load_dword v33, v253, s[32:35], s82 offen sc1
s_mov_b64 exec, -1
s_waitcnt vmcnt(9)
ds_read_b128 a[96:99], v7 offset:0
ds_read_b128 a[100:103], v7 offset:2048
ds_read_b128 a[104:107], v8 offset:0
ds_read_b128 a[108:111], v8 offset:2048
s_waitcnt lgkmcnt(0)
s_add_u32 m0, s57, 0xfffffb80
s_nop 0
buffer_load_dwordx4 v5, s[4:7], 0 offen offset:1152 lds
v_mfma_f32_16x16x32_bf16 v[124:127], a[96:99], v[140:143], v[124:127]
s_add_u32 m0, s57, 0xffffff80
s_nop 0
buffer_load_dwordx4 v6, s[4:7], 0 offen offset:1152 lds
v_mfma_f32_16x16x32_bf16 v[132:135], a[96:99], a[96:99], v[132:135]
s_add_u32 m0, s57, 0x380
s_nop 0
buffer_load_dwordx4 v249, s[4:7], 0 offen offset:1152 lds
v_mfma_f32_16x16x32_bf16 v[164:167], v[140:143], a[96:99], v[164:167]
s_add_u32 m0, s57, 0x780
s_nop 0
buffer_load_dwordx4 v250, s[4:7], 0 offen offset:1152 lds
v_mfma_f32_16x16x32_bf16 v[128:131], a[100:103], v[140:143], v[128:131]
v_mfma_f32_16x16x32_bf16 v[136:139], a[100:103], a[100:103], v[136:139]
v_mfma_f32_16x16x32_bf16 v[168:171], v[140:143], a[100:103], v[168:171]
v_mfma_f32_16x16x32_bf16 v[124:127], a[104:107], v[140:143], v[124:127]
v_mfma_f32_16x16x32_bf16 v[132:135], a[104:107], a[104:107], v[132:135]
v_mfma_f32_16x16x32_bf16 v[164:167], v[140:143], a[104:107], v[164:167]
v_mfma_f32_16x16x32_bf16 v[128:131], a[108:111], v[140:143], v[128:131]
v_mfma_f32_16x16x32_bf16 v[136:139], a[108:111], a[108:111], v[136:139]
v_mfma_f32_16x16x32_bf16 v[168:171], v[140:143], a[108:111], v[168:171]
s_waitcnt vmcnt(9)
ds_read_b128 a[112:115], v7 offset:4096
ds_read_b128 a[116:119], v7 offset:6144
ds_read_b128 a[120:123], v8 offset:4096
ds_read_b128 a[124:127], v8 offset:6144
s_waitcnt vmcnt(4)
s_cmp_lg_u32 s40, 0
s_nop 0
s_cbranch_scc1 L_nw4
s_mov_b32 s51, 400000
L_rp5:
v_cmp_gt_u32 vcc, v252, v33
s_nop 1
s_nop 2
s_cbranch_vccz L_rk6
s_sleep 2
buffer_load_dword v33, v253, s[32:35], s82 offen sc1
s_waitcnt vmcnt(0)
s_sub_u32 s51, s51, 1
s_cmp_lg_u32 s51, 0
s_cbranch_scc1 L_rp5
L_rk6:
L_nw4:
s_barrier
s_waitcnt lgkmcnt(0)
s_add_u32 m0, s59, 0
s_add_u32 s50, s58, 0
buffer_load_dwordx4 v4, s[32:35], s50 offen sc1 lds
v_mfma_f32_16x16x32_bf16 v[124:127], a[112:115], v[140:143], v[124:127]
s_add_u32 m0, s59, 1024
s_add_u32 s50, s58, 1024
buffer_load_dwordx4 v4, s[32:35], s50 offen sc1 lds
v_mfma_f32_16x16x32_bf16 v[132:135], a[112:115], a[112:115], v[132:135]
s_add_u32 m0, s59, 2048
s_add_u32 s50, s58, 2048
buffer_load_dwordx4 v4, s[32:35], s50 offen sc1 lds
v_mfma_f32_16x16x32_bf16 v[164:167], v[140:143], a[112:115], v[164:167]
s_add_u32 m0, s59, 3072
s_add_u32 s50, s58, 3072
buffer_load_dwordx4 v4, s[32:35], s50 offen sc1 lds
v_mfma_f32_16x16x32_bf16 v[128:131], a[116:119], v[140:143], v[128:131]
s_add_u32 m0, s59, 4096
s_add_u32 s50, s58, 4096
buffer_load_dwordx4 v4, s[32:35], s50 offen sc1 lds
v_mfma_f32_16x16x32_bf16 v[136:139], a[116:119], a[116:119], v[136:139]
s_add_u32 m0, s59, 20480
s_add_u32 s50, s58, 20480
buffer_load_dwordx4 v4, s[32:35], s50 offen sc1 lds
v_mfma_f32_16x16x32_bf16 v[168:171], v[140:143], a[116:119], v[168:171]
s_add_u32 m0, s59, 21504
s_add_u32 s50, s58, 21504
buffer_load_dwordx4 v4, s[32:35], s50 offen sc1 lds
v_mfma_f32_16x16x32_bf16 v[124:127], a[120:123], v[140:143], v[124:127]
s_add_u32 m0, s59, 22528
s_add_u32 s50, s58, 22528
buffer_load_dwordx4 v4, s[32:35], s50 offen sc1 lds
v_mfma_f32_16x16x32_bf16 v[132:135], a[120:123], a[120:123], v[132:135]
v_mfma_f32_16x16x32_bf16 v[164:167], v[140:143], a[120:123], v[164:167]
v_mfma_f32_16x16x32_bf16 v[128:131], a[124:127], v[140:143], v[128:131]
v_mfma_f32_16x16x32_bf16 v[136:139], a[124:127], a[124:127], v[136:139]
v_mfma_f32_16x16x32_bf16 v[168:171], v[140:143], a[124:127], v[168:171]
ds_read_b128 a[128:131], v7 offset:8192
ds_read_b128 a[132:135], v7 offset:10240
ds_read_b128 a[136:139], v8 offset:8192
ds_read_b128 a[140:143], v8 offset:10240
s_waitcnt lgkmcnt(0)
s_add_u32 m0, s59, 23552
s_add_u32 s50, s58, 23552
buffer_load_dwordx4 v4, s[32:35], s50 offen sc1 lds
v_mfma_f32_16x16x32_bf16 v[124:127], a[128:131], v[140:143], v[124:127]
s_add_u32 m0, s59, 24576
s_add_u32 s50, s58, 24576
buffer_load_dwordx4 v4, s[32:35], s50 offen sc1 lds
v_mfma_f32_16x16x32_bf16 v[132:135], a[128:131], a[128:131], v[132:135]
s_add_u32 m0, s59, 40960
s_add_u32 s50, s58, 40960
buffer_load_dwordx4 v4, s[32:35], s50 offen sc1 lds
v_mfma_f32_16x16x32_bf16 v[164:167], v[140:143], a[128:131], v[164:167]
s_add_u32 m0, s59, 41984
s_add_u32 s50, s58, 41984
buffer_load_dwordx4 v4, s[32:35], s50 offen sc1 lds
v_mfma_f32_16x16x32_bf16 v[128:131], a[132:135], v[140:143], v[128:131]
s_add_u32 m0, s59, 43008
s_add_u32 s50, s58, 43008
buffer_load_dwordx4 v4, s[32:35], s50 offen sc1 lds
v_mfma_f32_16x16x32_bf16 v[136:139], a[132:135], a[132:135], v[136:139]
s_add_u32 m0, s59, 44032
s_add_u32 s50, s58, 44032
buffer_load_dwordx4 v4, s[32:35], s50 offen sc1 lds
v_mfma_f32_16x16x32_bf16 v[168:171], v[140:143], a[132:135], v[168:171]
s_add_u32 m0, s59, 45056
s_add_u32 s50, s58, 45056
buffer_load_dwordx4 v4, s[32:35], s50 offen sc1 lds
v_mfma_f32_16x16x32_bf16 v[124:127], a[136:139], v[140:143], v[124:127]
s_add_u32 m0, s59, 61440
s_add_u32 s50, s58, 61440
buffer_load_dwordx4 v4, s[32:35], s50 offen sc1 lds
v_mfma_f32_16x16x32_bf16 v[132:135], a[136:139], a[136:139], v[132:135]
v_mfma_f32_16x16x32_bf16 v[164:167], v[140:143], a[136:139], v[164:167]
v_mfma_f32_16x16x32_bf16 v[128:131], a[140:143], v[140:143], v[128:131]
v_mfma_f32_16x16x32_bf16 v[136:139], a[140:143], a[140:143], v[136:139]
v_mfma_f32_16x16x32_bf16 v[168:171], v[140:143], a[140:143], v[168:171]
s_cmp_lg_u32 s40, 3
s_nop 6
s_cbranch_scc1 L_pb7
s_cmp_eq_u32 s2, 0
s_cbranch_scc1 L_pb7
s_lshl_b32 s50, s41, 5
s_add_u32 s50, s50, s42
v_mov_b32 v60, 0
v_mov_b32 v61, s3
s_mov_b64 exec, 1
buffer_store_byte v61, v60, s[36:39], s50 offen sc1
s_mov_b64 exec, -1
L_pb7:
s_waitcnt vmcnt(16)
ds_read_b128 a[144:147], v7 offset:0
ds_read_b128 a[148:151], v7 offset:2048
ds_read_b128 a[152:155], v8 offset:0
ds_read_b128 a[156:159], v8 offset:2048
s_waitcnt lgkmcnt(0)
s_add_u32 m0, s59, 62464
s_add_u32 s50, s58, 62464
buffer_load_dwordx4 v4, s[32:35], s50 offen sc1 lds
v_mfma_f32_16x16x32_bf16 v[124:127], a[144:147], v[140:143], v[124:127]
s_add_u32 m0, s59, 63488
s_add_u32 s50, s58, 63488
buffer_load_dwordx4 v4, s[32:35], s50 offen sc1 lds
v_mfma_f32_16x16x32_bf16 v[132:135], a[144:147], a[144:147], v[132:135]
s_add_u32 m0, s59, 64512
s_add_u32 s50, s58, 64512
buffer_load_dwordx4 v4, s[32:35], s50 offen sc1 lds
v_mfma_f32_16x16x32_bf16 v[164:167], v[140:143], a[144:147], v[164:167]
s_add_u32 m0, s59, 65536
s_add_u32 s50, s58, 65536
buffer_load_dwordx4 v4, s[32:35], s50 offen sc1 lds
v_mfma_f32_16x16x32_bf16 v[128:131], a[148:151], v[140:143], v[128:131]
s_add_u32 m0, s59, 81920
s_add_u32 s50, s58, 81920
buffer_load_dwordx4 v4, s[32:35], s50 offen sc1 lds
v_mfma_f32_16x16x32_bf16 v[136:139], a[148:151], a[148:151], v[136:139]
s_add_u32 m0, s59, 82944
s_add_u32 s50, s58, 82944
buffer_load_dwordx4 v4, s[32:35], s50 offen sc1 lds
v_mfma_f32_16x16x32_bf16 v[168:171], v[140:143], a[148:151], v[168:171]
s_add_u32 m0, s59, 83968
s_add_u32 s50, s58, 83968
buffer_load_dwordx4 v4, s[32:35], s50 offen sc1 lds
v_mfma_f32_16x16x32_bf16 v[124:127], a[152:155], v[140:143], v[124:127]
s_add_u32 m0, s59, 84992
s_add_u32 s50, s58, 84992
buffer_load_dwordx4 v4, s[32:35], s50 offen sc1 lds
v_mfma_f32_16x16x32_bf16 v[132:135], a[152:155], a[152:155], v[132:135]
v_mfma_f32_16x16x32_bf16 v[164:167], v[140:143], a[152:155], v[164:167]
v_mfma_f32_16x16x32_bf16 v[128:131], a[156:159], v[140:143], v[128:131]
v_mfma_f32_16x16x32_bf16 v[136:139], a[156:159], a[156:159], v[136:139]
v_mfma_f32_16x16x32_bf16 v[168:171], v[140:143], a[156:159], v[168:171]
s_waitcnt vmcnt(19)
s_barrier
ds_read_b64_tr_b16 v[144:145], v14 offset:0
ds_read_b64_tr_b16 v[146:147], v14 offset:1280
ds_read_b64_tr_b16 v[148:149], v14 offset:40
ds_read_b64_tr_b16 v[150:151], v14 offset:1320
ds_read_b64_tr_b16 v[152:153], v15 offset:0
ds_read_b64_tr_b16 v[154:155], v15 offset:1280
ds_read_b64_tr_b16 v[156:157], v14 offset:80
ds_read_b64_tr_b16 v[158:159], v14 offset:1360
s_waitcnt lgkmcnt(6)
v_mfma_f32_16x16x32_bf16 v[64:67], a[0:3], v[144:147], 0
ds_read_b64_tr_b16 v[160:161], v14 offset:120
s_add_u32 m0, s59, 86016
v_mfma_f32_16x16x32_bf16 v[84:87], a[4:7], v[144:147], 0
ds_read_b64_tr_b16 v[162:163], v14 offset:1400
s_add_u32 s50, s58, 86016
v_mfma_f32_16x16x32_bf16 v[104:107], v[140:143], v[144:147], 0
buffer_load_dwordx4 v4, s[32:35], s50 offen sc1 lds
s_waitcnt lgkmcnt(6)
v_mfma_f32_16x16x32_bf16 v[68:71], a[0:3], v[148:151], 0
ds_read_b64_tr_b16 v[144:145], v14 offset:5120
s_mov_b32 s94, 0x3acccccd
v_mfma_f32_16x16x32_bf16 v[88:91], a[4:7], v[148:151], 0
ds_read_b64_tr_b16 v[146:147], v14 offset:6400
s_mov_b32 s95, 0x3acccccd
v_mfma_f32_16x16x32_bf16 v[108:111], v[140:143], v[148:151], 0
v_cmp_lt_u32 s[92:93], 7, v2
s_waitcnt lgkmcnt(6)
v_mfma_f32_16x16x32_bf16 v[72:75], a[0:3], v[152:155], 0
ds_read_b64_tr_b16 v[148:149], v14 offset:5160
v_cmp_eq_u32 s[86:87], 0, v251
v_mfma_f32_16x16x32_bf16 v[92:95], a[4:7], v[152:155], 0
ds_read_b64_tr_b16 v[150:151], v14 offset:6440
s_nop 0
v_mfma_f32_16x16x32_bf16 v[112:115], v[140:143], v[152:155], 0
v_cndmask_b32 v180, 0, v132, s[86:87]
s_waitcnt lgkmcnt(6)
v_mfma_f32_16x16x32_bf16 v[76:79], a[0:3], v[156:159], 0
ds_read_b64_tr_b16 v[152:153], v15 offset:5120
v_cndmask_b32 v184, 0, v136, s[86:87]
v_mfma_f32_16x16x32_bf16 v[96:99], a[4:7], v[156:159], 0
ds_read_b64_tr_b16 v[154:155], v15 offset:6400
v_cmp_eq_u32 s[88:89], 1, v251
v_mfma_f32_16x16x32_bf16 v[116:119], v[140:143], v[156:159], 0
s_nop 0
s_waitcnt lgkmcnt(6)
v_mfma_f32_16x16x32_bf16 v[80:83], a[0:3], v[160:163], 0
ds_read_b64_tr_b16 v[156:157], v14 offset:5200
v_cndmask_b32 v181, 0, v133, s[88:89]
v_mfma_f32_16x16x32_bf16 v[100:103], a[4:7], v[160:163], 0
ds_read_b64_tr_b16 v[158:159], v14 offset:6480
v_cndmask_b32 v185, 0, v137, s[88:89]
v_mfma_f32_16x16x32_bf16 v[120:123], v[140:143], v[160:163], 0
v_cmp_eq_u32 s[86:87], 2, v251
s_waitcnt lgkmcnt(6)
v_mfma_f32_16x16x32_bf16 v[64:67], a[8:11], v[144:147], v[64:67]
ds_read_b64_tr_b16 v[160:161], v14 offset:5240
s_nop 0
v_mfma_f32_16x16x32_bf16 v[84:87], a[12:15], v[144:147], v[84:87]
ds_read_b64_tr_b16 v[162:163], v14 offset:6520
v_cndmask_b32 v182, 0, v134, s[86:87]
v_mfma_f32_16x16x32_bf16 v[104:107], v[140:143], v[144:147], v[104:107]
v_cndmask_b32 v186, 0, v138, s[86:87]
s_waitcnt lgkmcnt(6)
v_mfma_f32_16x16x32_bf16 v[68:71], a[8:11], v[148:151], v[68:71]
ds_read_b64_tr_b16 v[144:145], v14 offset:10240
v_cmp_eq_u32 s[88:89], 3, v251
v_mfma_f32_16x16x32_bf16 v[88:91], a[12:15], v[148:151], v[88:91]
ds_read_b64_tr_b16 v[146:147], v14 offset:11520
s_nop 0
v_mfma_f32_16x16x32_bf16 v[108:111], v[140:143], v[148:151], v[108:111]
v_cndmask_b32 v183, 0, v135, s[88:89]
s_waitcnt lgkmcnt(6)
v_mfma_f32_16x16x32_bf16 v[72:75], a[8:11], v[152:155], v[72:75]
ds_read_b64_tr_b16 v[148:149], v14 offset:10280
v_cndmask_b32 v187, 0, v139, s[88:89]
v_mfma_f32_16x16x32_bf16 v[92:95], a[12:15], v[152:155], v[92:95]
ds_read_b64_tr_b16 v[150:151], v14 offset:11560
v_mfma_f32_16x16x32_bf16 v[112:115], v[140:143], v[152:155], v[112:115]
v_pk_mul_f32 v[172:173], v[124:125], s[94:95]
s_waitcnt lgkmcnt(6)
v_mfma_f32_16x16x32_bf16 v[76:79], a[8:11], v[156:159], v[76:79]
ds_read_b64_tr_b16 v[152:153], v15 offset:10240
v_mfma_f32_16x16x32_bf16 v[96:99], a[12:15], v[156:159], v[96:99]
ds_read_b64_tr_b16 v[154:155], v15 offset:11520
v_mfma_f32_16x16x32_bf16 v[116:119], v[140:143], v[156:159], v[116:119]
v_pk_mul_f32 v[174:175], v[126:127], s[94:95]
s_waitcnt lgkmcnt(6)
v_mfma_f32_16x16x32_bf16 v[80:83], a[8:11], v[160:163], v[80:83]
ds_read_b64_tr_b16 v[156:157], v14 offset:10320
v_mfma_f32_16x16x32_bf16 v[100:103], a[12:15], v[160:163], v[100:103]
ds_read_b64_tr_b16 v[158:159], v14 offset:11600
v_mfma_f32_16x16x32_bf16 v[120:123], v[140:143], v[160:163], v[120:123]
v_pk_mul_f32 v[176:177], v[128:129], s[94:95]
s_waitcnt lgkmcnt(6)
v_mfma_f32_16x16x32_bf16 v[64:67], a[16:19], v[144:147], v[64:67]
ds_read_b64_tr_b16 v[160:161], v14 offset:10360
v_mfma_f32_16x16x32_bf16 v[84:87], a[20:23], v[144:147], v[84:87]
ds_read_b64_tr_b16 v[162:163], v14 offset:11640
v_mfma_f32_16x16x32_bf16 v[104:107], v[140:143], v[144:147], v[104:107]
v_pk_mul_f32 v[178:179], v[130:131], s[94:95]
s_waitcnt lgkmcnt(6)
v_mfma_f32_16x16x32_bf16 v[68:71], a[16:19], v[148:151], v[68:71]
ds_read_b64_tr_b16 v[144:145], v14 offset:15360
v_mfma_f32_16x16x32_bf16 v[88:91], a[20:23], v[148:151], v[88:91]
ds_read_b64_tr_b16 v[146:147], v14 offset:16640
v_mfma_f32_16x16x32_bf16 v[108:111], v[140:143], v[148:151], v[108:111]
v_pk_add_f32 v[132:133], v[180:181], v[182:183]
s_waitcnt lgkmcnt(6)
v_mfma_f32_16x16x32_bf16 v[72:75], a[16:19], v[152:155], v[72:75]
ds_read_b64_tr_b16 v[148:149], v14 offset:15400
v_mfma_f32_16x16x32_bf16 v[92:95], a[20:23], v[152:155], v[92:95]
ds_read_b64_tr_b16 v[150:151], v14 offset:16680
v_mfma_f32_16x16x32_bf16 v[112:115], v[140:143], v[152:155], v[112:115]
v_pk_add_f32 v[136:137], v[184:185], v[186:187]
s_waitcnt lgkmcnt(6)
v_mfma_f32_16x16x32_bf16 v[76:79], a[16:19], v[156:159], v[76:79]
ds_read_b64_tr_b16 v[152:153], v15 offset:15360
v_add_f32 v132, v132, v133
v_mfma_f32_16x16x32_bf16 v[96:99], a[20:23], v[156:159], v[96:99]
ds_read_b64_tr_b16 v[154:155], v15 offset:16640
v_add_f32 v136, v136, v137
v_mfma_f32_16x16x32_bf16 v[116:119], v[140:143], v[156:159], v[116:119]
v_add_f32 v180, v180, v180 row_ror:8 row_mask:0xf bank_mask:0xf
s_waitcnt lgkmcnt(6)
v_mfma_f32_16x16x32_bf16 v[80:83], a[16:19], v[160:163], v[80:83]
ds_read_b64_tr_b16 v[156:157], v14 offset:15440
v_add_f32 v181, v181, v181 row_ror:8 row_mask:0xf bank_mask:0xf
v_mfma_f32_16x16x32_bf16 v[100:103], a[20:23], v[160:163], v[100:103]
ds_read_b64_tr_b16 v[158:159], v14 offset:16720
v_add_f32 v182, v182, v182 row_ror:8 row_mask:0xf bank_mask:0xf
v_mfma_f32_16x16x32_bf16 v[120:123], v[140:143], v[160:163], v[120:123]
v_add_f32 v183, v183, v183 row_ror:8 row_mask:0xf bank_mask:0xf
s_waitcnt lgkmcnt(6)
v_mfma_f32_16x16x32_bf16 v[64:67], a[24:27], v[144:147], v[64:67]
ds_read_b64_tr_b16 v[160:161], v14 offset:15480
v_add_f32 v184, v184, v184 row_ror:8 row_mask:0xf bank_mask:0xf
v_mfma_f32_16x16x32_bf16 v[84:87], a[28:31], v[144:147], v[84:87]
ds_read_b64_tr_b16 v[162:163], v14 offset:16760
v_add_f32 v185, v185, v185 row_ror:8 row_mask:0xf bank_mask:0xf
v_mfma_f32_16x16x32_bf16 v[104:107], v[140:143], v[144:147], v[104:107]
v_add_f32 v186, v186, v186 row_ror:8 row_mask:0xf bank_mask:0xf
s_waitcnt lgkmcnt(6)
v_mfma_f32_16x16x32_bf16 v[68:71], a[24:27], v[148:151], v[68:71]
s_waitcnt vmcnt(15)
s_barrier
ds_read_b64_tr_b16 v[144:145], v14 offset:20480
v_add_f32 v187, v187, v187 row_ror:8 row_mask:0xf bank_mask:0xf
v_mfma_f32_16x16x32_bf16 v[88:91], a[28:31], v[148:151], v[88:91]
ds_read_b64_tr_b16 v[146:147], v14 offset:21760
v_add_f32 v180, v180, v180 row_ror:4 row_mask:0xf bank_mask:0xf
v_mfma_f32_16x16x32_bf16 v[108:111], v[140:143], v[148:151], v[108:111]
v_add_f32 v181, v181, v181 row_ror:4 row_mask:0xf bank_mask:0xf
s_waitcnt lgkmcnt(6)
v_mfma_f32_16x16x32_bf16 v[72:75], a[24:27], v[152:155], v[72:75]
ds_read_b64_tr_b16 v[148:149], v14 offset:20520
v_add_f32 v182, v182, v182 row_ror:4 row_mask:0xf bank_mask:0xf
v_mfma_f32_16x16x32_bf16 v[92:95], a[28:31], v[152:155], v[92:95]
ds_read_b64_tr_b16 v[150:151], v14 offset:21800
v_add_f32 v183, v183, v183 row_ror:4 row_mask:0xf bank_mask:0xf
v_mfma_f32_16x16x32_bf16 v[112:115], v[140:143], v[152:155], v[112:115]
v_add_f32 v184, v184, v184 row_ror:4 row_mask:0xf bank_mask:0xf
s_waitcnt lgkmcnt(6)
v_mfma_f32_16x16x32_bf16 v[76:79], a[24:27], v[156:159], v[76:79]
ds_read_b64_tr_b16 v[152:153], v15 offset:20480
v_add_f32 v185, v185, v185 row_ror:4 row_mask:0xf bank_mask:0xf
v_mfma_f32_16x16x32_bf16 v[96:99], a[28:31], v[156:159], v[96:99]
ds_read_b64_tr_b16 v[154:155], v15 offset:21760
v_add_f32 v186, v186, v186 row_ror:4 row_mask:0xf bank_mask:0xf
v_mfma_f32_16x16x32_bf16 v[116:119], v[140:143], v[156:159], v[116:119]
v_add_f32 v187, v187, v187 row_ror:4 row_mask:0xf bank_mask:0xf
s_waitcnt lgkmcnt(6)
v_mfma_f32_16x16x32_bf16 v[80:83], a[24:27], v[160:163], v[80:83]
ds_read_b64_tr_b16 v[156:157], v14 offset:20560
v_add_f32 v180, v180, v180 row_ror:2 row_mask:0xf bank_mask:0xf
v_mfma_f32_16x16x32_bf16 v[100:103], a[28:31], v[160:163], v[100:103]
ds_read_b64_tr_b16 v[158:159], v14 offset:21840
v_add_f32 v181, v181, v181 row_ror:2 row_mask:0xf bank_mask:0xf
v_mfma_f32_16x16x32_bf16 v[120:123], v[140:143], v[160:163], v[120:123]
v_add_f32 v182, v182, v182 row_ror:2 row_mask:0xf bank_mask:0xf
s_waitcnt lgkmcnt(6)
v_mfma_f32_16x16x32_bf16 v[64:67], a[32:35], v[144:147], v[64:67]
ds_read_b64_tr_b16 v[160:161], v14 offset:20600
v_add_f32 v183, v183, v183 row_ror:2 row_mask:0xf bank_mask:0xf
v_mfma_f32_16x16x32_bf16 v[84:87], a[36:39], v[144:147], v[84:87]
ds_read_b64_tr_b16 v[162:163], v14 offset:21880
v_add_f32 v184, v184, v184 row_ror:2 row_mask:0xf bank_mask:0xf
v_mfma_f32_16x16x32_bf16 v[104:107], v[140:143], v[144:147], v[104:107]
v_add_f32 v185, v185, v185 row_ror:2 row_mask:0xf bank_mask:0xf
s_waitcnt lgkmcnt(6)
v_mfma_f32_16x16x32_bf16 v[68:71], a[32:35], v[148:151], v[68:71]
ds_read_b64_tr_b16 v[144:145], v14 offset:25600
v_add_f32 v186, v186, v186 row_ror:2 row_mask:0xf bank_mask:0xf
v_mfma_f32_16x16x32_bf16 v[88:91], a[36:39], v[148:151], v[88:91]
ds_read_b64_tr_b16 v[146:147], v14 offset:26880
v_add_f32 v187, v187, v187 row_ror:2 row_mask:0xf bank_mask:0xf
v_mfma_f32_16x16x32_bf16 v[108:111], v[140:143], v[148:151], v[108:111]
v_add_f32 v180, v180, v180 row_ror:1 row_mask:0xf bank_mask:0xf
s_waitcnt lgkmcnt(6)
v_mfma_f32_16x16x32_bf16 v[72:75], a[32:35], v[152:155], v[72:75]
ds_read_b64_tr_b16 v[148:149], v14 offset:25640
v_add_f32 v181, v181, v181 row_ror:1 row_mask:0xf bank_mask:0xf
v_mfma_f32_16x16x32_bf16 v[92:95], a[36:39], v[152:155], v[92:95]
ds_read_b64_tr_b16 v[150:151], v14 offset:26920
v_add_f32 v182, v182, v182 row_ror:1 row_mask:0xf bank_mask:0xf
v_mfma_f32_16x16x32_bf16 v[112:115], v[140:143], v[152:155], v[112:115]
v_add_f32 v183, v183, v183 row_ror:1 row_mask:0xf bank_mask:0xf
s_waitcnt lgkmcnt(6)
v_mfma_f32_16x16x32_bf16 v[76:79], a[32:35], v[156:159], v[76:79]
ds_read_b64_tr_b16 v[152:153], v15 offset:25600
v_add_f32 v184, v184, v184 row_ror:1 row_mask:0xf bank_mask:0xf
v_mfma_f32_16x16x32_bf16 v[96:99], a[36:39], v[156:159], v[96:99]
ds_read_b64_tr_b16 v[154:155], v15 offset:26880
v_add_f32 v185, v185, v185 row_ror:1 row_mask:0xf bank_mask:0xf
v_mfma_f32_16x16x32_bf16 v[116:119], v[140:143], v[156:159], v[116:119]
v_add_f32 v186, v186, v186 row_ror:1 row_mask:0xf bank_mask:0xf
s_waitcnt lgkmcnt(6)
v_mfma_f32_16x16x32_bf16 v[80:83], a[32:35], v[160:163], v[80:83]
ds_read_b64_tr_b16 v[156:157], v14 offset:25680
v_add_f32 v187, v187, v187 row_ror:1 row_mask:0xf bank_mask:0xf
v_mfma_f32_16x16x32_bf16 v[100:103], a[36:39], v[160:163], v[100:103]
ds_read_b64_tr_b16 v[158:159], v14 offset:26960
v_mov_b32 v133, v132
v_mfma_f32_16x16x32_bf16 v[120:123], v[140:143], v[160:163], v[120:123]
v_mov_b32 v137, v136
s_waitcnt lgkmcnt(6)
v_mfma_f32_16x16x32_bf16 v[64:67], a[40:43], v[144:147], v[64:67]
ds_read_b64_tr_b16 v[160:161], v14 offset:25720
v_permlane16_swap_b32 v132, v133
v_mfma_f32_16x16x32_bf16 v[84:87], a[44:47], v[144:147], v[84:87]
ds_read_b64_tr_b16 v[162:163], v14 offset:27000
v_permlane16_swap_b32 v136, v137
v_mfma_f32_16x16x32_bf16 v[104:107], v[140:143], v[144:147], v[104:107]
v_add_f32 v132, v132, v133
s_waitcnt lgkmcnt(6)
v_mfma_f32_16x16x32_bf16 v[68:71], a[40:43], v[148:151], v[68:71]
ds_read_b64_tr_b16 v[144:145], v14 offset:30720
v_add_f32 v136, v136, v137
v_mfma_f32_16x16x32_bf16 v[88:91], a[44:47], v[148:151], v[88:91]
ds_read_b64_tr_b16 v[146:147], v14 offset:32000
v_mov_b32 v133, v132
v_mfma_f32_16x16x32_bf16 v[108:111], v[140:143], v[148:151], v[108:111]
v_mov_b32 v137, v136
s_waitcnt lgkmcnt(6)
v_mfma_f32_16x16x32_bf16 v[72:75], a[40:43], v[152:155], v[72:75]
ds_read_b64_tr_b16 v[148:149], v14 offset:30760
v_permlane32_swap_b32 v132, v133
v_mfma_f32_16x16x32_bf16 v[92:95], a[44:47], v[152:155], v[92:95]
ds_read_b64_tr_b16 v[150:151], v14 offset:32040
v_permlane32_swap_b32 v136, v137
v_mfma_f32_16x16x32_bf16 v[112:115], v[140:143], v[152:155], v[112:115]
v_add_f32 v132, v132, v133
s_waitcnt lgkmcnt(6)
v_mfma_f32_16x16x32_bf16 v[76:79], a[40:43], v[156:159], v[76:79]
ds_read_b64_tr_b16 v[152:153], v15 offset:30720
v_add_f32 v136, v136, v137
v_mfma_f32_16x16x32_bf16 v[96:99], a[44:47], v[156:159], v[96:99]
ds_read_b64_tr_b16 v[154:155], v15 offset:32000
v_mul_f32 v28, s94, v164
v_mfma_f32_16x16x32_bf16 v[116:119], v[140:143], v[156:159], v[116:119]
v_mul_f32 v30, s94, v132
s_waitcnt lgkmcnt(6)
v_mfma_f32_16x16x32_bf16 v[80:83], a[40:43], v[160:163], v[80:83]
ds_read_b64_tr_b16 v[156:157], v14 offset:30800
v_mul_f32 v52, s94, v168
v_mfma_f32_16x16x32_bf16 v[100:103], a[44:47], v[160:163], v[100:103]
ds_read_b64_tr_b16 v[158:159], v14 offset:32080
v_mul_f32 v54, s94, v136
v_mfma_f32_16x16x32_bf16 v[120:123], v[140:143], v[160:163], v[120:123]
v_fma_f32 v30, -v28, v28, v30
s_waitcnt lgkmcnt(6)
v_mfma_f32_16x16x32_bf16 v[64:67], a[48:51], v[144:147], v[64:67]
ds_read_b64_tr_b16 v[160:161], v14 offset:30840
s_add_u32 m0, s100, 0
v_mfma_f32_16x16x32_bf16 v[84:87], a[52:55], v[144:147], v[84:87]
ds_read_b64_tr_b16 v[162:163], v14 offset:32120
s_add_u32 s50, s83, 0
v_mfma_f32_16x16x32_bf16 v[104:107], v[140:143], v[144:147], v[104:107]
buffer_load_dwordx4 v4, s[32:35], s50 offen sc1 lds
s_waitcnt lgkmcnt(6)
v_mfma_f32_16x16x32_bf16 v[68:71], a[48:51], v[148:151], v[68:71]
ds_read_b64_tr_b16 v[144:145], v14 offset:35840
v_fma_f32 v54, -v52, v52, v54
v_mfma_f32_16x16x32_bf16 v[88:91], a[52:55], v[148:151], v[88:91]
ds_read_b64_tr_b16 v[146:147], v14 offset:37120
v_mfma_f32_16x16x32_bf16 v[108:111], v[140:143], v[148:151], v[108:111]
v_pk_mul_f32 v[180:181], v[180:181], s[94:95]
s_waitcnt lgkmcnt(6)
v_mfma_f32_16x16x32_bf16 v[72:75], a[48:51], v[152:155], v[72:75]
ds_read_b64_tr_b16 v[148:149], v14 offset:35880
v_mfma_f32_16x16x32_bf16 v[92:95], a[52:55], v[152:155], v[92:95]
ds_read_b64_tr_b16 v[150:151], v14 offset:37160
v_mfma_f32_16x16x32_bf16 v[112:115], v[140:143], v[152:155], v[112:115]
v_pk_mul_f32 v[182:183], v[182:183], s[94:95]
s_waitcnt lgkmcnt(6)
v_mfma_f32_16x16x32_bf16 v[76:79], a[48:51], v[156:159], v[76:79]
ds_read_b64_tr_b16 v[152:153], v15 offset:35840
s_add_u32 m0, s100, 1024
v_mfma_f32_16x16x32_bf16 v[96:99], a[52:55], v[156:159], v[96:99]
ds_read_b64_tr_b16 v[154:155], v15 offset:37120
s_add_u32 s50, s83, 1024
v_mfma_f32_16x16x32_bf16 v[116:119], v[140:143], v[156:159], v[116:119]
buffer_load_dwordx4 v4, s[32:35], s50 offen sc1 lds
s_waitcnt lgkmcnt(6)
v_mfma_f32_16x16x32_bf16 v[80:83], a[48:51], v[160:163], v[80:83]
ds_read_b64_tr_b16 v[156:157], v14 offset:35920
v_mfma_f32_16x16x32_bf16 v[100:103], a[52:55], v[160:163], v[100:103]
ds_read_b64_tr_b16 v[158:159], v14 offset:37200
v_mfma_f32_16x16x32_bf16 v[120:123], v[140:143], v[160:163], v[120:123]
v_pk_mul_f32 v[184:185], v[184:185], s[94:95]
s_waitcnt lgkmcnt(6)
v_mfma_f32_16x16x32_bf16 v[64:67], a[56:59], v[144:147], v[64:67]
ds_read_b64_tr_b16 v[160:161], v14 offset:35960
v_mfma_f32_16x16x32_bf16 v[84:87], a[60:63], v[144:147], v[84:87]
ds_read_b64_tr_b16 v[162:163], v14 offset:37240
v_mfma_f32_16x16x32_bf16 v[104:107], v[140:143], v[144:147], v[104:107]
v_pk_mul_f32 v[186:187], v[186:187], s[94:95]
s_waitcnt lgkmcnt(6)
v_mfma_f32_16x16x32_bf16 v[68:71], a[56:59], v[148:151], v[68:71]
s_add_u32 m0, s100, 2048
s_add_u32 s50, s83, 2048
buffer_load_dwordx4 v4, s[32:35], s50 offen sc1 lds
s_waitcnt vmcnt(13)
s_barrier
ds_read_b64_tr_b16 v[144:145], v14 offset:40960
v_mfma_f32_16x16x32_bf16 v[88:91], a[60:63], v[148:151], v[88:91]
ds_read_b64_tr_b16 v[146:147], v14 offset:42240
v_mfma_f32_16x16x32_bf16 v[108:111], v[140:143], v[148:151], v[108:111]
v_pk_fma_f32 v[180:181], v[172:173], v[172:173], v[180:181] neg_lo:[1,0,0] neg_hi:[1,0,0]
s_waitcnt lgkmcnt(6)
v_mfma_f32_16x16x32_bf16 v[72:75], a[56:59], v[152:155], v[72:75]
ds_read_b64_tr_b16 v[148:149], v14 offset:41000
v_mfma_f32_16x16x32_bf16 v[92:95], a[60:63], v[152:155], v[92:95]
ds_read_b64_tr_b16 v[150:151], v14 offset:42280
v_mfma_f32_16x16x32_bf16 v[112:115], v[140:143], v[152:155], v[112:115]
v_pk_fma_f32 v[182:183], v[174:175], v[174:175], v[182:183] neg_lo:[1,0,0] neg_hi:[1,0,0]
s_waitcnt lgkmcnt(6)
v_mfma_f32_16x16x32_bf16 v[76:79], a[56:59], v[156:159], v[76:79]
ds_read_b64_tr_b16 v[152:153], v15 offset:40960
v_mfma_f32_16x16x32_bf16 v[96:99], a[60:63], v[156:159], v[96:99]
ds_read_b64_tr_b16 v[154:155], v15 offset:42240
v_mfma_f32_16x16x32_bf16 v[116:119], v[140:143], v[156:159], v[116:119]
v_pk_fma_f32 v[184:185], v[176:177], v[176:177], v[184:185] neg_lo:[1,0,0] neg_hi:[1,0,0]
s_waitcnt lgkmcnt(6)
v_mfma_f32_16x16x32_bf16 v[80:83], a[56:59], v[160:163], v[80:83]
ds_read_b64_tr_b16 v[156:157], v14 offset:41040
s_add_u32 m0, s100, 12288
v_mfma_f32_16x16x32_bf16 v[100:103], a[60:63], v[160:163], v[100:103]
ds_read_b64_tr_b16 v[158:159], v14 offset:42320
s_add_u32 s50, s83, 12288
v_mfma_f32_16x16x32_bf16 v[120:123], v[140:143], v[160:163], v[120:123]
buffer_load_dwordx4 v4, s[32:35], s50 offen sc1 lds
s_waitcnt lgkmcnt(6)
v_mfma_f32_16x16x32_bf16 v[64:67], a[64:67], v[144:147], v[64:67]
ds_read_b64_tr_b16 v[160:161], v14 offset:41080
v_mfma_f32_16x16x32_bf16 v[84:87], a[68:71], v[144:147], v[84:87]
ds_read_b64_tr_b16 v[162:163], v14 offset:42360
v_mfma_f32_16x16x32_bf16 v[104:107], v[140:143], v[144:147], v[104:107]
v_pk_fma_f32 v[186:187], v[178:179], v[178:179], v[186:187] neg_lo:[1,0,0] neg_hi:[1,0,0]
s_waitcnt lgkmcnt(6)
v_mfma_f32_16x16x32_bf16 v[68:71], a[64:67], v[148:151], v[68:71]
ds_read_b64_tr_b16 v[144:145], v14 offset:46080
v_max_f32 v180, 0, v180
v_mfma_f32_16x16x32_bf16 v[88:91], a[68:71], v[148:151], v[88:91]
ds_read_b64_tr_b16 v[146:147], v14 offset:47360
v_max_f32 v181, 0, v181
v_mfma_f32_16x16x32_bf16 v[108:111], v[140:143], v[148:151], v[108:111]
v_max_f32 v182, 0, v182
s_waitcnt lgkmcnt(6)
v_mfma_f32_16x16x32_bf16 v[72:75], a[64:67], v[152:155], v[72:75]
ds_read_b64_tr_b16 v[148:149], v14 offset:46120
s_add_u32 m0, s100, 13312
v_mfma_f32_16x16x32_bf16 v[92:95], a[68:71], v[152:155], v[92:95]
ds_read_b64_tr_b16 v[150:151], v14 offset:47400
s_add_u32 s50, s83, 13312
v_mfma_f32_16x16x32_bf16 v[112:115], v[140:143], v[152:155], v[112:115]
buffer_load_dwordx4 v4, s[32:35], s50 offen sc1 lds
s_waitcnt lgkmcnt(6)
v_mfma_f32_16x16x32_bf16 v[76:79], a[64:67], v[156:159], v[76:79]
ds_read_b64_tr_b16 v[152:153], v15 offset:46080
v_max_f32 v183, 0, v183
v_mfma_f32_16x16x32_bf16 v[96:99], a[68:71], v[156:159], v[96:99]
ds_read_b64_tr_b16 v[154:155], v15 offset:47360
v_max_f32 v184, 0, v184
v_mfma_f32_16x16x32_bf16 v[116:119], v[140:143], v[156:159], v[116:119]
v_max_f32 v185, 0, v185
s_waitcnt lgkmcnt(6)
v_mfma_f32_16x16x32_bf16 v[80:83], a[64:67], v[160:163], v[80:83]
ds_read_b64_tr_b16 v[156:157], v14 offset:46160
v_max_f32 v186, 0, v186
v_mfma_f32_16x16x32_bf16 v[100:103], a[68:71], v[160:163], v[100:103]
ds_read_b64_tr_b16 v[158:159], v14 offset:47440
v_max_f32 v187, 0, v187
v_mfma_f32_16x16x32_bf16 v[120:123], v[140:143], v[160:163], v[120:123]
v_max_f32 v30, 0, v30
s_waitcnt lgkmcnt(6)
v_mfma_f32_16x16x32_bf16 v[64:67], a[72:75], v[144:147], v[64:67]
ds_read_b64_tr_b16 v[160:161], v14 offset:46200
s_add_u32 m0, s100, 14336
v_mfma_f32_16x16x32_bf16 v[84:87], a[76:79], v[144:147], v[84:87]
ds_read_b64_tr_b16 v[162:163], v14 offset:47480
s_add_u32 s50, s83, 14336
v_mfma_f32_16x16x32_bf16 v[104:107], v[140:143], v[144:147], v[104:107]
buffer_load_dwordx4 v4, s[32:35], s50 offen sc1 lds
s_waitcnt lgkmcnt(6)
v_mfma_f32_16x16x32_bf16 v[68:71], a[72:75], v[148:151], v[68:71]
ds_read_b64_tr_b16 v[144:145], v14 offset:51200
v_max_f32 v54, 0, v54
v_mfma_f32_16x16x32_bf16 v[88:91], a[76:79], v[148:151], v[88:91]
ds_read_b64_tr_b16 v[146:147], v14 offset:52480
v_add_f32 v180, 0x3727c5ac, v180
v_mfma_f32_16x16x32_bf16 v[108:111], v[140:143], v[148:151], v[108:111]
v_add_f32 v181, 0x3727c5ac, v181
s_waitcnt lgkmcnt(6)
v_mfma_f32_16x16x32_bf16 v[72:75], a[72:75], v[152:155], v[72:75]
ds_read_b64_tr_b16 v[148:149], v14 offset:51240
v_add_f32 v182, 0x3727c5ac, v182
v_mfma_f32_16x16x32_bf16 v[92:95], a[76:79], v[152:155], v[92:95]
ds_read_b64_tr_b16 v[150:151], v14 offset:52520
v_add_f32 v183, 0x3727c5ac, v183
v_mfma_f32_16x16x32_bf16 v[112:115], v[140:143], v[152:155], v[112:115]
v_add_f32 v184, 0x3727c5ac, v184
s_waitcnt lgkmcnt(6)
v_mfma_f32_16x16x32_bf16 v[76:79], a[72:75], v[156:159], v[76:79]
ds_read_b64_tr_b16 v[152:153], v15 offset:51200
s_add_u32 m0, s100, 24576
v_mfma_f32_16x16x32_bf16 v[96:99], a[76:79], v[156:159], v[96:99]
ds_read_b64_tr_b16 v[154:155], v15 offset:52480
s_add_u32 s50, s83, 24576
v_mfma_f32_16x16x32_bf16 v[116:119], v[140:143], v[156:159], v[116:119]
buffer_load_dwordx4 v4, s[32:35], s50 offen sc1 lds
s_waitcnt lgkmcnt(6)
v_mfma_f32_16x16x32_bf16 v[80:83], a[72:75], v[160:163], v[80:83]
ds_read_b64_tr_b16 v[156:157], v14 offset:51280
v_add_f32 v185, 0x3727c5ac, v185
v_mfma_f32_16x16x32_bf16 v[100:103], a[76:79], v[160:163], v[100:103]
ds_read_b64_tr_b16 v[158:159], v14 offset:52560
v_add_f32 v186, 0x3727c5ac, v186
v_mfma_f32_16x16x32_bf16 v[120:123], v[140:143], v[160:163], v[120:123]
v_add_f32 v187, 0x3727c5ac, v187
s_waitcnt lgkmcnt(6)
v_mfma_f32_16x16x32_bf16 v[64:67], a[80:83], v[144:147], v[64:67]
ds_read_b64_tr_b16 v[160:161], v14 offset:51320
v_add_f32 v30, 0x3727c5ac, v30
v_mfma_f32_16x16x32_bf16 v[84:87], a[84:87], v[144:147], v[84:87]
ds_read_b64_tr_b16 v[162:163], v14 offset:52600
v_add_f32 v54, 0x3727c5ac, v54
v_mfma_f32_16x16x32_bf16 v[104:107], v[140:143], v[144:147], v[104:107]
v_rsq_f32 v180, v180
s_waitcnt lgkmcnt(6)
v_mfma_f32_16x16x32_bf16 v[68:71], a[80:83], v[148:151], v[68:71]
ds_read_b64_tr_b16 v[144:145], v14 offset:56320
s_add_u32 m0, s100, 25600
v_mfma_f32_16x16x32_bf16 v[88:91], a[84:87], v[148:151], v[88:91]
ds_read_b64_tr_b16 v[146:147], v14 offset:57600
s_add_u32 s50, s83, 25600
v_mfma_f32_16x16x32_bf16 v[108:111], v[140:143], v[148:151], v[108:111]
buffer_load_dwordx4 v4, s[32:35], s50 offen sc1 lds
s_waitcnt lgkmcnt(6)
v_mfma_f32_16x16x32_bf16 v[72:75], a[80:83], v[152:155], v[72:75]
ds_read_b64_tr_b16 v[148:149], v14 offset:56360
v_mfma_f32_16x16x32_bf16 v[92:95], a[84:87], v[152:155], v[92:95]
ds_read_b64_tr_b16 v[150:151], v14 offset:57640
v_mfma_f32_16x16x32_bf16 v[112:115], v[140:143], v[152:155], v[112:115]
v_rsq_f32 v181, v181
s_waitcnt lgkmcnt(6)
v_mfma_f32_16x16x32_bf16 v[76:79], a[80:83], v[156:159], v[76:79]
ds_read_b64_tr_b16 v[152:153], v15 offset:56320
v_mfma_f32_16x16x32_bf16 v[96:99], a[84:87], v[156:159], v[96:99]
ds_read_b64_tr_b16 v[154:155], v15 offset:57600
v_mfma_f32_16x16x32_bf16 v[116:119], v[140:143], v[156:159], v[116:119]
v_rsq_f32 v182, v182
s_waitcnt lgkmcnt(6)
v_mfma_f32_16x16x32_bf16 v[80:83], a[80:83], v[160:163], v[80:83]
ds_read_b64_tr_b16 v[156:157], v14 offset:56400
s_add_u32 m0, s100, 26624
v_mfma_f32_16x16x32_bf16 v[100:103], a[84:87], v[160:163], v[100:103]
ds_read_b64_tr_b16 v[158:159], v14 offset:57680
s_add_u32 s50, s83, 26624
v_mfma_f32_16x16x32_bf16 v[120:123], v[140:143], v[160:163], v[120:123]
buffer_load_dwordx4 v4, s[32:35], s50 offen sc1 lds
s_waitcnt lgkmcnt(6)
v_mfma_f32_16x16x32_bf16 v[64:67], a[88:91], v[144:147], v[64:67]
ds_read_b64_tr_b16 v[160:161], v14 offset:56440
v_mfma_f32_16x16x32_bf16 v[84:87], a[92:95], v[144:147], v[84:87]
ds_read_b64_tr_b16 v[162:163], v14 offset:57720
v_mfma_f32_16x16x32_bf16 v[104:107], v[140:143], v[144:147], v[104:107]
v_rsq_f32 v183, v183
s_waitcnt lgkmcnt(6)
v_mfma_f32_16x16x32_bf16 v[68:71], a[88:91], v[148:151], v[68:71]
s_waitcnt vmcnt(14)
s_barrier
v_add_u32 v14, 0xf000, v14
v_add_u32 v15, 0xf000, v15
ds_read_b64_tr_b16 v[144:145], v14 offset:0
v_mfma_f32_16x16x32_bf16 v[88:91], a[92:95], v[148:151], v[88:91]
ds_read_b64_tr_b16 v[146:147], v14 offset:1280
v_mfma_f32_16x16x32_bf16 v[108:111], v[140:143], v[148:151], v[108:111]
v_rsq_f32 v184, v184
s_waitcnt lgkmcnt(6)
v_mfma_f32_16x16x32_bf16 v[72:75], a[88:91], v[152:155], v[72:75]
ds_read_b64_tr_b16 v[148:149], v14 offset:40
s_add_u32 m0, s100, 36864
v_mfma_f32_16x16x32_bf16 v[92:95], a[92:95], v[152:155], v[92:95]
ds_read_b64_tr_b16 v[150:151], v14 offset:1320
s_add_u32 s50, s83, 36864
v_mfma_f32_16x16x32_bf16 v[112:115], v[140:143], v[152:155], v[112:115]
buffer_load_dwordx4 v4, s[32:35], s50 offen sc1 lds
s_waitcnt lgkmcnt(6)
v_mfma_f32_16x16x32_bf16 v[76:79], a[88:91], v[156:159], v[76:79]
ds_read_b64_tr_b16 v[152:153], v15 offset:0
v_mfma_f32_16x16x32_bf16 v[96:99], a[92:95], v[156:159], v[96:99]
ds_read_b64_tr_b16 v[154:155], v15 offset:1280
v_mfma_f32_16x16x32_bf16 v[116:119], v[140:143], v[156:159], v[116:119]
v_rsq_f32 v185, v185
s_waitcnt lgkmcnt(6)
v_mfma_f32_16x16x32_bf16 v[80:83], a[88:91], v[160:163], v[80:83]
ds_read_b64_tr_b16 v[156:157], v14 offset:80
v_mfma_f32_16x16x32_bf16 v[100:103], a[92:95], v[160:163], v[100:103]
ds_read_b64_tr_b16 v[158:159], v14 offset:1360
v_mfma_f32_16x16x32_bf16 v[120:123], v[140:143], v[160:163], v[120:123]
v_rsq_f32 v186, v186
s_waitcnt lgkmcnt(6)
v_mfma_f32_16x16x32_bf16 v[64:67], a[96:99], v[144:147], v[64:67]
ds_read_b64_tr_b16 v[160:161], v14 offset:120
s_add_u32 m0, s100, 37888
v_mfma_f32_16x16x32_bf16 v[84:87], a[100:103], v[144:147], v[84:87]
ds_read_b64_tr_b16 v[162:163], v14 offset:1400
s_add_u32 s50, s83, 37888
v_mfma_f32_16x16x32_bf16 v[104:107], v[140:143], v[144:147], v[104:107]
buffer_load_dwordx4 v4, s[32:35], s50 offen sc1 lds
s_waitcnt lgkmcnt(6)
v_mfma_f32_16x16x32_bf16 v[68:71], a[96:99], v[148:151], v[68:71]
ds_read_b64_tr_b16 v[144:145], v14 offset:5120
v_mfma_f32_16x16x32_bf16 v[88:91], a[100:103], v[148:151], v[88:91]
ds_read_b64_tr_b16 v[146:147], v14 offset:6400
v_mfma_f32_16x16x32_bf16 v[108:111], v[140:143], v[148:151], v[108:111]
v_rsq_f32 v187, v187
s_waitcnt lgkmcnt(6)
v_mfma_f32_16x16x32_bf16 v[72:75], a[96:99], v[152:155], v[72:75]
ds_read_b64_tr_b16 v[148:149], v14 offset:5160
v_mfma_f32_16x16x32_bf16 v[92:95], a[100:103], v[152:155], v[92:95]
ds_read_b64_tr_b16 v[150:151], v14 offset:6440
v_mfma_f32_16x16x32_bf16 v[112:115], v[140:143], v[152:155], v[112:115]
v_rsq_f32 v30, v30
s_waitcnt lgkmcnt(6)
v_mfma_f32_16x16x32_bf16 v[76:79], a[96:99], v[156:159], v[76:79]
ds_read_b64_tr_b16 v[152:153], v15 offset:5120
s_add_u32 m0, s100, 38912
v_mfma_f32_16x16x32_bf16 v[96:99], a[100:103], v[156:159], v[96:99]
ds_read_b64_tr_b16 v[154:155], v15 offset:6400
s_add_u32 s50, s83, 38912
v_mfma_f32_16x16x32_bf16 v[116:119], v[140:143], v[156:159], v[116:119]
buffer_load_dwordx4 v4, s[32:35], s50 offen sc1 lds
s_waitcnt lgkmcnt(6)
v_mfma_f32_16x16x32_bf16 v[80:83], a[96:99], v[160:163], v[80:83]
ds_read_b64_tr_b16 v[156:157], v14 offset:5200
v_mfma_f32_16x16x32_bf16 v[100:103], a[100:103], v[160:163], v[100:103]
ds_read_b64_tr_b16 v[158:159], v14 offset:6480
v_mfma_f32_16x16x32_bf16 v[120:123], v[140:143], v[160:163], v[120:123]
v_rsq_f32 v54, v54
s_waitcnt lgkmcnt(6)
v_mfma_f32_16x16x32_bf16 v[64:67], a[104:107], v[144:147], v[64:67]
ds_read_b64_tr_b16 v[160:161], v14 offset:5240
v_mfma_f32_16x16x32_bf16 v[84:87], a[108:111], v[144:147], v[84:87]
ds_read_b64_tr_b16 v[162:163], v14 offset:6520
v_mfma_f32_16x16x32_bf16 v[104:107], v[140:143], v[144:147], v[104:107]
s_waitcnt lgkmcnt(6)
v_mfma_f32_16x16x32_bf16 v[68:71], a[104:107], v[148:151], v[68:71]
ds_read_b64_tr_b16 v[144:145], v14 offset:10240
s_add_u32 m0, s100, 49152
v_mfma_f32_16x16x32_bf16 v[88:91], a[108:111], v[148:151], v[88:91]
ds_read_b64_tr_b16 v[146:147], v14 offset:11520
s_add_u32 s50, s83, 49152
v_mfma_f32_16x16x32_bf16 v[108:111], v[140:143], v[148:151], v[108:111]
buffer_load_dwordx4 v4, s[32:35], s50 offen sc1 lds
s_waitcnt lgkmcnt(6)
v_mfma_f32_16x16x32_bf16 v[72:75], a[104:107], v[152:155], v[72:75]
ds_read_b64_tr_b16 v[148:149], v14 offset:10280
v_mfma_f32_16x16x32_bf16 v[92:95], a[108:111], v[152:155], v[92:95]
ds_read_b64_tr_b16 v[150:151], v14 offset:11560
v_mfma_f32_16x16x32_bf16 v[112:115], v[140:143], v[152:155], v[112:115]
s_waitcnt lgkmcnt(6)
v_mfma_f32_16x16x32_bf16 v[76:79], a[104:107], v[156:159], v[76:79]
ds_read_b64_tr_b16 v[152:153], v15 offset:10240
v_mfma_f32_16x16x32_bf16 v[96:99], a[108:111], v[156:159], v[96:99]
ds_read_b64_tr_b16 v[154:155], v15 offset:11520
v_mfma_f32_16x16x32_bf16 v[116:119], v[140:143], v[156:159], v[116:119]
s_waitcnt lgkmcnt(6)
v_mfma_f32_16x16x32_bf16 v[80:83], a[104:107], v[160:163], v[80:83]
ds_read_b64_tr_b16 v[156:157], v14 offset:10320
s_add_u32 m0, s100, 50176
v_mfma_f32_16x16x32_bf16 v[100:103], a[108:111], v[160:163], v[100:103]
ds_read_b64_tr_b16 v[158:159], v14 offset:11600
s_add_u32 s50, s83, 50176
v_mfma_f32_16x16x32_bf16 v[120:123], v[140:143], v[160:163], v[120:123]
buffer_load_dwordx4 v4, s[32:35], s50 offen sc1 lds
s_waitcnt lgkmcnt(6)
v_mfma_f32_16x16x32_bf16 v[64:67], a[112:115], v[144:147], v[64:67]
ds_read_b64_tr_b16 v[160:161], v14 offset:10360
v_mfma_f32_16x16x32_bf16 v[84:87], a[116:119], v[144:147], v[84:87]
ds_read_b64_tr_b16 v[162:163], v14 offset:11640
v_mfma_f32_16x16x32_bf16 v[104:107], v[140:143], v[144:147], v[104:107]
s_waitcnt lgkmcnt(6)
v_mfma_f32_16x16x32_bf16 v[68:71], a[112:115], v[148:151], v[68:71]
ds_read_b64_tr_b16 v[144:145], v14 offset:15360
v_mfma_f32_16x16x32_bf16 v[88:91], a[116:119], v[148:151], v[88:91]
ds_read_b64_tr_b16 v[146:147], v14 offset:16640
v_mfma_f32_16x16x32_bf16 v[108:111], v[140:143], v[148:151], v[108:111]
s_waitcnt lgkmcnt(6)
v_mfma_f32_16x16x32_bf16 v[72:75], a[112:115], v[152:155], v[72:75]
ds_read_b64_tr_b16 v[148:149], v14 offset:15400
s_add_u32 m0, s100, 51200
v_mfma_f32_16x16x32_bf16 v[92:95], a[116:119], v[152:155], v[92:95]
ds_read_b64_tr_b16 v[150:151], v14 offset:16680
s_add_u32 s50, s83, 51200
v_mfma_f32_16x16x32_bf16 v[112:115], v[140:143], v[152:155], v[112:115]
buffer_load_dwordx4 v4, s[32:35], s50 offen sc1 lds
s_waitcnt lgkmcnt(6)
v_mfma_f32_16x16x32_bf16 v[76:79], a[112:115], v[156:159], v[76:79]
ds_read_b64_tr_b16 v[152:153], v15 offset:15360
v_mfma_f32_16x16x32_bf16 v[96:99], a[116:119], v[156:159], v[96:99]
ds_read_b64_tr_b16 v[154:155], v15 offset:16640
v_mfma_f32_16x16x32_bf16 v[116:119], v[140:143], v[156:159], v[116:119]
s_waitcnt lgkmcnt(6)
v_mfma_f32_16x16x32_bf16 v[80:83], a[112:115], v[160:163], v[80:83]
ds_read_b64_tr_b16 v[156:157], v14 offset:15440
v_mfma_f32_16x16x32_bf16 v[100:103], a[116:119], v[160:163], v[100:103]
ds_read_b64_tr_b16 v[158:159], v14 offset:16720
v_mfma_f32_16x16x32_bf16 v[120:123], v[140:143], v[160:163], v[120:123]
s_waitcnt lgkmcnt(6)
v_mfma_f32_16x16x32_bf16 v[64:67], a[120:123], v[144:147], v[64:67]
ds_read_b64_tr_b16 v[160:161], v14 offset:15480
v_mfma_f32_16x16x32_bf16 v[84:87], a[124:127], v[144:147], v[84:87]
ds_read_b64_tr_b16 v[162:163], v14 offset:16760
v_mfma_f32_16x16x32_bf16 v[104:107], v[140:143], v[144:147], v[104:107]
s_waitcnt lgkmcnt(6)
v_mfma_f32_16x16x32_bf16 v[68:71], a[120:123], v[148:151], v[68:71]
s_waitcnt vmcnt(15)
s_barrier
ds_read_b64_tr_b16 v[144:145], v14 offset:20480
v_mfma_f32_16x16x32_bf16 v[88:91], a[124:127], v[148:151], v[88:91]
ds_read_b64_tr_b16 v[146:147], v14 offset:21760
v_mfma_f32_16x16x32_bf16 v[108:111], v[140:143], v[148:151], v[108:111]
s_waitcnt lgkmcnt(6)
v_mfma_f32_16x16x32_bf16 v[72:75], a[120:123], v[152:155], v[72:75]
ds_read_b64_tr_b16 v[148:149], v14 offset:20520
v_mfma_f32_16x16x32_bf16 v[92:95], a[124:127], v[152:155], v[92:95]
ds_read_b64_tr_b16 v[150:151], v14 offset:21800
v_mfma_f32_16x16x32_bf16 v[112:115], v[140:143], v[152:155], v[112:115]
s_waitcnt lgkmcnt(6)
v_mfma_f32_16x16x32_bf16 v[76:79], a[120:123], v[156:159], v[76:79]
ds_read_b64_tr_b16 v[152:153], v15 offset:20480
v_mfma_f32_16x16x32_bf16 v[96:99], a[124:127], v[156:159], v[96:99]
ds_read_b64_tr_b16 v[154:155], v15 offset:21760
v_mfma_f32_16x16x32_bf16 v[116:119], v[140:143], v[156:159], v[116:119]
s_mul_i32 s50, s2, 25
s_mul_i32 s51, s40, 7
s_add_u32 s50, s50, s51
s_lshl_b32 s50, s50, 7
s_mov_b64 exec, 0x7f
buffer_load_dword v255, v254, s[12:15], s50 offen
s_mov_b64 exec, -1
s_waitcnt lgkmcnt(6)
v_mfma_f32_16x16x32_bf16 v[80:83], a[120:123], v[160:163], v[80:83]
ds_read_b64_tr_b16 v[156:157], v14 offset:20560
v_mfma_f32_16x16x32_bf16 v[100:103], a[124:127], v[160:163], v[100:103]
ds_read_b64_tr_b16 v[158:159], v14 offset:21840
v_mfma_f32_16x16x32_bf16 v[120:123], v[140:143], v[160:163], v[120:123]
s_waitcnt lgkmcnt(6)
v_mfma_f32_16x16x32_bf16 v[64:67], a[128:131], v[144:147], v[64:67]
ds_read_b64_tr_b16 v[160:161], v14 offset:20600
v_mfma_f32_16x16x32_bf16 v[84:87], a[132:135], v[144:147], v[84:87]
ds_read_b64_tr_b16 v[162:163], v14 offset:21880
v_mfma_f32_16x16x32_bf16 v[104:107], v[140:143], v[144:147], v[104:107]
s_mul_i32 s50, s2, 68
s_mul_i32 s51, s40, 17
s_add_u32 s50, s50, s51
s_lshl_b32 s50, s50, 7
s_mov_b64 exec, 0x1ffff
buffer_load_dword v255, v254, s[16:19], s50 offen
s_mov_b64 exec, -1
s_waitcnt lgkmcnt(6)
v_mfma_f32_16x16x32_bf16 v[68:71], a[128:131], v[148:151], v[68:71]
ds_read_b64_tr_b16 v[144:145], v14 offset:25600
v_mfma_f32_16x16x32_bf16 v[88:91], a[132:135], v[148:151], v[88:91]
ds_read_b64_tr_b16 v[146:147], v14 offset:26880
v_mfma_f32_16x16x32_bf16 v[108:111], v[140:143], v[148:151], v[108:111]
s_waitcnt lgkmcnt(6)
v_mfma_f32_16x16x32_bf16 v[72:75], a[128:131], v[152:155], v[72:75]
ds_read_b64_tr_b16 v[148:149], v14 offset:25640
v_mfma_f32_16x16x32_bf16 v[92:95], a[132:135], v[152:155], v[92:95]
ds_read_b64_tr_b16 v[150:151], v14 offset:26920
v_mfma_f32_16x16x32_bf16 v[112:115], v[140:143], v[152:155], v[112:115]
s_mul_i32 s50, s2, 68
s_mul_i32 s51, s40, 17
s_add_u32 s50, s50, s51
s_lshl_b32 s50, s50, 7
s_mov_b64 exec, 0x1ffff
buffer_load_dword v255, v254, s[20:23], s50 offen
s_mov_b64 exec, -1
s_waitcnt lgkmcnt(6)
v_mfma_f32_16x16x32_bf16 v[76:79], a[128:131], v[156:159], v[76:79]
ds_read_b64_tr_b16 v[152:153], v15 offset:25600
v_mfma_f32_16x16x32_bf16 v[96:99], a[132:135], v[156:159], v[96:99]
ds_read_b64_tr_b16 v[154:155], v15 offset:26880
v_mfma_f32_16x16x32_bf16 v[116:119], v[140:143], v[156:159], v[116:119]
s_waitcnt lgkmcnt(6)
v_mfma_f32_16x16x32_bf16 v[80:83], a[128:131], v[160:163], v[80:83]
ds_read_b64_tr_b16 v[156:157], v14 offset:25680
v_mfma_f32_16x16x32_bf16 v[100:103], a[132:135], v[160:163], v[100:103]
ds_read_b64_tr_b16 v[158:159], v14 offset:26960
v_mfma_f32_16x16x32_bf16 v[120:123], v[140:143], v[160:163], v[120:123]
s_mul_i32 s50, s2, 68
s_mul_i32 s51, s40, 17
s_add_u32 s50, s50, s51
s_lshl_b32 s50, s50, 7
s_mov_b64 exec, 0x1ffff
buffer_load_dword v255, v254, s[24:27], s50 offen
s_mov_b64 exec, -1
s_waitcnt lgkmcnt(6)
v_mfma_f32_16x16x32_bf16 v[64:67], a[136:139], v[144:147], v[64:67]
ds_read_b64_tr_b16 v[160:161], v14 offset:25720
v_mfma_f32_16x16x32_bf16 v[84:87], a[140:143], v[144:147], v[84:87]
ds_read_b64_tr_b16 v[162:163], v14 offset:27000
v_mfma_f32_16x16x32_bf16 v[104:107], v[140:143], v[144:147], v[104:107]
s_waitcnt lgkmcnt(6)
v_mfma_f32_16x16x32_bf16 v[68:71], a[136:139], v[148:151], v[68:71]
ds_read_b64_tr_b16 v[144:145], v14 offset:30720
v_mfma_f32_16x16x32_bf16 v[88:91], a[140:143], v[148:151], v[88:91]
ds_read_b64_tr_b16 v[146:147], v14 offset:32000
v_mfma_f32_16x16x32_bf16 v[108:111], v[140:143], v[148:151], v[108:111]
s_waitcnt lgkmcnt(6)
v_mfma_f32_16x16x32_bf16 v[72:75], a[136:139], v[152:155], v[72:75]
ds_read_b64_tr_b16 v[148:149], v14 offset:30760
v_mfma_f32_16x16x32_bf16 v[92:95], a[140:143], v[152:155], v[92:95]
ds_read_b64_tr_b16 v[150:151], v14 offset:32040
v_mfma_f32_16x16x32_bf16 v[112:115], v[140:143], v[152:155], v[112:115]
s_waitcnt lgkmcnt(6)
v_mfma_f32_16x16x32_bf16 v[76:79], a[136:139], v[156:159], v[76:79]
ds_read_b64_tr_b16 v[152:153], v15 offset:30720
v_mfma_f32_16x16x32_bf16 v[96:99], a[140:143], v[156:159], v[96:99]
ds_read_b64_tr_b16 v[154:155], v15 offset:32000
v_mfma_f32_16x16x32_bf16 v[116:119], v[140:143], v[156:159], v[116:119]
s_waitcnt lgkmcnt(6)
v_mfma_f32_16x16x32_bf16 v[80:83], a[136:139], v[160:163], v[80:83]
ds_read_b64_tr_b16 v[156:157], v14 offset:30800
v_mfma_f32_16x16x32_bf16 v[100:103], a[140:143], v[160:163], v[100:103]
ds_read_b64_tr_b16 v[158:159], v14 offset:32080
v_mfma_f32_16x16x32_bf16 v[120:123], v[140:143], v[160:163], v[120:123]
s_waitcnt lgkmcnt(6)
v_mfma_f32_16x16x32_bf16 v[64:67], a[144:147], v[144:147], v[64:67]
ds_read_b64_tr_b16 v[160:161], v14 offset:30840
v_mfma_f32_16x16x32_bf16 v[84:87], a[148:151], v[144:147], v[84:87]
ds_read_b64_tr_b16 v[162:163], v14 offset:32120
v_mfma_f32_16x16x32_bf16 v[104:107], v[140:143], v[144:147], v[104:107]
s_waitcnt lgkmcnt(6)
v_mfma_f32_16x16x32_bf16 v[68:71], a[144:147], v[148:151], v[68:71]
ds_read_b64_tr_b16 v[144:145], v14 offset:35840
v_mfma_f32_16x16x32_bf16 v[88:91], a[148:151], v[148:151], v[88:91]
ds_read_b64_tr_b16 v[146:147], v14 offset:37120
v_mfma_f32_16x16x32_bf16 v[108:111], v[140:143], v[148:151], v[108:111]
s_waitcnt lgkmcnt(6)
v_mfma_f32_16x16x32_bf16 v[72:75], a[144:147], v[152:155], v[72:75]
ds_read_b64_tr_b16 v[148:149], v14 offset:35880
v_mfma_f32_16x16x32_bf16 v[92:95], a[148:151], v[152:155], v[92:95]
ds_read_b64_tr_b16 v[150:151], v14 offset:37160
v_mfma_f32_16x16x32_bf16 v[112:115], v[140:143], v[152:155], v[112:115]
s_waitcnt lgkmcnt(6)
v_mfma_f32_16x16x32_bf16 v[76:79], a[144:147], v[156:159], v[76:79]
ds_read_b64_tr_b16 v[152:153], v15 offset:35840
v_mfma_f32_16x16x32_bf16 v[96:99], a[148:151], v[156:159], v[96:99]
ds_read_b64_tr_b16 v[154:155], v15 offset:37120
v_mfma_f32_16x16x32_bf16 v[116:119], v[140:143], v[156:159], v[116:119]
s_waitcnt lgkmcnt(6)
v_mfma_f32_16x16x32_bf16 v[80:83], a[144:147], v[160:163], v[80:83]
ds_read_b64_tr_b16 v[156:157], v14 offset:35920
v_mfma_f32_16x16x32_bf16 v[100:103], a[148:151], v[160:163], v[100:103]
ds_read_b64_tr_b16 v[158:159], v14 offset:37200
v_mfma_f32_16x16x32_bf16 v[120:123], v[140:143], v[160:163], v[120:123]
s_waitcnt lgkmcnt(6)
v_mfma_f32_16x16x32_bf16 v[64:67], a[152:155], v[144:147], v[64:67]
ds_read_b64_tr_b16 v[160:161], v14 offset:35960
v_mfma_f32_16x16x32_bf16 v[84:87], a[156:159], v[144:147], v[84:87]
ds_read_b64_tr_b16 v[162:163], v14 offset:37240
v_mfma_f32_16x16x32_bf16 v[104:107], v[140:143], v[144:147], v[104:107]
s_waitcnt lgkmcnt(6)
v_mfma_f32_16x16x32_bf16 v[68:71], a[152:155], v[148:151], v[68:71]
v_mfma_f32_16x16x32_bf16 v[88:91], a[156:159], v[148:151], v[88:91]
v_mfma_f32_16x16x32_bf16 v[108:111], v[140:143], v[148:151], v[108:111]
s_waitcnt lgkmcnt(4)
v_mfma_f32_16x16x32_bf16 v[72:75], a[152:155], v[152:155], v[72:75]
v_mfma_f32_16x16x32_bf16 v[92:95], a[156:159], v[152:155], v[92:95]
v_mfma_f32_16x16x32_bf16 v[112:115], v[140:143], v[152:155], v[112:115]
s_waitcnt lgkmcnt(2)
v_mfma_f32_16x16x32_bf16 v[76:79], a[152:155], v[156:159], v[76:79]
v_mfma_f32_16x16x32_bf16 v[96:99], a[156:159], v[156:159], v[96:99]
v_mfma_f32_16x16x32_bf16 v[116:119], v[140:143], v[156:159], v[116:119]
s_waitcnt lgkmcnt(0)
v_mfma_f32_16x16x32_bf16 v[80:83], a[152:155], v[160:163], v[80:83]
v_mfma_f32_16x16x32_bf16 v[100:103], a[156:159], v[160:163], v[100:103]
v_mfma_f32_16x16x32_bf16 v[120:123], v[140:143], v[160:163], v[120:123]
s_waitcnt vmcnt(4)
s_barrier
v_pk_fma_f32 v[64:65], v[172:173], v[104:105], v[64:65] neg_lo:[1,0,0] neg_hi:[1,0,0]
v_pk_fma_f32 v[66:67], v[174:175], v[104:105], v[66:67] neg_lo:[1,0,0] neg_hi:[1,0,0]
v_pk_fma_f32 v[68:69], v[172:173], v[108:109], v[68:69] neg_lo:[1,0,0] neg_hi:[1,0,0]
v_pk_fma_f32 v[70:71], v[174:175], v[108:109], v[70:71] neg_lo:[1,0,0] neg_hi:[1,0,0]
v_pk_fma_f32 v[72:73], v[172:173], v[112:113], v[72:73] neg_lo:[1,0,0] neg_hi:[1,0,0]
v_pk_fma_f32 v[74:75], v[174:175], v[112:113], v[74:75] neg_lo:[1,0,0] neg_hi:[1,0,0]
v_pk_fma_f32 v[76:77], v[172:173], v[116:117], v[76:77] neg_lo:[1,0,0] neg_hi:[1,0,0]
v_pk_fma_f32 v[78:79], v[174:175], v[116:117], v[78:79] neg_lo:[1,0,0] neg_hi:[1,0,0]
v_pk_fma_f32 v[80:81], v[172:173], v[120:121], v[80:81] neg_lo:[1,0,0] neg_hi:[1,0,0]
v_pk_fma_f32 v[82:83], v[174:175], v[120:121], v[82:83] neg_lo:[1,0,0] neg_hi:[1,0,0]
v_pk_fma_f32 v[84:85], v[176:177], v[104:105], v[84:85] neg_lo:[1,0,0] neg_hi:[1,0,0]
v_pk_fma_f32 v[86:87], v[178:179], v[104:105], v[86:87] neg_lo:[1,0,0] neg_hi:[1,0,0]
v_pk_fma_f32 v[88:89], v[176:177], v[108:109], v[88:89] neg_lo:[1,0,0] neg_hi:[1,0,0]
v_pk_fma_f32 v[90:91], v[178:179], v[108:109], v[90:91] neg_lo:[1,0,0] neg_hi:[1,0,0]
v_pk_fma_f32 v[92:93], v[176:177], v[112:113], v[92:93] neg_lo:[1,0,0] neg_hi:[1,0,0]
v_pk_fma_f32 v[94:95], v[178:179], v[112:113], v[94:95] neg_lo:[1,0,0] neg_hi:[1,0,0]
v_pk_fma_f32 v[96:97], v[176:177], v[116:117], v[96:97] neg_lo:[1,0,0] neg_hi:[1,0,0]
v_pk_fma_f32 v[98:99], v[178:179], v[116:117], v[98:99] neg_lo:[1,0,0] neg_hi:[1,0,0]
v_pk_fma_f32 v[100:101], v[176:177], v[120:121], v[100:101] neg_lo:[1,0,0] neg_hi:[1,0,0]
v_pk_fma_f32 v[102:103], v[178:179], v[120:121], v[102:103] neg_lo:[1,0,0] neg_hi:[1,0,0]
v_pk_mul_f32 v[64:65], v[180:181], v[64:65]
v_pk_mul_f32 v[66:67], v[182:183], v[66:67]
v_pk_mul_f32 v[68:69], v[180:181], v[68:69]
v_pk_mul_f32 v[70:71], v[182:183], v[70:71]
v_pk_mul_f32 v[72:73], v[180:181], v[72:73]
v_pk_mul_f32 v[74:75], v[182:183], v[74:75]
v_pk_mul_f32 v[76:77], v[180:181], v[76:77]
v_pk_mul_f32 v[78:79], v[182:183], v[78:79]
v_pk_mul_f32 v[80:81], v[180:181], v[80:81]
v_pk_mul_f32 v[82:83], v[182:183], v[82:83]
v_pk_mul_f32 v[84:85], v[184:185], v[84:85]
v_pk_mul_f32 v[86:87], v[186:187], v[86:87]
v_pk_mul_f32 v[88:89], v[184:185], v[88:89]
v_pk_mul_f32 v[90:91], v[186:187], v[90:91]
v_pk_mul_f32 v[92:93], v[184:185], v[92:93]
v_pk_mul_f32 v[94:95], v[186:187], v[94:95]
v_pk_mul_f32 v[96:97], v[184:185], v[96:97]
v_pk_mul_f32 v[98:99], v[186:187], v[98:99]
v_pk_mul_f32 v[100:101], v[184:185], v[100:101]
v_pk_mul_f32 v[102:103], v[186:187], v[102:103]
v_cvt_pk_bf16_f32 v116, v76, v77
v_cvt_pk_bf16_f32 v117, v78, v79
v_cvt_pk_bf16_f32 v118, v96, v97
v_cvt_pk_bf16_f32 v119, v98, v99
v_cvt_pk_bf16_f32 v120, v80, v81
v_cvt_pk_bf16_f32 v121, v82, v83
v_cvt_pk_bf16_f32 v122, v100, v101
v_cvt_pk_bf16_f32 v123, v102, v103
v_pk_mul_f32 v[188:189], v[72:73], s[96:97]
v_pk_mul_f32 v[190:191], v[74:75], s[96:97]
v_pk_mul_f32 v[192:193], v[92:93], s[96:97]
v_pk_mul_f32 v[194:195], v[94:95], s[96:97]
v_exp_f32_e64 v188, v188 clamp
v_exp_f32_e64 v189, v189 clamp
v_exp_f32_e64 v190, v190 clamp
v_exp_f32_e64 v191, v191 clamp
v_exp_f32_e64 v192, v192 clamp
v_exp_f32_e64 v193, v193 clamp
v_exp_f32_e64 v194, v194 clamp
v_exp_f32_e64 v195, v195 clamp
v_pk_add_f32 v[196:197], v[72:73], s[98:99]
v_pk_add_f32 v[198:199], v[74:75], s[98:99]
v_pk_add_f32 v[200:201], v[92:93], s[98:99]
v_pk_add_f32 v[202:203], v[94:95], s[98:99]
v_max_f32 v196, s98, v196
v_max_f32 v197, s98, v197
v_max_f32 v198, s98, v198
v_max_f32 v199, s98, v199
v_max_f32 v200, s98, v200
v_max_f32 v201, s98, v201
v_max_f32 v202, s98, v202
v_max_f32 v203, s98, v203
v_pk_add_f32 v[188:189], v[188:189], v[196:197]
v_pk_add_f32 v[190:191], v[190:191], v[198:199]
v_pk_add_f32 v[192:193], v[192:193], v[200:201]
v_pk_add_f32 v[194:195], v[194:195], v[202:203]
v_cndmask_b32 v72, v72, v188, s[92:93]
v_cndmask_b32 v73, v73, v189, s[92:93]
v_cndmask_b32 v74, v74, v190, s[92:93]
v_cndmask_b32 v75, v75, v191, s[92:93]
v_cndmask_b32 v92, v92, v192, s[92:93]
v_cndmask_b32 v93, v93, v193, s[92:93]
v_cndmask_b32 v94, v94, v194, s[92:93]
v_cndmask_b32 v95, v95, v195, s[92:93]
v_cvt_pk_bf16_f32 v112, v72, v73
v_cvt_pk_bf16_f32 v113, v74, v75
v_cvt_pk_bf16_f32 v114, v92, v93
v_cvt_pk_bf16_f32 v115, v94, v95
v_pk_mul_f32 v[188:189], v[64:65], s[96:97]
v_pk_mul_f32 v[190:191], v[66:67], s[96:97]
v_pk_mul_f32 v[192:193], v[84:85], s[96:97]
v_pk_mul_f32 v[194:195], v[86:87], s[96:97]
v_pk_mul_f32 v[196:197], v[68:69], s[96:97]
v_pk_mul_f32 v[198:199], v[70:71], s[96:97]
v_pk_mul_f32 v[200:201], v[88:89], s[96:97]
v_pk_mul_f32 v[202:203], v[90:91], s[96:97]
v_exp_f32_e64 v188, v188 clamp
v_exp_f32_e64 v189, v189 clamp
v_exp_f32_e64 v190, v190 clamp
v_exp_f32_e64 v191, v191 clamp
v_exp_f32_e64 v192, v192 clamp
v_exp_f32_e64 v193, v193 clamp
v_exp_f32_e64 v194, v194 clamp
v_exp_f32_e64 v195, v195 clamp
v_exp_f32_e64 v196, v196 clamp
v_exp_f32_e64 v197, v197 clamp
v_exp_f32_e64 v198, v198 clamp
v_exp_f32_e64 v199, v199 clamp
v_exp_f32_e64 v200, v200 clamp
v_exp_f32_e64 v201, v201 clamp
v_exp_f32_e64 v202, v202 clamp
v_exp_f32_e64 v203, v203 clamp
v_pk_add_f32 v[204:205], v[64:65], s[98:99]
v_pk_add_f32 v[206:207], v[66:67], s[98:99]
v_pk_add_f32 v[208:209], v[84:85], s[98:99]
v_pk_add_f32 v[210:211], v[86:87], s[98:99]
v_pk_add_f32 v[212:213], v[68:69], s[98:99]
v_pk_add_f32 v[214:215], v[70:71], s[98:99]
v_pk_add_f32 v[216:217], v[88:89], s[98:99]
v_pk_add_f32 v[218:219], v[90:91], s[98:99]
v_max_f32 v204, s98, v204
v_max_f32 v205, s98, v205
v_max_f32 v206, s98, v206
v_max_f32 v207, s98, v207
v_max_f32 v208, s98, v208
v_max_f32 v209, s98, v209
v_max_f32 v210, s98, v210
v_max_f32 v211, s98, v211
v_max_f32 v212, s98, v212
v_max_f32 v213, s98, v213
v_max_f32 v214, s98, v214
v_max_f32 v215, s98, v215
v_max_f32 v216, s98, v216
v_max_f32 v217, s98, v217
v_max_f32 v218, s98, v218
v_max_f32 v219, s98, v219
v_pk_add_f32 v[64:65], v[188:189], v[204:205]
v_pk_add_f32 v[66:67], v[190:191], v[206:207]
v_pk_add_f32 v[84:85], v[192:193], v[208:209]
v_pk_add_f32 v[86:87], v[194:195], v[210:211]
v_pk_add_f32 v[68:69], v[196:197], v[212:213]
v_pk_add_f32 v[70:71], v[198:199], v[214:215]
v_pk_add_f32 v[88:89], v[200:201], v[216:217]
v_pk_add_f32 v[90:91], v[202:203], v[218:219]
v_cvt_pk_bf16_f32 v104, v64, v65
v_cvt_pk_bf16_f32 v105, v66, v67
v_cvt_pk_bf16_f32 v106, v84, v85
v_cvt_pk_bf16_f32 v107, v86, v87
v_cvt_pk_bf16_f32 v108, v68, v69
v_cvt_pk_bf16_f32 v109, v70, v71
v_cvt_pk_bf16_f32 v110, v88, v89
v_cvt_pk_bf16_f32 v111, v90, v91
s_mul_i32 s52, s40, 10240
v_add_u32 v60, s52, v4
s_lshl_b32 s53, s44, 16
s_lshl_b32 s52, s41, 13
s_add_u32 s53, s53, s52
s_lshl_b32 s52, s43, 12
s_add_u32 s53, s53, s52
s_add_u32 s53, s53, 65536
v_mfma_f32_16x16x32_bf16 v[208:211], v[112:115], v[116:119], 0
v_mfma_f32_16x16x32_bf16 v[212:215], v[112:115], v[120:123], 0
v_mfma_f32_16x16x32_bf16 v[224:227], v[112:115], v[112:115], 0
v_mfma_f32_16x16x32_bf16 v[236:239], v[112:115], v[140:143], 0
v_mfma_f32_16x16x32_bf16 v[200:203], v[104:107], v[116:119], 0
v_mfma_f32_16x16x32_bf16 v[216:219], v[104:107], v[112:115], 0
v_mfma_f32_16x16x32_bf16 v[228:231], v[104:107], v[140:143], 0
v_mfma_f32_16x16x32_bf16 v[204:207], v[108:111], v[120:123], 0
v_mfma_f32_16x16x32_bf16 v[220:223], v[108:111], v[112:115], 0
v_mfma_f32_16x16x32_bf16 v[232:235], v[108:111], v[140:143], 0
ds_write_b128 v60, v[208:211] offset:2048
ds_write_b128 v60, v[212:215] offset:3072
ds_write_b128 v60, v[224:227] offset:6144
ds_write_b128 v60, v[236:239] offset:9216
ds_write_b128 v60, v[200:203] offset:0
ds_write_b128 v60, v[216:219] offset:4096
ds_write_b128 v60, v[228:231] offset:7168
ds_write_b128 v60, v[204:207] offset:1024
ds_write_b128 v60, v[220:223] offset:5120
ds_write_b128 v60, v[232:235] offset:8192
v_mov_b32 v144, 0
v_mov_b32 v145, 0
v_mov_b32 v146, 0
v_mov_b32 v147, 0
v_add_u32 v61, 81920, v32
s_waitcnt lgkmcnt(0)
s_barrier
ds_read_b128 v[200:203], v26 offset:0
ds_read_b128 v[204:207], v26 offset:10240
ds_read_b128 v[208:211], v26 offset:20480
ds_read_b128 v[212:215], v26 offset:30720
ds_write_b128 v61, v[144:147]
ds_write_b128 v61, v[144:147] offset:4096
s_waitcnt lgkmcnt(2)
v_pk_add_f32 v[200:201], v[200:201], v[204:205]
v_pk_add_f32 v[202:203], v[202:203], v[206:207]
v_pk_add_f32 v[208:209], v[208:209], v[212:213]
v_pk_add_f32 v[210:211], v[210:211], v[214:215]
v_pk_add_f32 v[200:201], v[200:201], v[208:209]
v_pk_add_f32 v[202:203], v[202:203], v[210:211]
buffer_store_dwordx4 v[200:203], v32, s[32:35], s53 offen sc1
s_lshl_b32 s52, s41, 5
v_and_b32 v47, 31, v1
v_add_u32 v47, s52, v47
buffer_load_ubyte v33, v47, s[36:39], 0 offen sc1
ds_read_b64_tr_b16 v[144:145], v16 offset:0
ds_read_b64_tr_b16 v[146:147], v16 offset:768
ds_read_b64_tr_b16 v[148:149], v16 offset:40
ds_read_b64_tr_b16 v[150:151], v16 offset:808
ds_read_b64_tr_b16 v[152:153], v17 offset:0
ds_read_b64_tr_b16 v[154:155], v17 offset:768
ds_read_b64_tr_b16 v[156:157], v16 offset:3072
ds_read_b64_tr_b16 v[158:159], v16 offset:3840
s_waitcnt lgkmcnt(6)
v_mfma_f32_16x16x32_bf16 v[64:67], v[144:147], a[0:3], 0
ds_read_b64_tr_b16 v[160:161], v16 offset:3112
v_mfma_f32_16x16x32_bf16 v[76:79], v[144:147], a[4:7], 0
ds_read_b64_tr_b16 v[162:163], v16 offset:3880
v_mfma_f32_16x16x32_bf16 v[88:91], v[144:147], v[140:143], 0
s_waitcnt lgkmcnt(6)
v_mfma_f32_16x16x32_bf16 v[68:71], v[148:151], a[0:3], 0
ds_read_b64_tr_b16 v[144:145], v17 offset:3072
v_mfma_f32_16x16x32_bf16 v[80:83], v[148:151], a[4:7], 0
ds_read_b64_tr_b16 v[146:147], v17 offset:3840
v_mfma_f32_16x16x32_bf16 v[92:95], v[148:151], v[140:143], 0
s_waitcnt lgkmcnt(6)
v_mfma_f32_16x16x32_bf16 v[72:75], v[152:155], a[0:3], 0
ds_read_b64_tr_b16 v[148:149], v16 offset:6144
v_mfma_f32_16x16x32_bf16 v[84:87], v[152:155], a[4:7], 0
ds_read_b64_tr_b16 v[150:151], v16 offset:6912
v_mfma_f32_16x16x32_bf16 v[96:99], v[152:155], v[140:143], 0
s_waitcnt lgkmcnt(6)
v_mfma_f32_16x16x32_bf16 v[64:67], v[156:159], a[8:11], v[64:67]
ds_read_b64_tr_b16 v[152:153], v16 offset:6184
v_mfma_f32_16x16x32_bf16 v[76:79], v[156:159], a[12:15], v[76:79]
ds_read_b64_tr_b16 v[154:155], v16 offset:6952
v_mfma_f32_16x16x32_bf16 v[88:91], v[156:159], v[140:143], v[88:91]
s_waitcnt lgkmcnt(6)
v_mfma_f32_16x16x32_bf16 v[68:71], v[160:163], a[8:11], v[68:71]
ds_read_b64_tr_b16 v[156:157], v17 offset:6144
v_mfma_f32_16x16x32_bf16 v[80:83], v[160:163], a[12:15], v[80:83]
ds_read_b64_tr_b16 v[158:159], v17 offset:6912
v_mfma_f32_16x16x32_bf16 v[92:95], v[160:163], v[140:143], v[92:95]
s_waitcnt lgkmcnt(6)
v_mfma_f32_16x16x32_bf16 v[72:75], v[144:147], a[8:11], v[72:75]
ds_read_b64_tr_b16 v[160:161], v16 offset:9216
v_mfma_f32_16x16x32_bf16 v[84:87], v[144:147], a[12:15], v[84:87]
ds_read_b64_tr_b16 v[162:163], v16 offset:9984
v_mfma_f32_16x16x32_bf16 v[96:99], v[144:147], v[140:143], v[96:99]
s_waitcnt lgkmcnt(6)
v_mfma_f32_16x16x32_bf16 v[64:67], v[148:151], a[16:19], v[64:67]
ds_read_b64_tr_b16 v[144:145], v16 offset:9256
v_mfma_f32_16x16x32_bf16 v[76:79], v[148:151], a[20:23], v[76:79]
ds_read_b64_tr_b16 v[146:147], v16 offset:10024
v_mfma_f32_16x16x32_bf16 v[88:91], v[148:151], v[140:143], v[88:91]
s_waitcnt lgkmcnt(6)
v_mfma_f32_16x16x32_bf16 v[68:71], v[152:155], a[16:19], v[68:71]
ds_read_b64_tr_b16 v[148:149], v17 offset:9216
v_mfma_f32_16x16x32_bf16 v[80:83], v[152:155], a[20:23], v[80:83]
ds_read_b64_tr_b16 v[150:151], v17 offset:9984
v_mfma_f32_16x16x32_bf16 v[92:95], v[152:155], v[140:143], v[92:95]
s_waitcnt lgkmcnt(6)
v_mfma_f32_16x16x32_bf16 v[72:75], v[156:159], a[16:19], v[72:75]
ds_read_b64_tr_b16 v[152:153], v16 offset:12288
v_mfma_f32_16x16x32_bf16 v[84:87], v[156:159], a[20:23], v[84:87]
ds_read_b64_tr_b16 v[154:155], v16 offset:13056
v_mfma_f32_16x16x32_bf16 v[96:99], v[156:159], v[140:143], v[96:99]
s_waitcnt lgkmcnt(6)
v_mfma_f32_16x16x32_bf16 v[64:67], v[160:163], a[24:27], v[64:67]
ds_read_b64_tr_b16 v[156:157], v16 offset:12328
v_mfma_f32_16x16x32_bf16 v[76:79], v[160:163], a[28:31], v[76:79]
ds_read_b64_tr_b16 v[158:159], v16 offset:13096
v_mfma_f32_16x16x32_bf16 v[88:91], v[160:163], v[140:143], v[88:91]
s_waitcnt lgkmcnt(6)
v_mfma_f32_16x16x32_bf16 v[68:71], v[144:147], a[24:27], v[68:71]
ds_read_b64_tr_b16 v[160:161], v17 offset:12288
v_mfma_f32_16x16x32_bf16 v[80:83], v[144:147], a[28:31], v[80:83]
ds_read_b64_tr_b16 v[162:163], v17 offset:13056
v_mfma_f32_16x16x32_bf16 v[92:95], v[144:147], v[140:143], v[92:95]
s_waitcnt lgkmcnt(6)
v_mfma_f32_16x16x32_bf16 v[72:75], v[148:151], a[24:27], v[72:75]
ds_read_b64_tr_b16 v[144:145], v16 offset:15360
v_mfma_f32_16x16x32_bf16 v[84:87], v[148:151], a[28:31], v[84:87]
ds_read_b64_tr_b16 v[146:147], v16 offset:16128
v_mfma_f32_16x16x32_bf16 v[96:99], v[148:151], v[140:143], v[96:99]
s_waitcnt lgkmcnt(6)
v_mfma_f32_16x16x32_bf16 v[64:67], v[152:155], a[32:35], v[64:67]
ds_read_b64_tr_b16 v[148:149], v16 offset:15400
v_mfma_f32_16x16x32_bf16 v[76:79], v[152:155], a[36:39], v[76:79]
ds_read_b64_tr_b16 v[150:151], v16 offset:16168
v_mfma_f32_16x16x32_bf16 v[88:91], v[152:155], v[140:143], v[88:91]
s_waitcnt lgkmcnt(6)
v_mfma_f32_16x16x32_bf16 v[68:71], v[156:159], a[32:35], v[68:71]
ds_read_b64_tr_b16 v[152:153], v17 offset:15360
v_mfma_f32_16x16x32_bf16 v[80:83], v[156:159], a[36:39], v[80:83]
ds_read_b64_tr_b16 v[154:155], v17 offset:16128
v_mfma_f32_16x16x32_bf16 v[92:95], v[156:159], v[140:143], v[92:95]
s_waitcnt lgkmcnt(6)
v_mfma_f32_16x16x32_bf16 v[72:75], v[160:163], a[32:35], v[72:75]
ds_read_b64_tr_b16 v[156:157], v16 offset:18432
v_mfma_f32_16x16x32_bf16 v[84:87], v[160:163], a[36:39], v[84:87]
ds_read_b64_tr_b16 v[158:159], v16 offset:19200
v_mfma_f32_16x16x32_bf16 v[96:99], v[160:163], v[140:143], v[96:99]
s_waitcnt lgkmcnt(6)
v_mfma_f32_16x16x32_bf16 v[64:67], v[144:147], a[40:43], v[64:67]
ds_read_b64_tr_b16 v[160:161], v16 offset:18472
v_mfma_f32_16x16x32_bf16 v[76:79], v[144:147], a[44:47], v[76:79]
ds_read_b64_tr_b16 v[162:163], v16 offset:19240
v_mfma_f32_16x16x32_bf16 v[88:91], v[144:147], v[140:143], v[88:91]
s_waitcnt vmcnt(0)
s_barrier
s_cmp_lg_u32 s40, 0
s_nop 4
s_cbranch_scc1 L_nw8
s_lshl_b32 s50, s44, 8
v_mov_b32 v60, 0
v_mov_b32 v61, 1
s_mov_b64 exec, 1
buffer_atomic_add v61, v60, s[32:35], s50 offen sc1
s_mov_b64 exec, -1
s_mov_b32 s51, 400000
L_pl9:
v_cmp_eq_u32 s[84:85], s3, v33
v_cmp_eq_u32 s[86:87], 0, v33
s_cmp_eq_u32 s84, -1
s_nop 3
s_cbranch_scc1 L_pl12
s_or_b32 s52, s84, s86
s_cmp_lg_u32 s52, -1
s_cbranch_scc1 L_pl11
buffer_load_ubyte v33, v47, s[36:39], 0 offen sc1
s_waitcnt vmcnt(0)
s_sub_u32 s51, s51, 1
s_cmp_lg_u32 s51, 0
s_cbranch_scc1 L_pl9
L_pl11:
s_mov_b32 s84, 0
L_pl12:
L_nw8:
s_waitcnt lgkmcnt(6)
v_mfma_f32_16x16x32_bf16 v[68:71], v[148:151], a[40:43], v[68:71]
ds_read_b64_tr_b16 v[144:145], v17 offset:18432
s_add_u32 m0, s61, 0
v_mfma_f32_16x16x32_bf16 v[80:83], v[148:151], a[44:47], v[80:83]
ds_read_b64_tr_b16 v[146:147], v17 offset:19200
s_mov_b32 s50, 0
v_mfma_f32_16x16x32_bf16 v[92:95], v[148:151], v[140:143], v[92:95]
buffer_load_dwordx4 v23, s[12:15], s50 offen lds
s_waitcnt lgkmcnt(6)
v_mfma_f32_16x16x32_bf16 v[72:75], v[152:155], a[40:43], v[72:75]
ds_read_b64_tr_b16 v[148:149], v16 offset:21504
s_add_u32 m0, s61, 4096
v_mfma_f32_16x16x32_bf16 v[84:87], v[152:155], a[44:47], v[84:87]
ds_read_b64_tr_b16 v[150:151], v16 offset:22272
s_mov_b32 s50, 51200
v_mfma_f32_16x16x32_bf16 v[96:99], v[152:155], v[140:143], v[96:99]
buffer_load_dwordx4 v23, s[12:15], s50 offen lds
s_waitcnt lgkmcnt(6)
v_mfma_f32_16x16x32_bf16 v[64:67], v[156:159], a[48:51], v[64:67]
ds_read_b64_tr_b16 v[152:153], v16 offset:21544
s_add_u32 m0, s61, 8192
v_mfma_f32_16x16x32_bf16 v[76:79], v[156:159], a[52:55], v[76:79]
ds_read_b64_tr_b16 v[154:155], v16 offset:22312
s_mov_b32 s50, 102400
v_mfma_f32_16x16x32_bf16 v[88:91], v[156:159], v[140:143], v[88:91]
buffer_load_dwordx4 v23, s[12:15], s50 offen lds
s_waitcnt lgkmcnt(6)
v_mfma_f32_16x16x32_bf16 v[68:71], v[160:163], a[48:51], v[68:71]
ds_read_b64_tr_b16 v[156:157], v17 offset:21504
s_add_u32 m0, s61, 12288
v_mfma_f32_16x16x32_bf16 v[80:83], v[160:163], a[52:55], v[80:83]
ds_read_b64_tr_b16 v[158:159], v17 offset:22272
s_mov_b32 s50, 153600
v_mfma_f32_16x16x32_bf16 v[92:95], v[160:163], v[140:143], v[92:95]
buffer_load_dwordx4 v23, s[12:15], s50 offen lds
s_waitcnt lgkmcnt(6)
v_mfma_f32_16x16x32_bf16 v[72:75], v[144:147], a[48:51], v[72:75]
ds_read_b64_tr_b16 v[160:161], v16 offset:24576
s_add_u32 m0, s61, 16384
v_mfma_f32_16x16x32_bf16 v[84:87], v[144:147], a[52:55], v[84:87]
ds_read_b64_tr_b16 v[162:163], v16 offset:25344
s_mov_b32 s50, 204800
v_mfma_f32_16x16x32_bf16 v[96:99], v[144:147], v[140:143], v[96:99]
buffer_load_dwordx4 v23, s[12:15], s50 offen lds
s_waitcnt lgkmcnt(6)
v_mfma_f32_16x16x32_bf16 v[64:67], v[148:151], a[56:59], v[64:67]
ds_read_b64_tr_b16 v[144:145], v16 offset:24616
s_add_u32 m0, s61, 20480
v_mfma_f32_16x16x32_bf16 v[76:79], v[148:151], a[60:63], v[76:79]
ds_read_b64_tr_b16 v[146:147], v16 offset:25384
s_mov_b32 s50, 256000
v_mfma_f32_16x16x32_bf16 v[88:91], v[148:151], v[140:143], v[88:91]
buffer_load_dwordx4 v23, s[12:15], s50 offen lds
s_waitcnt lgkmcnt(6)
v_mfma_f32_16x16x32_bf16 v[68:71], v[152:155], a[56:59], v[68:71]
ds_read_b64_tr_b16 v[148:149], v17 offset:24576
s_add_u32 m0, s61, 24576
v_mfma_f32_16x16x32_bf16 v[80:83], v[152:155], a[60:63], v[80:83]
ds_read_b64_tr_b16 v[150:151], v17 offset:25344
s_mov_b32 s50, 307200
v_mfma_f32_16x16x32_bf16 v[92:95], v[152:155], v[140:143], v[92:95]
buffer_load_dwordx4 v23, s[12:15], s50 offen lds
s_waitcnt lgkmcnt(6)
v_mfma_f32_16x16x32_bf16 v[72:75], v[156:159], a[56:59], v[72:75]
ds_read_b64_tr_b16 v[152:153], v16 offset:27648
s_add_u32 m0, s61, 28672
v_mfma_f32_16x16x32_bf16 v[84:87], v[156:159], a[60:63], v[84:87]
ds_read_b64_tr_b16 v[154:155], v16 offset:28416
s_mov_b32 s50, 358400
v_mfma_f32_16x16x32_bf16 v[96:99], v[156:159], v[140:143], v[96:99]
buffer_load_dwordx4 v23, s[12:15], s50 offen lds
s_waitcnt lgkmcnt(6)
v_mfma_f32_16x16x32_bf16 v[64:67], v[160:163], a[64:67], v[64:67]
ds_read_b64_tr_b16 v[156:157], v16 offset:27688
s_add_u32 m0, s61, 32768
v_mfma_f32_16x16x32_bf16 v[76:79], v[160:163], a[68:71], v[76:79]
ds_read_b64_tr_b16 v[158:159], v16 offset:28456
s_mov_b32 s50, 409600
v_mfma_f32_16x16x32_bf16 v[88:91], v[160:163], v[140:143], v[88:91]
buffer_load_dwordx4 v23, s[12:15], s50 offen lds
s_waitcnt lgkmcnt(6)
v_mfma_f32_16x16x32_bf16 v[68:71], v[144:147], a[64:67], v[68:71]
ds_read_b64_tr_b16 v[160:161], v17 offset:27648
s_add_u32 m0, s61, 36864
v_mfma_f32_16x16x32_bf16 v[80:83], v[144:147], a[68:71], v[80:83]
ds_read_b64_tr_b16 v[162:163], v17 offset:28416
s_mov_b32 s50, 460800
v_mfma_f32_16x16x32_bf16 v[92:95], v[144:147], v[140:143], v[92:95]
buffer_load_dwordx4 v23, s[12:15], s50 offen lds
s_waitcnt lgkmcnt(6)
v_mfma_f32_16x16x32_bf16 v[72:75], v[148:151], a[64:67], v[72:75]
ds_read_b64_tr_b16 v[144:145], v16 offset:30720
s_add_u32 m0, s61, 40960
v_mfma_f32_16x16x32_bf16 v[84:87], v[148:151], a[68:71], v[84:87]
ds_read_b64_tr_b16 v[146:147], v16 offset:31488
s_mov_b32 s50, 512000
v_mfma_f32_16x16x32_bf16 v[96:99], v[148:151], v[140:143], v[96:99]
buffer_load_dwordx4 v23, s[12:15], s50 offen lds
s_waitcnt lgkmcnt(6)
v_mfma_f32_16x16x32_bf16 v[64:67], v[152:155], a[72:75], v[64:67]
ds_read_b64_tr_b16 v[148:149], v16 offset:30760
s_add_u32 m0, s61, 45056
v_mfma_f32_16x16x32_bf16 v[76:79], v[152:155], a[76:79], v[76:79]
ds_read_b64_tr_b16 v[150:151], v16 offset:31528
s_mov_b32 s50, 563200
v_mfma_f32_16x16x32_bf16 v[88:91], v[152:155], v[140:143], v[88:91]
buffer_load_dwordx4 v23, s[12:15], s50 offen lds
s_waitcnt lgkmcnt(6)
v_mfma_f32_16x16x32_bf16 v[68:71], v[156:159], a[72:75], v[68:71]
ds_read_b64_tr_b16 v[152:153], v17 offset:30720
s_add_u32 m0, s61, 49152
v_mfma_f32_16x16x32_bf16 v[80:83], v[156:159], a[76:79], v[80:83]
ds_read_b64_tr_b16 v[154:155], v17 offset:31488
s_mov_b32 s50, 614400
v_mfma_f32_16x16x32_bf16 v[92:95], v[156:159], v[140:143], v[92:95]
buffer_load_dwordx4 v23, s[12:15], s50 offen lds
s_waitcnt lgkmcnt(6)
v_mfma_f32_16x16x32_bf16 v[72:75], v[160:163], a[72:75], v[72:75]
ds_read_b64_tr_b16 v[156:157], v16 offset:33792
s_add_u32 m0, s61, 53248
v_mfma_f32_16x16x32_bf16 v[84:87], v[160:163], a[76:79], v[84:87]
ds_read_b64_tr_b16 v[158:159], v16 offset:34560
s_mov_b32 s50, 665600
v_mfma_f32_16x16x32_bf16 v[96:99], v[160:163], v[140:143], v[96:99]
buffer_load_dwordx4 v23, s[12:15], s50 offen lds
s_waitcnt lgkmcnt(6)
v_mfma_f32_16x16x32_bf16 v[64:67], v[144:147], a[80:83], v[64:67]
ds_read_b64_tr_b16 v[160:161], v16 offset:33832
s_add_u32 m0, s61, 57344
v_mfma_f32_16x16x32_bf16 v[76:79], v[144:147], a[84:87], v[76:79]
ds_read_b64_tr_b16 v[162:163], v16 offset:34600
s_mov_b32 s50, 716800
v_mfma_f32_16x16x32_bf16 v[88:91], v[144:147], v[140:143], v[88:91]
buffer_load_dwordx4 v23, s[12:15], s50 offen lds
s_waitcnt lgkmcnt(6)
v_mfma_f32_16x16x32_bf16 v[68:71], v[148:151], a[80:83], v[68:71]
ds_read_b64_tr_b16 v[144:145], v17 offset:33792
s_add_u32 m0, s61, 61440
v_mfma_f32_16x16x32_bf16 v[80:83], v[148:151], a[84:87], v[80:83]
ds_read_b64_tr_b16 v[146:147], v17 offset:34560
s_mov_b32 s50, 768000
v_mfma_f32_16x16x32_bf16 v[92:95], v[148:151], v[140:143], v[92:95]
buffer_load_dwordx4 v23, s[12:15], s50 offen lds
s_waitcnt lgkmcnt(6)
v_mfma_f32_16x16x32_bf16 v[72:75], v[152:155], a[80:83], v[72:75]
ds_read_b64_tr_b16 v[148:149], v16 offset:36864
s_add_u32 m0, s61, 65536
v_mfma_f32_16x16x32_bf16 v[84:87], v[152:155], a[84:87], v[84:87]
ds_read_b64_tr_b16 v[150:151], v16 offset:37632
s_mov_b32 s50, 0
v_mfma_f32_16x16x32_bf16 v[96:99], v[152:155], v[140:143], v[96:99]
buffer_load_dwordx4 v24, s[12:15], s50 offen lds
s_waitcnt lgkmcnt(6)
v_mfma_f32_16x16x32_bf16 v[64:67], v[156:159], a[88:91], v[64:67]
ds_read_b64_tr_b16 v[152:153], v16 offset:36904
s_add_u32 m0, s61, 69632
v_mfma_f32_16x16x32_bf16 v[76:79], v[156:159], a[92:95], v[76:79]
ds_read_b64_tr_b16 v[154:155], v16 offset:37672
s_mov_b32 s50, 204800
v_mfma_f32_16x16x32_bf16 v[88:91], v[156:159], v[140:143], v[88:91]
buffer_load_dwordx4 v24, s[12:15], s50 offen lds
s_waitcnt lgkmcnt(6)
v_mfma_f32_16x16x32_bf16 v[68:71], v[160:163], a[88:91], v[68:71]
ds_read_b64_tr_b16 v[156:157], v17 offset:36864
s_add_u32 m0, s61, 73728
v_mfma_f32_16x16x32_bf16 v[80:83], v[160:163], a[92:95], v[80:83]
ds_read_b64_tr_b16 v[158:159], v17 offset:37632
s_mov_b32 s50, 409600
v_mfma_f32_16x16x32_bf16 v[92:95], v[160:163], v[140:143], v[92:95]
buffer_load_dwordx4 v24, s[12:15], s50 offen lds
s_waitcnt lgkmcnt(6)
v_mfma_f32_16x16x32_bf16 v[72:75], v[144:147], a[88:91], v[72:75]
ds_read_b64_tr_b16 v[160:161], v16 offset:39936
s_add_u32 m0, s61, 77824
v_mfma_f32_16x16x32_bf16 v[84:87], v[144:147], a[92:95], v[84:87]
ds_read_b64_tr_b16 v[162:163], v16 offset:40704
s_mov_b32 s50, 614400
v_mfma_f32_16x16x32_bf16 v[96:99], v[144:147], v[140:143], v[96:99]
buffer_load_dwordx4 v24, s[12:15], s50 offen lds
s_waitcnt lgkmcnt(6)
v_mfma_f32_16x16x32_bf16 v[64:67], v[148:151], a[96:99], v[64:67]
ds_read_b64_tr_b16 v[144:145], v16 offset:39976
s_add_u32 s50, s60, 0
v_mfma_f32_16x16x32_bf16 v[76:79], v[148:151], a[100:103], v[76:79]
ds_read_b64_tr_b16 v[146:147], v16 offset:40744
v_mfma_f32_16x16x32_bf16 v[88:91], v[148:151], v[140:143], v[88:91]
buffer_load_dwordx4 v[34:37], v46, s[4:7], s50 offen
s_waitcnt lgkmcnt(6)
v_mfma_f32_16x16x32_bf16 v[68:71], v[152:155], a[96:99], v[68:71]
ds_read_b64_tr_b16 v[148:149], v17 offset:39936
s_lshl_b32 s50, s44, 8
v_mfma_f32_16x16x32_bf16 v[80:83], v[152:155], a[100:103], v[80:83]
ds_read_b64_tr_b16 v[150:151], v17 offset:40704
v_mov_b32 v60, 0
v_mfma_f32_16x16x32_bf16 v[92:95], v[152:155], v[140:143], v[92:95]
buffer_load_dword v61, v60, s[32:35], s50 offen sc1
s_waitcnt lgkmcnt(6)
v_mfma_f32_16x16x32_bf16 v[72:75], v[156:159], a[96:99], v[72:75]
ds_read_b64_tr_b16 v[152:153], v16 offset:43008
s_add_u32 s50, s60, 20480
v_mfma_f32_16x16x32_bf16 v[84:87], v[156:159], a[100:103], v[84:87]
ds_read_b64_tr_b16 v[154:155], v16 offset:43776
v_mfma_f32_16x16x32_bf16 v[96:99], v[156:159], v[140:143], v[96:99]
buffer_load_dwordx4 v[38:41], v46, s[4:7], s50 offen
s_waitcnt lgkmcnt(6)
v_mfma_f32_16x16x32_bf16 v[64:67], v[160:163], a[104:107], v[64:67]
ds_read_b64_tr_b16 v[156:157], v16 offset:43048
s_add_u32 s50, s60, 40960
v_mfma_f32_16x16x32_bf16 v[76:79], v[160:163], a[108:111], v[76:79]
ds_read_b64_tr_b16 v[158:159], v16 offset:43816
v_mfma_f32_16x16x32_bf16 v[88:91], v[160:163], v[140:143], v[88:91]
buffer_load_dwordx4 v[42:45], v46, s[4:7], s50 offen
s_waitcnt lgkmcnt(6)
v_mfma_f32_16x16x32_bf16 v[68:71], v[144:147], a[104:107], v[68:71]
ds_read_b64_tr_b16 v[160:161], v17 offset:43008
v_mfma_f32_16x16x32_bf16 v[80:83], v[144:147], a[108:111], v[80:83]
ds_read_b64_tr_b16 v[162:163], v17 offset:43776
v_mfma_f32_16x16x32_bf16 v[92:95], v[144:147], v[140:143], v[92:95]
s_waitcnt lgkmcnt(6)
v_mfma_f32_16x16x32_bf16 v[72:75], v[148:151], a[104:107], v[72:75]
ds_read_b64_tr_b16 v[144:145], v16 offset:46080
v_mfma_f32_16x16x32_bf16 v[84:87], v[148:151], a[108:111], v[84:87]
ds_read_b64_tr_b16 v[146:147], v16 offset:46848
v_mfma_f32_16x16x32_bf16 v[96:99], v[148:151], v[140:143], v[96:99]
s_waitcnt lgkmcnt(6)
v_mfma_f32_16x16x32_bf16 v[64:67], v[152:155], a[112:115], v[64:67]
ds_read_b64_tr_b16 v[148:149], v16 offset:46120
v_mfma_f32_16x16x32_bf16 v[76:79], v[152:155], a[116:119], v[76:79]
ds_read_b64_tr_b16 v[150:151], v16 offset:46888
v_mfma_f32_16x16x32_bf16 v[88:91], v[152:155], v[140:143], v[88:91]
s_waitcnt lgkmcnt(6)
v_mfma_f32_16x16x32_bf16 v[68:71], v[156:159], a[112:115], v[68:71]
ds_read_b64_tr_b16 v[152:153], v17 offset:46080
v_mfma_f32_16x16x32_bf16 v[80:83], v[156:159], a[116:119], v[80:83]
ds_read_b64_tr_b16 v[154:155], v17 offset:46848
v_mfma_f32_16x16x32_bf16 v[92:95], v[156:159], v[140:143], v[92:95]
s_waitcnt lgkmcnt(6)
v_mfma_f32_16x16x32_bf16 v[72:75], v[160:163], a[112:115], v[72:75]
ds_read_b64_tr_b16 v[156:157], v16 offset:49152
v_mfma_f32_16x16x32_bf16 v[84:87], v[160:163], a[116:119], v[84:87]
ds_read_b64_tr_b16 v[158:159], v16 offset:49920
v_mfma_f32_16x16x32_bf16 v[96:99], v[160:163], v[140:143], v[96:99]
s_waitcnt lgkmcnt(6)
v_mfma_f32_16x16x32_bf16 v[64:67], v[144:147], a[120:123], v[64:67]
ds_read_b64_tr_b16 v[160:161], v16 offset:49192
v_mfma_f32_16x16x32_bf16 v[76:79], v[144:147], a[124:127], v[76:79]
ds_read_b64_tr_b16 v[162:163], v16 offset:49960
v_mfma_f32_16x16x32_bf16 v[88:91], v[144:147], v[140:143], v[88:91]
s_waitcnt lgkmcnt(6)
v_mfma_f32_16x16x32_bf16 v[68:71], v[148:151], a[120:123], v[68:71]
ds_read_b64_tr_b16 v[144:145], v17 offset:49152
v_mfma_f32_16x16x32_bf16 v[80:83], v[148:151], a[124:127], v[80:83]
ds_read_b64_tr_b16 v[146:147], v17 offset:49920
v_mfma_f32_16x16x32_bf16 v[92:95], v[148:151], v[140:143], v[92:95]
s_waitcnt lgkmcnt(6)
v_mfma_f32_16x16x32_bf16 v[72:75], v[152:155], a[120:123], v[72:75]
ds_read_b64_tr_b16 v[148:149], v16 offset:52224
v_mfma_f32_16x16x32_bf16 v[84:87], v[152:155], a[124:127], v[84:87]
ds_read_b64_tr_b16 v[150:151], v16 offset:52992
v_mfma_f32_16x16x32_bf16 v[96:99], v[152:155], v[140:143], v[96:99]
s_waitcnt lgkmcnt(6)
v_mfma_f32_16x16x32_bf16 v[64:67], v[156:159], a[128:131], v[64:67]
ds_read_b64_tr_b16 v[152:153], v16 offset:52264
v_mfma_f32_16x16x32_bf16 v[76:79], v[156:159], a[132:135], v[76:79]
ds_read_b64_tr_b16 v[154:155], v16 offset:53032
v_mfma_f32_16x16x32_bf16 v[88:91], v[156:159], v[140:143], v[88:91]
s_waitcnt lgkmcnt(6)
v_mfma_f32_16x16x32_bf16 v[68:71], v[160:163], a[128:131], v[68:71]
ds_read_b64_tr_b16 v[156:157], v17 offset:52224
v_mfma_f32_16x16x32_bf16 v[80:83], v[160:163], a[132:135], v[80:83]
ds_read_b64_tr_b16 v[158:159], v17 offset:52992
v_mfma_f32_16x16x32_bf16 v[92:95], v[160:163], v[140:143], v[92:95]
s_waitcnt lgkmcnt(6)
v_mfma_f32_16x16x32_bf16 v[72:75], v[144:147], a[128:131], v[72:75]
ds_read_b64_tr_b16 v[160:161], v16 offset:55296
v_mfma_f32_16x16x32_bf16 v[84:87], v[144:147], a[132:135], v[84:87]
ds_read_b64_tr_b16 v[162:163], v16 offset:56064
v_mfma_f32_16x16x32_bf16 v[96:99], v[144:147], v[140:143], v[96:99]
s_waitcnt lgkmcnt(6)
v_mfma_f32_16x16x32_bf16 v[64:67], v[148:151], a[136:139], v[64:67]
ds_read_b64_tr_b16 v[144:145], v16 offset:55336
v_mfma_f32_16x16x32_bf16 v[76:79], v[148:151], a[140:143], v[76:79]
ds_read_b64_tr_b16 v[146:147], v16 offset:56104
v_mfma_f32_16x16x32_bf16 v[88:91], v[148:151], v[140:143], v[88:91]
s_waitcnt lgkmcnt(6)
v_mfma_f32_16x16x32_bf16 v[68:71], v[152:155], a[136:139], v[68:71]
ds_read_b64_tr_b16 v[148:149], v17 offset:55296
v_mfma_f32_16x16x32_bf16 v[80:83], v[152:155], a[140:143], v[80:83]
ds_read_b64_tr_b16 v[150:151], v17 offset:56064
v_mfma_f32_16x16x32_bf16 v[92:95], v[152:155], v[140:143], v[92:95]
s_waitcnt lgkmcnt(6)
v_mfma_f32_16x16x32_bf16 v[72:75], v[156:159], a[136:139], v[72:75]
ds_read_b64_tr_b16 v[152:153], v16 offset:58368
v_mfma_f32_16x16x32_bf16 v[84:87], v[156:159], a[140:143], v[84:87]
ds_read_b64_tr_b16 v[154:155], v16 offset:59136
v_mfma_f32_16x16x32_bf16 v[96:99], v[156:159], v[140:143], v[96:99]
s_waitcnt vmcnt(2)
v_readfirstlane_b32 s89, v61
s_nop 0
s_cmp_lt_u32 s89, 16
s_nop 3
s_cbranch_scc1 L_ne13
s_lshl_b32 s50, s44, 16
s_add_u32 s50, s50, 65536
buffer_load_dwordx4 v[168:171], v32, s[32:35], s50 offen sc1
s_add_u32 s50, s50, 4096
buffer_load_dwordx4 v[172:175], v32, s[32:35], s50 offen sc1
s_add_u32 s50, s50, 4096
buffer_load_dwordx4 v[176:179], v32, s[32:35], s50 offen sc1
s_add_u32 s50, s50, 4096
buffer_load_dwordx4 v[180:183], v32, s[32:35], s50 offen sc1
s_add_u32 s50, s50, 4096
buffer_load_dwordx4 v[184:187], v32, s[32:35], s50 offen sc1
s_add_u32 s50, s50, 4096
buffer_load_dwordx4 v[188:191], v32, s[32:35], s50 offen sc1
s_add_u32 s50, s50, 4096
buffer_load_dwordx4 v[192:195], v32, s[32:35], s50 offen sc1
s_add_u32 s50, s50, 4096
buffer_load_dwordx4 v[196:199], v32, s[32:35], s50 offen sc1
s_add_u32 s50, s50, 4096
buffer_load_dwordx4 v[200:203], v32, s[32:35], s50 offen sc1
s_add_u32 s50, s50, 4096
buffer_load_dwordx4 v[204:207], v32, s[32:35], s50 offen sc1
s_add_u32 s50, s50, 4096
buffer_load_dwordx4 v[208:211], v32, s[32:35], s50 offen sc1
s_add_u32 s50, s50, 4096
buffer_load_dwordx4 v[212:215], v32, s[32:35], s50 offen sc1
s_add_u32 s50, s50, 4096
buffer_load_dwordx4 v[216:219], v32, s[32:35], s50 offen sc1
s_add_u32 s50, s50, 4096
buffer_load_dwordx4 v[220:223], v32, s[32:35], s50 offen sc1
s_add_u32 s50, s50, 4096
buffer_load_dwordx4 v[224:227], v32, s[32:35], s50 offen sc1
s_add_u32 s50, s50, 4096
buffer_load_dwordx4 v[228:231], v32, s[32:35], s50 offen sc1
L_ne13:
s_waitcnt lgkmcnt(6)
v_mfma_f32_16x16x32_bf16 v[64:67], v[160:163], a[144:147], v[64:67]
ds_read_b64_tr_b16 v[156:157], v16 offset:58408
v_mfma_f32_16x16x32_bf16 v[76:79], v[160:163], a[148:151], v[76:79]
ds_read_b64_tr_b16 v[158:159], v16 offset:59176
v_mfma_f32_16x16x32_bf16 v[88:91], v[160:163], v[140:143], v[88:91]
s_waitcnt lgkmcnt(6)
v_mfma_f32_16x16x32_bf16 v[68:71], v[144:147], a[144:147], v[68:71]
ds_read_b64_tr_b16 v[160:161], v17 offset:58368
v_mfma_f32_16x16x32_bf16 v[80:83], v[144:147], a[148:151], v[80:83]
ds_read_b64_tr_b16 v[162:163], v17 offset:59136
v_mfma_f32_16x16x32_bf16 v[92:95], v[144:147], v[140:143], v[92:95]
s_waitcnt lgkmcnt(6)
v_mfma_f32_16x16x32_bf16 v[72:75], v[148:151], a[144:147], v[72:75]
v_mfma_f32_16x16x32_bf16 v[84:87], v[148:151], a[148:151], v[84:87]
v_mfma_f32_16x16x32_bf16 v[96:99], v[148:151], v[140:143], v[96:99]
s_waitcnt lgkmcnt(4)
v_mfma_f32_16x16x32_bf16 v[64:67], v[152:155], a[152:155], v[64:67]
v_mfma_f32_16x16x32_bf16 v[76:79], v[152:155], a[156:159], v[76:79]
v_mfma_f32_16x16x32_bf16 v[88:91], v[152:155], v[140:143], v[88:91]
s_waitcnt lgkmcnt(2)
v_mfma_f32_16x16x32_bf16 v[68:71], v[156:159], a[152:155], v[68:71]
v_mfma_f32_16x16x32_bf16 v[80:83], v[156:159], a[156:159], v[80:83]
v_mfma_f32_16x16x32_bf16 v[92:95], v[156:159], v[140:143], v[92:95]
s_waitcnt lgkmcnt(0)
v_mfma_f32_16x16x32_bf16 v[72:75], v[160:163], a[152:155], v[72:75]
v_mfma_f32_16x16x32_bf16 v[84:87], v[160:163], a[156:159], v[84:87]
v_mfma_f32_16x16x32_bf16 v[96:99], v[160:163], v[140:143], v[96:99]
v_pk_fma_f32 v[64:65], v[28:29], v[88:89], v[64:65] op_sel_hi:[0,1,1] neg_lo:[1,0,0] neg_hi:[1,0,0]
v_pk_fma_f32 v[66:67], v[28:29], v[90:91], v[66:67] op_sel_hi:[0,1,1] neg_lo:[1,0,0] neg_hi:[1,0,0]
s_nop 1
v_pk_fma_f32 v[68:69], v[28:29], v[92:93], v[68:69] op_sel_hi:[0,1,1] neg_lo:[1,0,0] neg_hi:[1,0,0]
v_pk_fma_f32 v[70:71], v[28:29], v[94:95], v[70:71] op_sel_hi:[0,1,1] neg_lo:[1,0,0] neg_hi:[1,0,0]
s_nop 1
v_pk_fma_f32 v[72:73], v[28:29], v[96:97], v[72:73] op_sel_hi:[0,1,1] neg_lo:[1,0,0] neg_hi:[1,0,0]
v_pk_fma_f32 v[74:75], v[28:29], v[98:99], v[74:75] op_sel_hi:[0,1,1] neg_lo:[1,0,0] neg_hi:[1,0,0]
v_pk_fma_f32 v[76:77], v[52:53], v[88:89], v[76:77] op_sel_hi:[0,1,1] neg_lo:[1,0,0] neg_hi:[1,0,0]
v_pk_fma_f32 v[78:79], v[52:53], v[90:91], v[78:79] op_sel_hi:[0,1,1] neg_lo:[1,0,0] neg_hi:[1,0,0]
v_pk_fma_f32 v[80:81], v[52:53], v[92:93], v[80:81] op_sel_hi:[0,1,1] neg_lo:[1,0,0] neg_hi:[1,0,0]
v_pk_fma_f32 v[82:83], v[52:53], v[94:95], v[82:83] op_sel_hi:[0,1,1] neg_lo:[1,0,0] neg_hi:[1,0,0]
v_pk_fma_f32 v[84:85], v[52:53], v[96:97], v[84:85] op_sel_hi:[0,1,1] neg_lo:[1,0,0] neg_hi:[1,0,0]
v_pk_fma_f32 v[86:87], v[52:53], v[98:99], v[86:87] op_sel_hi:[0,1,1] neg_lo:[1,0,0] neg_hi:[1,0,0]
v_pk_mul_f32 v[64:65], v[30:31], v[64:65] op_sel_hi:[0,1]
v_pk_mul_f32 v[66:67], v[30:31], v[66:67] op_sel_hi:[0,1]
v_pk_mul_f32 v[68:69], v[30:31], v[68:69] op_sel_hi:[0,1]
v_pk_mul_f32 v[70:71], v[30:31], v[70:71] op_sel_hi:[0,1]
v_pk_mul_f32 v[72:73], v[30:31], v[72:73] op_sel_hi:[0,1]
v_pk_mul_f32 v[74:75], v[30:31], v[74:75] op_sel_hi:[0,1]
v_pk_mul_f32 v[76:77], v[54:55], v[76:77] op_sel_hi:[0,1]
v_pk_mul_f32 v[78:79], v[54:55], v[78:79] op_sel_hi:[0,1]
v_pk_mul_f32 v[80:81], v[54:55], v[80:81] op_sel_hi:[0,1]
v_pk_mul_f32 v[82:83], v[54:55], v[82:83] op_sel_hi:[0,1]
v_pk_mul_f32 v[84:85], v[54:55], v[84:85] op_sel_hi:[0,1]
v_pk_mul_f32 v[86:87], v[54:55], v[86:87] op_sel_hi:[0,1]
v_pk_mul_f32 v[120:121], v[64:65], s[96:97]
v_pk_mul_f32 v[122:123], v[66:67], s[96:97]
v_pk_mul_f32 v[124:125], v[68:69], s[96:97]
v_pk_mul_f32 v[126:127], v[70:71], s[96:97]
v_pk_mul_f32 v[128:129], v[72:73], s[96:97]
v_pk_mul_f32 v[130:131], v[74:75], s[96:97]
v_pk_mul_f32 v[132:133], v[76:77], s[96:97]
v_pk_mul_f32 v[134:135], v[78:79], s[96:97]
v_pk_mul_f32 v[136:137], v[80:81], s[96:97]
v_pk_mul_f32 v[138:139], v[82:83], s[96:97]
v_pk_mul_f32 v[140:141], v[84:85], s[96:97]
v_pk_mul_f32 v[142:143], v[86:87], s[96:97]
v_exp_f32_e64 v120, v120 clamp
v_exp_f32_e64 v121, v121 clamp
v_exp_f32_e64 v122, v122 clamp
v_exp_f32_e64 v123, v123 clamp
v_exp_f32_e64 v124, v124 clamp
v_exp_f32_e64 v125, v125 clamp
v_exp_f32_e64 v126, v126 clamp
v_exp_f32_e64 v127, v127 clamp
v_exp_f32_e64 v128, v128 clamp
v_exp_f32_e64 v129, v129 clamp
v_exp_f32_e64 v130, v130 clamp
v_exp_f32_e64 v131, v131 clamp
v_exp_f32_e64 v132, v132 clamp
v_exp_f32_e64 v133, v133 clamp
v_exp_f32_e64 v134, v134 clamp
v_exp_f32_e64 v135, v135 clamp
v_exp_f32_e64 v136, v136 clamp
v_exp_f32_e64 v137, v137 clamp
v_exp_f32_e64 v138, v138 clamp
v_exp_f32_e64 v139, v139 clamp
v_exp_f32_e64 v140, v140 clamp
v_exp_f32_e64 v141, v141 clamp
v_exp_f32_e64 v142, v142 clamp
v_exp_f32_e64 v143, v143 clamp
v_pk_add_f32 v[144:145], v[64:65], s[98:99]
v_pk_add_f32 v[146:147], v[66:67], s[98:99]
v_pk_add_f32 v[148:149], v[68:69], s[98:99]
v_pk_add_f32 v[150:151], v[70:71], s[98:99]
v_pk_add_f32 v[152:153], v[72:73], s[98:99]
v_pk_add_f32 v[154:155], v[74:75], s[98:99]
v_pk_add_f32 v[156:157], v[76:77], s[98:99]
v_pk_add_f32 v[158:159], v[78:79], s[98:99]
v_pk_add_f32 v[160:161], v[80:81], s[98:99]
v_pk_add_f32 v[162:163], v[82:83], s[98:99]
v_pk_add_f32 v[164:165], v[84:85], s[98:99]
v_pk_add_f32 v[166:167], v[86:87], s[98:99]
v_max_f32 v144, s98, v144
v_max_f32 v145, s98, v145
v_max_f32 v146, s98, v146
v_max_f32 v147, s98, v147
v_max_f32 v148, s98, v148
v_max_f32 v149, s98, v149
v_max_f32 v150, s98, v150
v_max_f32 v151, s98, v151
v_max_f32 v152, s98, v152
v_max_f32 v153, s98, v153
v_max_f32 v154, s98, v154
v_max_f32 v155, s98, v155
v_max_f32 v156, s98, v156
v_max_f32 v157, s98, v157
v_max_f32 v158, s98, v158
v_max_f32 v159, s98, v159
v_max_f32 v160, s98, v160
v_max_f32 v161, s98, v161
v_max_f32 v162, s98, v162
v_max_f32 v163, s98, v163
v_max_f32 v164, s98, v164
v_max_f32 v165, s98, v165
v_max_f32 v166, s98, v166
v_max_f32 v167, s98, v167
v_pk_add_f32 v[64:65], v[120:121], v[144:145]
v_pk_add_f32 v[66:67], v[122:123], v[146:147]
v_pk_add_f32 v[68:69], v[124:125], v[148:149]
v_pk_add_f32 v[70:71], v[126:127], v[150:151]
v_pk_add_f32 v[72:73], v[128:129], v[152:153]
v_pk_add_f32 v[74:75], v[130:131], v[154:155]
v_pk_add_f32 v[76:77], v[132:133], v[156:157]
v_pk_add_f32 v[78:79], v[134:135], v[158:159]
v_pk_add_f32 v[80:81], v[136:137], v[160:161]
v_pk_add_f32 v[82:83], v[138:139], v[162:163]
v_pk_add_f32 v[84:85], v[140:141], v[164:165]
v_pk_add_f32 v[86:87], v[142:143], v[166:167]
v_cvt_pk_bf16_f32 v104, v64, v65
v_cvt_pk_bf16_f32 v105, v66, v67
v_cvt_pk_bf16_f32 v106, v68, v69
v_cvt_pk_bf16_f32 v107, v70, v71
v_cvt_pk_bf16_f32 v108, v72, v73
v_cvt_pk_bf16_f32 v109, v74, v75
v_mov_b32 v110, 0
v_mov_b32 v111, 0
v_cvt_pk_bf16_f32 v112, v76, v77
v_cvt_pk_bf16_f32 v113, v78, v79
v_cvt_pk_bf16_f32 v114, v80, v81
v_cvt_pk_bf16_f32 v115, v82, v83
v_cvt_pk_bf16_f32 v116, v84, v85
v_cvt_pk_bf16_f32 v117, v86, v87
v_mov_b32 v118, 0
v_mov_b32 v119, 0
s_lshl_b32 s52, s43, 3
s_lshl_b32 s53, s40, 1
s_add_u32 s52, s52, s53
s_mul_i32 s52, s52, 20480
s_add_u32 s52, s52, s101
s_lshl_b32 s53, s44, 10
s_add_u32 s55, s52, s53
s_lshr_b32 s53, s44, 2
s_lshl_b32 s53, s53, 10
s_add_u32 s56, s52, s53
s_and_b32 s53, s44, 3
s_lshl_b32 s53, s53, 8
s_add_u32 s56, s56, s53
s_add_u32 s56, s56, 16384
s_add_u32 s53, s55, 20480
s_add_u32 s54, s56, 20480
v_lshlrev_b32 v47, 4, v2
v_lshl_add_u32 v47, v3, 3, v47
v_add_u32 v58, 81920, v4
s_cmp_ge_u32 s89, 16
s_nop 0
s_cbranch_scc1 L_nl14
s_lshl_b32 s50, s44, 8
v_mov_b32 v60, 0
s_mov_b32 s51, 400000
L_poll15:
buffer_load_dword v61, v60, s[32:35], s50 offen sc1
s_waitcnt vmcnt(0)
v_readfirstlane_b32 s52, v61
s_nop 0
s_cmp_ge_u32 s52, 16
s_nop 2
s_cbranch_scc1 L_pd16
s_sub_u32 s51, s51, 1
s_cmp_lg_u32 s51, 0
s_cbranch_scc1 L_poll15
L_pd16:
s_lshl_b32 s50, s44, 16
s_add_u32 s50, s50, 65536
buffer_load_dwordx4 v[168:171], v32, s[32:35], s50 offen sc1
s_add_u32 s50, s50, 4096
buffer_load_dwordx4 v[172:175], v32, s[32:35], s50 offen sc1
s_add_u32 s50, s50, 4096
buffer_load_dwordx4 v[176:179], v32, s[32:35], s50 offen sc1
s_add_u32 s50, s50, 4096
buffer_load_dwordx4 v[180:183], v32, s[32:35], s50 offen sc1
s_add_u32 s50, s50, 4096
buffer_load_dwordx4 v[184:187], v32, s[32:35], s50 offen sc1
s_add_u32 s50, s50, 4096
buffer_load_dwordx4 v[188:191], v32, s[32:35], s50 offen sc1
s_add_u32 s50, s50, 4096
buffer_load_dwordx4 v[192:195], v32, s[32:35], s50 offen sc1
s_add_u32 s50, s50, 4096
buffer_load_dwordx4 v[196:199], v32, s[32:35], s50 offen sc1
s_add_u32 s50, s50, 4096
buffer_load_dwordx4 v[200:203], v32, s[32:35], s50 offen sc1
s_add_u32 s50, s50, 4096
buffer_load_dwordx4 v[204:207], v32, s[32:35], s50 offen sc1
s_add_u32 s50, s50, 4096
buffer_load_dwordx4 v[208:211], v32, s[32:35], s50 offen sc1
s_add_u32 s50, s50, 4096
buffer_load_dwordx4 v[212:215], v32, s[32:35], s50 offen sc1
s_add_u32 s50, s50, 4096
buffer_load_dwordx4 v[216:219], v32, s[32:35], s50 offen sc1
s_add_u32 s50, s50, 4096
buffer_load_dwordx4 v[220:223], v32, s[32:35], s50 offen sc1
s_add_u32 s50, s50, 4096
buffer_load_dwordx4 v[224:227], v32, s[32:35], s50 offen sc1
s_add_u32 s50, s50, 4096
buffer_load_dwordx4 v[228:231], v32, s[32:35], s50 offen sc1
L_nl14:
v_cmp_eq_u32 vcc, 0, v3
s_waitcnt vmcnt(0)
v_pk_add_f32 v[168:169], v[168:169], v[200:201]
v_pk_add_f32 v[170:171], v[170:171], v[202:203]
v_pk_add_f32 v[172:173], v[172:173], v[204:205]
v_pk_add_f32 v[174:175], v[174:175], v[206:207]
v_pk_add_f32 v[176:177], v[176:177], v[208:209]
v_pk_add_f32 v[178:179], v[178:179], v[210:211]
v_pk_add_f32 v[180:181], v[180:181], v[212:213]
v_pk_add_f32 v[182:183], v[182:183], v[214:215]
v_pk_add_f32 v[184:185], v[184:185], v[216:217]
v_pk_add_f32 v[186:187], v[186:187], v[218:219]
v_pk_add_f32 v[188:189], v[188:189], v[220:221]
v_pk_add_f32 v[190:191], v[190:191], v[222:223]
v_pk_add_f32 v[192:193], v[192:193], v[224:225]
v_pk_add_f32 v[194:195], v[194:195], v[226:227]
v_pk_add_f32 v[196:197], v[196:197], v[228:229]
v_pk_add_f32 v[198:199], v[198:199], v[230:231]
v_pk_add_f32 v[168:169], v[168:169], v[184:185]
v_pk_add_f32 v[170:171], v[170:171], v[186:187]
v_pk_add_f32 v[172:173], v[172:173], v[188:189]
v_pk_add_f32 v[174:175], v[174:175], v[190:191]
v_pk_add_f32 v[176:177], v[176:177], v[192:193]
v_pk_add_f32 v[178:179], v[178:179], v[194:195]
v_pk_add_f32 v[180:181], v[180:181], v[196:197]
v_pk_add_f32 v[182:183], v[182:183], v[198:199]
v_pk_add_f32 v[168:169], v[168:169], v[176:177]
v_pk_add_f32 v[170:171], v[170:171], v[178:179]
v_pk_add_f32 v[172:173], v[172:173], v[180:181]
v_pk_add_f32 v[174:175], v[174:175], v[182:183]
v_pk_add_f32 v[168:169], v[168:169], v[172:173]
v_pk_add_f32 v[170:171], v[170:171], v[174:175]
v_cvt_pk_bf16_f32 v172, v168, v169
v_cvt_pk_bf16_f32 v173, v170, v171
ds_write_b64 v27, v[172:173]
s_waitcnt lgkmcnt(0)
s_barrier
ds_read_b128 v[188:191], v58 offset:6144
ds_read_b128 v[192:195], v58 offset:7168
ds_read_b128 v[164:167], v58 offset:0
ds_read_b128 v[168:171], v58 offset:1024
ds_read_b128 v[172:175], v58 offset:2048
ds_read_b128 v[176:179], v58 offset:3072
ds_read_b128 v[180:183], v58 offset:4096
ds_read_b128 v[184:187], v58 offset:5120
s_add_u32 m0, s61, 106496
s_mov_b32 s50, 0
buffer_load_dwordx4 v22, s[16:19], s50 offen lds
s_add_u32 m0, s61, 110592
s_mov_b32 s50, 0
buffer_load_dwordx4 v22, s[20:23], s50 offen lds
s_add_u32 m0, s61, 114688
s_mov_b32 s50, 110592
buffer_load_dwordx4 v22, s[16:19], s50 offen lds
s_add_u32 m0, s61, 118784
s_mov_b32 s50, 110592
buffer_load_dwordx4 v22, s[20:23], s50 offen lds
s_waitcnt lgkmcnt(6)
v_mfma_f32_16x16x32_bf16 v[76:79], v[188:191], v[104:107], 0
v_mfma_f32_16x16x32_bf16 v[92:95], v[188:191], v[112:115], 0
v_mfma_f32_16x16x32_bf16 v[76:79], v[192:195], v[108:111], v[76:79]
v_mfma_f32_16x16x32_bf16 v[92:95], v[192:195], v[116:119], v[92:95]
s_waitcnt lgkmcnt(4)
v_mfma_f32_16x16x32_bf16 v[64:67], v[164:167], v[104:107], 0
v_mfma_f32_16x16x32_bf16 v[80:83], v[164:167], v[112:115], 0
v_mfma_f32_16x16x32_bf16 v[64:67], v[168:171], v[108:111], v[64:67]
v_mfma_f32_16x16x32_bf16 v[80:83], v[168:171], v[116:119], v[80:83]
s_waitcnt lgkmcnt(2)
v_mfma_f32_16x16x32_bf16 v[68:71], v[172:175], v[104:107], 0
v_mfma_f32_16x16x32_bf16 v[84:87], v[172:175], v[112:115], 0
v_mfma_f32_16x16x32_bf16 v[68:71], v[176:179], v[108:111], v[68:71]
v_mfma_f32_16x16x32_bf16 v[84:87], v[176:179], v[116:119], v[84:87]
s_waitcnt lgkmcnt(0)
v_mfma_f32_16x16x32_bf16 v[72:75], v[180:183], v[104:107], 0
v_mfma_f32_16x16x32_bf16 v[88:91], v[180:183], v[112:115], 0
v_mfma_f32_16x16x32_bf16 v[72:75], v[184:187], v[108:111], v[72:75]
v_mfma_f32_16x16x32_bf16 v[88:91], v[184:187], v[116:119], v[88:91]
v_pk_add_f32 v[76:77], v[76:77], s[98:99]
v_pk_add_f32 v[92:93], v[92:93], s[98:99]
v_rcp_f32 v76, v76
v_rcp_f32 v78, v77
v_rcp_f32 v92, v92
v_rcp_f32 v94, v93
v_cndmask_b32 v212, v78, v76, vcc
v_cndmask_b32 v214, v94, v92, vcc
v_pk_mul_f32 v[64:65], v[76:77], v[64:65] op_sel_hi:[0,1]
v_pk_mul_f32 v[66:67], v[76:77], v[66:67] op_sel_hi:[0,1]
v_pk_mul_f32 v[68:69], v[78:79], v[68:69] op_sel_hi:[0,1]
v_pk_mul_f32 v[70:71], v[78:79], v[70:71] op_sel_hi:[0,1]
v_pk_mul_f32 v[72:73], v[212:213], v[72:73] op_sel_hi:[0,1]
v_pk_mul_f32 v[74:75], v[212:213], v[74:75] op_sel_hi:[0,1]
v_cvt_pk_bf16_f32 v196, v64, v65
v_cvt_pk_bf16_f32 v197, v66, v67
v_cvt_pk_bf16_f32 v198, v68, v69
v_cvt_pk_bf16_f32 v199, v70, v71
v_cvt_pk_bf16_f32 v200, v72, v73
v_cvt_pk_bf16_f32 v201, v74, v75
buffer_store_dwordx4 v[196:199], v4, s[32:35], s55 offen sc1
s_mov_b32 exec_hi, 0
buffer_store_dwordx2 v[200:201], v47, s[32:35], s56 offen sc1
s_mov_b64 exec, -1
v_pk_mul_f32 v[80:81], v[92:93], v[80:81] op_sel_hi:[0,1]
v_pk_mul_f32 v[82:83], v[92:93], v[82:83] op_sel_hi:[0,1]
v_pk_mul_f32 v[84:85], v[94:95], v[84:85] op_sel_hi:[0,1]
v_pk_mul_f32 v[86:87], v[94:95], v[86:87] op_sel_hi:[0,1]
v_pk_mul_f32 v[88:89], v[214:215], v[88:89] op_sel_hi:[0,1]
v_pk_mul_f32 v[90:91], v[214:215], v[90:91] op_sel_hi:[0,1]
v_cvt_pk_bf16_f32 v204, v80, v81
v_cvt_pk_bf16_f32 v205, v82, v83
v_cvt_pk_bf16_f32 v206, v84, v85
v_cvt_pk_bf16_f32 v207, v86, v87
v_cvt_pk_bf16_f32 v208, v88, v89
v_cvt_pk_bf16_f32 v209, v90, v91
buffer_store_dwordx4 v[204:207], v4, s[32:35], s53 offen sc1
s_mov_b32 exec_hi, 0
buffer_store_dwordx2 v[208:209], v47, s[32:35], s54 offen sc1
s_mov_b64 exec, -1
s_and_b32 s59, s49, 15
s_mul_i32 s88, s59, 20480
s_lshl_b32 s50, s48, 10
s_add_u32 s88, s88, s50
s_add_u32 s88, s88, s101
v_add_u32 v5, s88, v4
v_add_u32 v6, 20480, v5
v_add_u32 v7, 40960, v5
s_lshl_b32 s50, s48, 6
v_xor_b32 v60, s50, v25
s_lshl_b32 s50, s48, 12
s_add_u32 s50, s50, 0
v_xor_b32 v48, 0, v60
v_xor_b32 v49, 32, v60
v_xor_b32 v50, 64, v60
v_xor_b32 v51, 96, v60
v_add_u32 v48, s50, v48
v_add_u32 v49, s50, v49
v_add_u32 v50, s50, v50
v_add_u32 v51, s50, v51
s_mul_i32 s50, s40, 6144
s_add_u32 s50, s50, 81920
v_add_u32 v56, s50, v4
s_xor_b32 s50, s40, 1
s_mul_i32 s50, s50, 6144
s_add_u32 s50, s50, 81920
v_add_u32 v57, s50, v4
v_permlane16_swap_b32 v34, v36
v_permlane16_swap_b32 v35, v37
v_permlane16_swap_b32 v38, v40
v_permlane16_swap_b32 v39, v41
v_permlane16_swap_b32 v42, v44
v_permlane16_swap_b32 v43, v45
s_waitcnt vmcnt(0)
s_barrier
s_cmp_lg_u32 s40, 0
s_cbranch_scc1 L_nw17
s_cmp_eq_u32 s84, 0
s_cbranch_scc1 L_as18
v_mov_b32 v60, 0
v_mov_b32 v61, 1
s_lshl_b32 s50, s41, 7
s_lshl_b32 s51, s42, 2
s_add_u32 s50, s50, s51
s_add_u32 s50, s50, 16384
s_mov_b64 exec, 1
buffer_store_dword v61, v60, s[32:35], s50 offen
s_mov_b64 exec, -1
s_branch L_ad19
L_as18:
s_lshl_b32 s50, s41, 8
s_add_u32 s50, s50, 4096
v_mov_b32 v60, 0
v_mov_b32 v61, 1
s_mov_b64 exec, 1
buffer_atomic_add v61, v60, s[32:35], s50 offen sc1
s_mov_b64 exec, -1
L_ad19:
L_nw17:
s_cmp_ge_u32 s42, 30
s_cbranch_scc1 L_cs
s_add_u32 m0, s61, 122880
s_mov_b32 s50, 221184
buffer_load_dwordx4 v22, s[16:19], s50 offen lds
s_add_u32 m0, s61, 126976
s_mov_b32 s50, 221184
buffer_load_dwordx4 v22, s[20:23], s50 offen lds
s_cmp_lg_u32 s40, 0
s_cbranch_scc1 L_nw20
s_cmp_eq_u32 s84, 0
s_cbranch_scc1 L_ps21
s_lshl_b32 s50, s41, 7
s_add_u32 s50, s50, 16384
v_min_u32 v60, 31, v1
v_lshlrev_b32 v60, 2, v60
s_mov_b32 s51, 400000
L_pf23:
buffer_load_dword v61, v60, s[32:35], s50 offen sc1
s_waitcnt vmcnt(0)
v_cmp_eq_u32 vcc, 0, v61
s_nop 1
s_nop 2
s_cbranch_vccz L_pe22
s_sub_u32 s51, s51, 1
s_cmp_lg_u32 s51, 0
s_cbranch_scc1 L_pf23
s_branch L_pe22
L_ps21:
s_lshl_b32 s50, s41, 8
s_add_u32 s50, s50, 4096
v_mov_b32 v60, 0
s_mov_b32 s51, 400000
L_poll24:
buffer_load_dword v61, v60, s[32:35], s50 offen sc1
s_waitcnt vmcnt(0)
v_readfirstlane_b32 s52, v61
s_nop 0
s_cmp_ge_u32 s52, 32
s_nop 2
s_cbranch_scc1 L_pd25
s_sub_u32 s51, s51, 1
s_cmp_lg_u32 s51, 0
s_cbranch_scc1 L_poll24
L_pd25:
L_pe22:
L_nw20:
s_barrier
s_mov_b32 s62, 0
buffer_load_dwordx4 a[0:3], v5, s[32:35], s62 offen sc1
buffer_load_dwordx4 a[4:7], v6, s[32:35], s62 offen sc1
buffer_load_dwordx4 a[8:11], v7, s[32:35], s62 offen sc1
s_mov_b32 s62, 2048
buffer_load_dwordx4 a[12:15], v5, s[32:35], s62 offen sc1
buffer_load_dwordx4 a[16:19], v6, s[32:35], s62 offen sc1
buffer_load_dwordx4 a[20:23], v7, s[32:35], s62 offen sc1
s_mov_b32 s62, 4096
buffer_load_dwordx4 a[24:27], v5, s[32:35], s62 offen sc1
buffer_load_dwordx4 a[28:31], v6, s[32:35], s62 offen sc1
buffer_load_dwordx4 a[32:35], v7, s[32:35], s62 offen sc1
ds_read_b64_tr_b16 v[144:145], v48 offset:0
ds_read_b64_tr_b16 v[146:147], v48 offset:2048
ds_read_b64_tr_b16 v[148:149], v49 offset:0
ds_read_b64_tr_b16 v[150:151], v49 offset:2048
ds_read_b64_tr_b16 v[152:153], v50 offset:0
ds_read_b64_tr_b16 v[154:155], v50 offset:2048
ds_read_b64_tr_b16 v[156:157], v51 offset:0
ds_read_b64_tr_b16 v[158:159], v51 offset:2048
s_waitcnt vmcnt(6)
s_waitcnt lgkmcnt(6)
v_mfma_f32_16x16x32_bf16 v[64:67], v[144:147], a[0:3], 0
ds_read_b64_tr_b16 v[160:161], v48 offset:8192
s_mov_b32 s62, 6144
v_mfma_f32_16x16x32_bf16 v[80:83], v[144:147], a[4:7], 0
ds_read_b64_tr_b16 v[162:163], v48 offset:10240
v_mfma_f32_16x16x32_bf16 v[96:99], v[144:147], a[8:11], 0
buffer_load_dwordx4 a[36:39], v5, s[32:35], s62 offen sc1
s_waitcnt lgkmcnt(6)
v_mfma_f32_16x16x32_bf16 v[68:71], v[148:151], a[0:3], 0
ds_read_b64_tr_b16 v[144:145], v49 offset:8192
v_mfma_f32_16x16x32_bf16 v[84:87], v[148:151], a[4:7], 0
ds_read_b64_tr_b16 v[146:147], v49 offset:10240
v_mfma_f32_16x16x32_bf16 v[100:103], v[148:151], a[8:11], 0
buffer_load_dwordx4 a[40:43], v6, s[32:35], s62 offen sc1
s_waitcnt lgkmcnt(6)
v_mfma_f32_16x16x32_bf16 v[72:75], v[152:155], a[0:3], 0
ds_read_b64_tr_b16 v[148:149], v50 offset:8192
v_mfma_f32_16x16x32_bf16 v[88:91], v[152:155], a[4:7], 0
ds_read_b64_tr_b16 v[150:151], v50 offset:10240
v_mfma_f32_16x16x32_bf16 v[104:107], v[152:155], a[8:11], 0
buffer_load_dwordx4 a[44:47], v7, s[32:35], s62 offen sc1
s_waitcnt lgkmcnt(6)
v_mfma_f32_16x16x32_bf16 v[76:79], v[156:159], a[0:3], 0
ds_read_b64_tr_b16 v[152:153], v51 offset:8192
s_mov_b32 s62, 8192
v_mfma_f32_16x16x32_bf16 v[92:95], v[156:159], a[4:7], 0
ds_read_b64_tr_b16 v[154:155], v51 offset:10240
v_mfma_f32_16x16x32_bf16 v[108:111], v[156:159], a[8:11], 0
buffer_load_dwordx4 a[48:51], v5, s[32:35], s62 offen sc1
s_waitcnt vmcnt(7)
s_waitcnt lgkmcnt(6)
v_mfma_f32_16x16x32_bf16 v[64:67], v[160:163], a[12:15], v[64:67]
ds_read_b64_tr_b16 v[156:157], v48 offset:16384
v_mfma_f32_16x16x32_bf16 v[80:83], v[160:163], a[16:19], v[80:83]
ds_read_b64_tr_b16 v[158:159], v48 offset:18432
v_mfma_f32_16x16x32_bf16 v[96:99], v[160:163], a[20:23], v[96:99]
buffer_load_dwordx4 a[52:55], v6, s[32:35], s62 offen sc1
s_waitcnt lgkmcnt(6)
v_mfma_f32_16x16x32_bf16 v[68:71], v[144:147], a[12:15], v[68:71]
ds_read_b64_tr_b16 v[160:161], v49 offset:16384
v_mfma_f32_16x16x32_bf16 v[84:87], v[144:147], a[16:19], v[84:87]
ds_read_b64_tr_b16 v[162:163], v49 offset:18432
v_mfma_f32_16x16x32_bf16 v[100:103], v[144:147], a[20:23], v[100:103]
buffer_load_dwordx4 a[56:59], v7, s[32:35], s62 offen sc1
s_waitcnt lgkmcnt(6)
v_mfma_f32_16x16x32_bf16 v[72:75], v[148:151], a[12:15], v[72:75]
ds_read_b64_tr_b16 v[144:145], v50 offset:16384
s_mov_b32 s62, 10240
v_mfma_f32_16x16x32_bf16 v[88:91], v[148:151], a[16:19], v[88:91]
ds_read_b64_tr_b16 v[146:147], v50 offset:18432
v_mfma_f32_16x16x32_bf16 v[104:107], v[148:151], a[20:23], v[104:107]
buffer_load_dwordx4 a[60:63], v5, s[32:35], s62 offen sc1
s_waitcnt lgkmcnt(6)
v_mfma_f32_16x16x32_bf16 v[76:79], v[152:155], a[12:15], v[76:79]
ds_read_b64_tr_b16 v[148:149], v51 offset:16384
v_mfma_f32_16x16x32_bf16 v[92:95], v[152:155], a[16:19], v[92:95]
ds_read_b64_tr_b16 v[150:151], v51 offset:18432
v_mfma_f32_16x16x32_bf16 v[108:111], v[152:155], a[20:23], v[108:111]
buffer_load_dwordx4 a[64:67], v6, s[32:35], s62 offen sc1
s_waitcnt vmcnt(8)
s_waitcnt lgkmcnt(6)
v_mfma_f32_16x16x32_bf16 v[64:67], v[156:159], a[24:27], v[64:67]
ds_read_b64_tr_b16 v[152:153], v48 offset:24576
v_mfma_f32_16x16x32_bf16 v[80:83], v[156:159], a[28:31], v[80:83]
ds_read_b64_tr_b16 v[154:155], v48 offset:26624
v_mfma_f32_16x16x32_bf16 v[96:99], v[156:159], a[32:35], v[96:99]
buffer_load_dwordx4 a[68:71], v7, s[32:35], s62 offen sc1
s_waitcnt lgkmcnt(6)
v_mfma_f32_16x16x32_bf16 v[68:71], v[160:163], a[24:27], v[68:71]
ds_read_b64_tr_b16 v[156:157], v49 offset:24576
s_mov_b32 s62, 12288
v_mfma_f32_16x16x32_bf16 v[84:87], v[160:163], a[28:31], v[84:87]
ds_read_b64_tr_b16 v[158:159], v49 offset:26624
v_mfma_f32_16x16x32_bf16 v[100:103], v[160:163], a[32:35], v[100:103]
buffer_load_dwordx4 a[72:75], v5, s[32:35], s62 offen sc1
s_waitcnt lgkmcnt(6)
v_mfma_f32_16x16x32_bf16 v[72:75], v[144:147], a[24:27], v[72:75]
ds_read_b64_tr_b16 v[160:161], v50 offset:24576
v_mfma_f32_16x16x32_bf16 v[88:91], v[144:147], a[28:31], v[88:91]
ds_read_b64_tr_b16 v[162:163], v50 offset:26624
v_mfma_f32_16x16x32_bf16 v[104:107], v[144:147], a[32:35], v[104:107]
buffer_load_dwordx4 a[76:79], v6, s[32:35], s62 offen sc1
s_waitcnt lgkmcnt(6)
v_mfma_f32_16x16x32_bf16 v[76:79], v[148:151], a[24:27], v[76:79]
ds_read_b64_tr_b16 v[144:145], v51 offset:24576
v_mfma_f32_16x16x32_bf16 v[92:95], v[148:151], a[28:31], v[92:95]
ds_read_b64_tr_b16 v[146:147], v51 offset:26624
v_mfma_f32_16x16x32_bf16 v[108:111], v[148:151], a[32:35], v[108:111]
buffer_load_dwordx4 a[80:83], v7, s[32:35], s62 offen sc1
s_waitcnt vmcnt(9)
s_waitcnt lgkmcnt(6)
v_mfma_f32_16x16x32_bf16 v[64:67], v[152:155], a[36:39], v[64:67]
ds_read_b64_tr_b16 v[148:149], v48 offset:32768
s_mov_b32 s62, 14336
v_mfma_f32_16x16x32_bf16 v[80:83], v[152:155], a[40:43], v[80:83]
ds_read_b64_tr_b16 v[150:151], v48 offset:34816
v_mfma_f32_16x16x32_bf16 v[96:99], v[152:155], a[44:47], v[96:99]
buffer_load_dwordx4 a[84:87], v5, s[32:35], s62 offen sc1
s_waitcnt lgkmcnt(6)
v_mfma_f32_16x16x32_bf16 v[68:71], v[156:159], a[36:39], v[68:71]
ds_read_b64_tr_b16 v[152:153], v49 offset:32768
v_mfma_f32_16x16x32_bf16 v[84:87], v[156:159], a[40:43], v[84:87]
ds_read_b64_tr_b16 v[154:155], v49 offset:34816
v_mfma_f32_16x16x32_bf16 v[100:103], v[156:159], a[44:47], v[100:103]
buffer_load_dwordx4 a[88:91], v6, s[32:35], s62 offen sc1
s_waitcnt lgkmcnt(6)
v_mfma_f32_16x16x32_bf16 v[72:75], v[160:163], a[36:39], v[72:75]
ds_read_b64_tr_b16 v[156:157], v50 offset:32768
v_mfma_f32_16x16x32_bf16 v[88:91], v[160:163], a[40:43], v[88:91]
ds_read_b64_tr_b16 v[158:159], v50 offset:34816
v_mfma_f32_16x16x32_bf16 v[104:107], v[160:163], a[44:47], v[104:107]
buffer_load_dwordx4 a[92:95], v7, s[32:35], s62 offen sc1
s_waitcnt lgkmcnt(6)
v_mfma_f32_16x16x32_bf16 v[76:79], v[144:147], a[36:39], v[76:79]
ds_read_b64_tr_b16 v[160:161], v51 offset:32768
s_mov_b32 s62, 16384
v_mfma_f32_16x16x32_bf16 v[92:95], v[144:147], a[40:43], v[92:95]
ds_read_b64_tr_b16 v[162:163], v51 offset:34816
v_mfma_f32_16x16x32_bf16 v[108:111], v[144:147], a[44:47], v[108:111]
buffer_load_dwordx4 a[96:99], v5, s[32:35], s62 offen sc1
s_waitcnt vmcnt(10)
s_waitcnt lgkmcnt(6)
v_mfma_f32_16x16x32_bf16 v[64:67], v[148:151], a[48:51], v[64:67]
ds_read_b64_tr_b16 v[144:145], v48 offset:40960
v_mfma_f32_16x16x32_bf16 v[80:83], v[148:151], a[52:55], v[80:83]
ds_read_b64_tr_b16 v[146:147], v48 offset:43008
v_mfma_f32_16x16x32_bf16 v[96:99], v[148:151], a[56:59], v[96:99]
buffer_load_dwordx4 a[100:103], v6, s[32:35], s62 offen sc1
s_waitcnt lgkmcnt(6)
v_mfma_f32_16x16x32_bf16 v[68:71], v[152:155], a[48:51], v[68:71]
ds_read_b64_tr_b16 v[148:149], v49 offset:40960
v_mfma_f32_16x16x32_bf16 v[84:87], v[152:155], a[52:55], v[84:87]
ds_read_b64_tr_b16 v[150:151], v49 offset:43008
v_mfma_f32_16x16x32_bf16 v[100:103], v[152:155], a[56:59], v[100:103]
buffer_load_dwordx4 a[104:107], v7, s[32:35], s62 offen sc1
s_waitcnt lgkmcnt(6)
v_mfma_f32_16x16x32_bf16 v[72:75], v[156:159], a[48:51], v[72:75]
ds_read_b64_tr_b16 v[152:153], v50 offset:40960
s_mov_b32 s62, 18432
v_mfma_f32_16x16x32_bf16 v[88:91], v[156:159], a[52:55], v[88:91]
ds_read_b64_tr_b16 v[154:155], v50 offset:43008
v_mfma_f32_16x16x32_bf16 v[104:107], v[156:159], a[56:59], v[104:107]
buffer_load_dwordx4 a[108:111], v5, s[32:35], s62 offen sc1
s_waitcnt lgkmcnt(6)
v_mfma_f32_16x16x32_bf16 v[76:79], v[160:163], a[48:51], v[76:79]
ds_read_b64_tr_b16 v[156:157], v51 offset:40960
v_mfma_f32_16x16x32_bf16 v[92:95], v[160:163], a[52:55], v[92:95]
ds_read_b64_tr_b16 v[158:159], v51 offset:43008
v_mfma_f32_16x16x32_bf16 v[108:111], v[160:163], a[56:59], v[108:111]
buffer_load_dwordx4 a[112:115], v6, s[32:35], s62 offen sc1
s_waitcnt vmcnt(11)
s_waitcnt lgkmcnt(6)
v_mfma_f32_16x16x32_bf16 v[64:67], v[144:147], a[60:63], v[64:67]
ds_read_b64_tr_b16 v[160:161], v48 offset:49152
v_mfma_f32_16x16x32_bf16 v[80:83], v[144:147], a[64:67], v[80:83]
ds_read_b64_tr_b16 v[162:163], v48 offset:51200
v_mfma_f32_16x16x32_bf16 v[96:99], v[144:147], a[68:71], v[96:99]
buffer_load_dwordx4 a[116:119], v7, s[32:35], s62 offen sc1
s_waitcnt lgkmcnt(6)
v_mfma_f32_16x16x32_bf16 v[68:71], v[148:151], a[60:63], v[68:71]
ds_read_b64_tr_b16 v[144:145], v49 offset:49152
s_add_u32 m0, s61, 131072
v_mfma_f32_16x16x32_bf16 v[84:87], v[148:151], a[64:67], v[84:87]
ds_read_b64_tr_b16 v[146:147], v49 offset:51200
s_mov_b32 s50, 331776
v_mfma_f32_16x16x32_bf16 v[100:103], v[148:151], a[68:71], v[100:103]
buffer_load_dwordx4 v22, s[16:19], s50 offen lds
s_waitcnt lgkmcnt(6)
v_mfma_f32_16x16x32_bf16 v[72:75], v[152:155], a[60:63], v[72:75]
ds_read_b64_tr_b16 v[148:149], v50 offset:49152
s_add_u32 m0, s61, 135168
v_mfma_f32_16x16x32_bf16 v[88:91], v[152:155], a[64:67], v[88:91]
ds_read_b64_tr_b16 v[150:151], v50 offset:51200
s_mov_b32 s50, 331776
v_mfma_f32_16x16x32_bf16 v[104:107], v[152:155], a[68:71], v[104:107]
buffer_load_dwordx4 v22, s[20:23], s50 offen lds
s_waitcnt lgkmcnt(6)
v_mfma_f32_16x16x32_bf16 v[76:79], v[156:159], a[60:63], v[76:79]
ds_read_b64_tr_b16 v[152:153], v51 offset:49152
s_add_u32 m0, s61, 139264
v_mfma_f32_16x16x32_bf16 v[92:95], v[156:159], a[64:67], v[92:95]
ds_read_b64_tr_b16 v[154:155], v51 offset:51200
s_mov_b32 s50, 442368
v_mfma_f32_16x16x32_bf16 v[108:111], v[156:159], a[68:71], v[108:111]
buffer_load_dwordx4 v22, s[16:19], s50 offen lds
s_waitcnt vmcnt(12)
s_waitcnt lgkmcnt(6)
v_mfma_f32_16x16x32_bf16 v[64:67], v[160:163], a[72:75], v[64:67]
ds_read_b64_tr_b16 v[156:157], v48 offset:57344
s_add_u32 m0, s61, 143360
v_mfma_f32_16x16x32_bf16 v[80:83], v[160:163], a[76:79], v[80:83]
ds_read_b64_tr_b16 v[158:159], v48 offset:59392
s_mov_b32 s50, 442368
v_mfma_f32_16x16x32_bf16 v[96:99], v[160:163], a[80:83], v[96:99]
buffer_load_dwordx4 v22, s[20:23], s50 offen lds
s_waitcnt lgkmcnt(6)
v_mfma_f32_16x16x32_bf16 v[68:71], v[144:147], a[72:75], v[68:71]
ds_read_b64_tr_b16 v[160:161], v49 offset:57344
s_add_u32 m0, s61, 147456
v_mfma_f32_16x16x32_bf16 v[84:87], v[144:147], a[76:79], v[84:87]
ds_read_b64_tr_b16 v[162:163], v49 offset:59392
s_mov_b32 s50, 552960
v_mfma_f32_16x16x32_bf16 v[100:103], v[144:147], a[80:83], v[100:103]
buffer_load_dwordx4 v22, s[16:19], s50 offen lds
s_waitcnt lgkmcnt(6)
v_mfma_f32_16x16x32_bf16 v[72:75], v[148:151], a[72:75], v[72:75]
ds_read_b64_tr_b16 v[144:145], v50 offset:57344
s_add_u32 m0, s61, 151552
v_mfma_f32_16x16x32_bf16 v[88:91], v[148:151], a[76:79], v[88:91]
ds_read_b64_tr_b16 v[146:147], v50 offset:59392
s_mov_b32 s50, 552960
v_mfma_f32_16x16x32_bf16 v[104:107], v[148:151], a[80:83], v[104:107]
buffer_load_dwordx4 v22, s[20:23], s50 offen lds
s_waitcnt lgkmcnt(6)
v_mfma_f32_16x16x32_bf16 v[76:79], v[152:155], a[72:75], v[76:79]
ds_read_b64_tr_b16 v[148:149], v51 offset:57344
s_add_u32 m0, s61, 155648
v_mfma_f32_16x16x32_bf16 v[92:95], v[152:155], a[76:79], v[92:95]
ds_read_b64_tr_b16 v[150:151], v51 offset:59392
s_mov_b32 s50, 663552
v_mfma_f32_16x16x32_bf16 v[108:111], v[152:155], a[80:83], v[108:111]
buffer_load_dwordx4 v22, s[16:19], s50 offen lds
s_waitcnt vmcnt(13)
s_waitcnt lgkmcnt(6)
v_mfma_f32_16x16x32_bf16 v[64:67], v[156:159], a[84:87], v[64:67]
v_add_u32 v48, 0x10000, v48
v_add_u32 v49, 0x10000, v49
v_add_u32 v50, 0x10000, v50
v_add_u32 v51, 0x10000, v51
ds_read_b64_tr_b16 v[152:153], v48 offset:0
s_add_u32 m0, s61, 159744
v_mfma_f32_16x16x32_bf16 v[80:83], v[156:159], a[88:91], v[80:83]
ds_read_b64_tr_b16 v[154:155], v48 offset:2048
s_mov_b32 s50, 663552
v_mfma_f32_16x16x32_bf16 v[96:99], v[156:159], a[92:95], v[96:99]
buffer_load_dwordx4 v22, s[20:23], s50 offen lds
s_waitcnt lgkmcnt(6)
v_mfma_f32_16x16x32_bf16 v[68:71], v[160:163], a[84:87], v[68:71]
ds_read_b64_tr_b16 v[156:157], v49 offset:0
v_mfma_f32_16x16x32_bf16 v[84:87], v[160:163], a[88:91], v[84:87]
ds_read_b64_tr_b16 v[158:159], v49 offset:2048
v_mfma_f32_16x16x32_bf16 v[100:103], v[160:163], a[92:95], v[100:103]
s_waitcnt lgkmcnt(6)
v_mfma_f32_16x16x32_bf16 v[72:75], v[144:147], a[84:87], v[72:75]
ds_read_b64_tr_b16 v[160:161], v50 offset:0
v_mfma_f32_16x16x32_bf16 v[88:91], v[144:147], a[88:91], v[88:91]
ds_read_b64_tr_b16 v[162:163], v50 offset:2048
v_mfma_f32_16x16x32_bf16 v[104:107], v[144:147], a[92:95], v[104:107]
s_waitcnt lgkmcnt(6)
v_mfma_f32_16x16x32_bf16 v[76:79], v[148:151], a[84:87], v[76:79]
ds_read_b64_tr_b16 v[144:145], v51 offset:0
v_mfma_f32_16x16x32_bf16 v[92:95], v[148:151], a[88:91], v[92:95]
ds_read_b64_tr_b16 v[146:147], v51 offset:2048
v_mfma_f32_16x16x32_bf16 v[108:111], v[148:151], a[92:95], v[108:111]
s_waitcnt vmcnt(11)
s_waitcnt lgkmcnt(6)
v_mfma_f32_16x16x32_bf16 v[64:67], v[152:155], a[96:99], v[64:67]
ds_read_b64_tr_b16 v[148:149], v48 offset:8192
v_mfma_f32_16x16x32_bf16 v[80:83], v[152:155], a[100:103], v[80:83]
ds_read_b64_tr_b16 v[150:151], v48 offset:10240
v_mfma_f32_16x16x32_bf16 v[96:99], v[152:155], a[104:107], v[96:99]
s_waitcnt lgkmcnt(6)
v_mfma_f32_16x16x32_bf16 v[68:71], v[156:159], a[96:99], v[68:71]
ds_read_b64_tr_b16 v[152:153], v49 offset:8192
v_mfma_f32_16x16x32_bf16 v[84:87], v[156:159], a[100:103], v[84:87]
ds_read_b64_tr_b16 v[154:155], v49 offset:10240
v_mfma_f32_16x16x32_bf16 v[100:103], v[156:159], a[104:107], v[100:103]
s_waitcnt lgkmcnt(6)
v_mfma_f32_16x16x32_bf16 v[72:75], v[160:163], a[96:99], v[72:75]
ds_read_b64_tr_b16 v[156:157], v50 offset:8192
v_mfma_f32_16x16x32_bf16 v[88:91], v[160:163], a[100:103], v[88:91]
ds_read_b64_tr_b16 v[158:159], v50 offset:10240
v_mfma_f32_16x16x32_bf16 v[104:107], v[160:163], a[104:107], v[104:107]
s_waitcnt lgkmcnt(6)
v_mfma_f32_16x16x32_bf16 v[76:79], v[144:147], a[96:99], v[76:79]
ds_read_b64_tr_b16 v[160:161], v51 offset:8192
v_mfma_f32_16x16x32_bf16 v[92:95], v[144:147], a[100:103], v[92:95]
ds_read_b64_tr_b16 v[162:163], v51 offset:10240
v_mfma_f32_16x16x32_bf16 v[108:111], v[144:147], a[104:107], v[108:111]
s_waitcnt vmcnt(8)
s_waitcnt lgkmcnt(6)
v_mfma_f32_16x16x32_bf16 v[64:67], v[148:151], a[108:111], v[64:67]
v_mfma_f32_16x16x32_bf16 v[80:83], v[148:151], a[112:115], v[80:83]
v_mfma_f32_16x16x32_bf16 v[96:99], v[148:151], a[116:119], v[96:99]
s_waitcnt lgkmcnt(4)
v_mfma_f32_16x16x32_bf16 v[68:71], v[152:155], a[108:111], v[68:71]
v_mfma_f32_16x16x32_bf16 v[84:87], v[152:155], a[112:115], v[84:87]
v_mfma_f32_16x16x32_bf16 v[100:103], v[152:155], a[116:119], v[100:103]
s_waitcnt lgkmcnt(2)
v_mfma_f32_16x16x32_bf16 v[72:75], v[156:159], a[108:111], v[72:75]
v_mfma_f32_16x16x32_bf16 v[88:91], v[156:159], a[112:115], v[88:91]
v_mfma_f32_16x16x32_bf16 v[104:107], v[156:159], a[116:119], v[104:107]
s_waitcnt lgkmcnt(0)
v_mfma_f32_16x16x32_bf16 v[76:79], v[160:163], a[108:111], v[76:79]
v_mfma_f32_16x16x32_bf16 v[92:95], v[160:163], a[112:115], v[92:95]
v_mfma_f32_16x16x32_bf16 v[108:111], v[160:163], a[116:119], v[108:111]
s_nop 1
ds_write_b128 v56, v[72:75] offset:0
s_nop 2
ds_write_b128 v56, v[76:79] offset:1024
ds_write_b128 v56, v[88:91] offset:2048
ds_write_b128 v56, v[92:95] offset:3072
ds_write_b128 v56, v[104:107] offset:4096
ds_write_b128 v56, v[108:111] offset:5120
v_lshlrev_b32 v124, 16, v34
v_and_b32 v125, 0xffff0000, v34
v_lshlrev_b32 v126, 16, v35
v_and_b32 v127, 0xffff0000, v35
v_lshlrev_b32 v128, 16, v36
v_and_b32 v129, 0xffff0000, v36
v_lshlrev_b32 v130, 16, v37
v_and_b32 v131, 0xffff0000, v37
v_lshlrev_b32 v132, 16, v38
v_and_b32 v133, 0xffff0000, v38
v_lshlrev_b32 v134, 16, v39
v_and_b32 v135, 0xffff0000, v39
v_lshlrev_b32 v136, 16, v40
v_and_b32 v137, 0xffff0000, v40
v_lshlrev_b32 v138, 16, v41
v_and_b32 v139, 0xffff0000, v41
v_lshlrev_b32 v140, 16, v42
v_and_b32 v141, 0xffff0000, v42
v_lshlrev_b32 v142, 16, v43
v_and_b32 v143, 0xffff0000, v43
v_lshlrev_b32 v144, 16, v44
v_and_b32 v145, 0xffff0000, v44
v_lshlrev_b32 v146, 16, v45
v_and_b32 v147, 0xffff0000, v45
v_pk_add_f32 v[64:65], v[64:65], v[124:125]
v_pk_add_f32 v[66:67], v[66:67], v[126:127]
v_pk_add_f32 v[68:69], v[68:69], v[128:129]
v_pk_add_f32 v[70:71], v[70:71], v[130:131]
v_pk_add_f32 v[80:81], v[80:81], v[132:133]
v_pk_add_f32 v[82:83], v[82:83], v[134:135]
v_pk_add_f32 v[84:85], v[84:85], v[136:137]
v_pk_add_f32 v[86:87], v[86:87], v[138:139]
v_pk_add_f32 v[96:97], v[96:97], v[140:141]
v_pk_add_f32 v[98:99], v[98:99], v[142:143]
v_pk_add_f32 v[100:101], v[100:101], v[144:145]
v_pk_add_f32 v[102:103], v[102:103], v[146:147]
s_waitcnt lgkmcnt(0)
s_barrier
ds_read_b128 v[72:75], v57 offset:0
ds_read_b128 v[76:79], v57 offset:1024
ds_read_b128 v[88:91], v57 offset:2048
ds_read_b128 v[92:95], v57 offset:3072
ds_read_b128 v[104:107], v57 offset:4096
ds_read_b128 v[108:111], v57 offset:5120
s_add_u32 s56, s88, 327680
s_lshl_b32 s52, s45, 11
s_add_u32 s56, s56, s52
s_mul_i32 s57, s59, 2560
s_add_u32 s57, s57, s101
s_lshl_b32 s52, s45, 8
s_add_u32 s57, s57, s52
s_lshl_b32 s52, s48, 7
s_add_u32 s57, s57, s52
s_add_u32 s57, s57, 655360
v_lshlrev_b32 v47, 3, v2
s_waitcnt lgkmcnt(4)
v_pk_add_f32 v[64:65], v[64:65], v[72:73]
v_pk_add_f32 v[66:67], v[66:67], v[74:75]
v_pk_add_f32 v[68:69], v[68:69], v[76:77]
v_pk_add_f32 v[70:71], v[70:71], v[78:79]
v_cvt_pk_bf16_f32 v112, v64, v65
v_cvt_pk_bf16_f32 v113, v66, v67
v_cvt_pk_bf16_f32 v114, v68, v69
v_cvt_pk_bf16_f32 v115, v70, v71
s_add_u32 s52, s56, 0
buffer_store_dwordx4 v[112:115], v4, s[32:35], s52 offen sc1
s_waitcnt lgkmcnt(2)
v_pk_add_f32 v[80:81], v[80:81], v[88:89]
v_pk_add_f32 v[82:83], v[82:83], v[90:91]
v_pk_add_f32 v[84:85], v[84:85], v[92:93]
v_pk_add_f32 v[86:87], v[86:87], v[94:95]
v_cvt_pk_bf16_f32 v116, v80, v81
v_cvt_pk_bf16_f32 v117, v82, v83
v_cvt_pk_bf16_f32 v118, v84, v85
v_cvt_pk_bf16_f32 v119, v86, v87
s_add_u32 s52, s56, 20480
buffer_store_dwordx4 v[116:119], v4, s[32:35], s52 offen sc1
s_waitcnt lgkmcnt(0)
v_pk_add_f32 v[96:97], v[96:97], v[104:105]
v_pk_add_f32 v[98:99], v[98:99], v[106:107]
v_pk_add_f32 v[100:101], v[100:101], v[108:109]
v_pk_add_f32 v[102:103], v[102:103], v[110:111]
v_cvt_pk_bf16_f32 v120, v96, v97
v_cvt_pk_bf16_f32 v121, v98, v99
v_cvt_pk_bf16_f32 v122, v100, v101
v_cvt_pk_bf16_f32 v123, v102, v103
s_add_u32 s52, s56, 40960
buffer_store_dwordx4 v[120:123], v4, s[32:35], s52 offen sc1
v_lshlrev_b32 v64, 16, v112
v_and_b32 v65, 0xffff0000, v112
v_lshlrev_b32 v66, 16, v113
v_and_b32 v67, 0xffff0000, v113
v_lshlrev_b32 v68, 16, v114
v_and_b32 v69, 0xffff0000, v114
v_lshlrev_b32 v70, 16, v115
v_and_b32 v71, 0xffff0000, v115
v_lshlrev_b32 v80, 16, v116
v_and_b32 v81, 0xffff0000, v116
v_lshlrev_b32 v82, 16, v117
v_and_b32 v83, 0xffff0000, v117
v_lshlrev_b32 v84, 16, v118
v_and_b32 v85, 0xffff0000, v118
v_lshlrev_b32 v86, 16, v119
v_and_b32 v87, 0xffff0000, v119
v_lshlrev_b32 v96, 16, v120
v_and_b32 v97, 0xffff0000, v120
v_lshlrev_b32 v98, 16, v121
v_and_b32 v99, 0xffff0000, v121
v_lshlrev_b32 v100, 16, v122
v_and_b32 v101, 0xffff0000, v122
v_lshlrev_b32 v102, 16, v123
v_and_b32 v103, 0xffff0000, v123
v_pk_mul_f32 v[72:73], v[64:65], v[64:65]
v_pk_mul_f32 v[88:89], v[80:81], v[80:81]
v_pk_mul_f32 v[104:105], v[96:97], v[96:97]
v_pk_fma_f32 v[72:73], v[66:67], v[66:67], v[72:73]
v_pk_add_f32 v[64:65], v[64:65], v[66:67]
v_pk_fma_f32 v[88:89], v[82:83], v[82:83], v[88:89]
v_pk_add_f32 v[80:81], v[80:81], v[82:83]
v_pk_fma_f32 v[104:105], v[98:99], v[98:99], v[104:105]
v_pk_add_f32 v[96:97], v[96:97], v[98:99]
v_pk_fma_f32 v[72:73], v[68:69], v[68:69], v[72:73]
v_pk_add_f32 v[64:65], v[64:65], v[68:69]
v_pk_fma_f32 v[88:89], v[84:85], v[84:85], v[88:89]
v_pk_add_f32 v[80:81], v[80:81], v[84:85]
v_pk_fma_f32 v[104:105], v[100:101], v[100:101], v[104:105]
v_pk_add_f32 v[96:97], v[96:97], v[100:101]
v_pk_fma_f32 v[72:73], v[70:71], v[70:71], v[72:73]
v_pk_add_f32 v[64:65], v[64:65], v[70:71]
v_pk_fma_f32 v[88:89], v[86:87], v[86:87], v[88:89]
v_pk_add_f32 v[80:81], v[80:81], v[86:87]
v_pk_fma_f32 v[104:105], v[102:103], v[102:103], v[104:105]
v_pk_add_f32 v[96:97], v[96:97], v[102:103]
v_add_f32 v164, v64, v65
v_add_f32 v165, v72, v73
v_add_f32 v168, v80, v81
v_add_f32 v169, v88, v89
v_add_f32 v172, v96, v97
v_add_f32 v173, v104, v105
v_mov_b32 v166, v164
v_mov_b32 v167, v165
v_mov_b32 v170, v168
v_mov_b32 v171, v169
v_mov_b32 v174, v172
v_mov_b32 v175, v173
v_permlane16_swap_b32 v164, v166
v_permlane16_swap_b32 v165, v167
v_permlane16_swap_b32 v168, v170
v_permlane16_swap_b32 v169, v171
v_permlane16_swap_b32 v172, v174
v_permlane16_swap_b32 v173, v175
v_pk_add_f32 v[164:165], v[164:165], v[166:167]
v_pk_add_f32 v[168:169], v[168:169], v[170:171]
v_pk_add_f32 v[172:173], v[172:173], v[174:175]
v_mov_b32 v166, v164
v_mov_b32 v167, v165
v_mov_b32 v170, v168
v_mov_b32 v171, v169
v_mov_b32 v174, v172
v_mov_b32 v175, v173
v_permlane32_swap_b32 v164, v166
v_permlane32_swap_b32 v165, v167
v_permlane32_swap_b32 v168, v170
v_permlane32_swap_b32 v169, v171
v_permlane32_swap_b32 v172, v174
v_permlane32_swap_b32 v173, v175
v_pk_add_f32 v[164:165], v[164:165], v[166:167]
v_pk_add_f32 v[168:169], v[168:169], v[170:171]
v_pk_add_f32 v[172:173], v[172:173], v[174:175]
s_add_u32 s52, s57, 0
s_mov_b64 exec, 0xffff
buffer_store_dwordx2 v[164:165], v47, s[32:35], s52 offen sc1
s_mov_b64 exec, -1
s_add_u32 s52, s57, 2560
s_mov_b64 exec, 0xffff
buffer_store_dwordx2 v[168:169], v47, s[32:35], s52 offen sc1
s_mov_b64 exec, -1
s_add_u32 s52, s57, 5120
s_mov_b64 exec, 0xffff
buffer_store_dwordx2 v[172:173], v47, s[32:35], s52 offen sc1
s_mov_b64 exec, -1
s_lshl_b32 s54, s40, 2
s_mul_i32 s55, s54, 20480
s_add_u32 s55, s55, 327680
s_add_u32 s55, s55, s101
v_add_u32 v5, s55, v4
v_add_u32 v20, 20480, v5
v_add_u32 v23, 40960, v5
v_add_u32 v24, 61440, v5
v_lshlrev_b32 v58, 7, v3
v_lshl_add_u32 v58, v2, 3, v58
v_lshlrev_b32 v59, 4, v3
s_mul_i32 s53, s54, 2560
s_add_u32 s53, s53, 655360
s_add_u32 s53, s53, s101
s_lshl_b32 s56, s42, 8
s_add_u32 s56, s56, 32768
s_add_u32 s57, s56, 6912
v_mov_b32 v60, v25
s_mov_b32 s50, 106496
v_xor_b32 v48, 0, v60
v_xor_b32 v49, 32, v60
v_xor_b32 v50, 64, v60
v_xor_b32 v51, 96, v60
v_add_u32 v48, s50, v48
v_add_u32 v49, s50, v49
v_add_u32 v50, s50, v50
v_add_u32 v51, s50, v51
s_waitcnt vmcnt(0)
s_barrier
s_cmp_lg_u32 s40, 0
s_cbranch_scc1 L_nw26
s_cmp_eq_u32 s84, 0
s_cbranch_scc1 L_as27
v_mov_b32 v60, 0
v_mov_b32 v61, 1
s_lshl_b32 s50, s41, 7
s_lshl_b32 s51, s42, 2
s_add_u32 s50, s50, s51
s_add_u32 s50, s50, 17408
s_mov_b64 exec, 1
buffer_store_dword v61, v60, s[32:35], s50 offen
s_mov_b64 exec, -1
s_branch L_ad28
L_as27:
s_lshl_b32 s50, s41, 8
s_add_u32 s50, s50, 6144
v_mov_b32 v60, 0
v_mov_b32 v61, 1
s_mov_b64 exec, 1
buffer_atomic_add v61, v60, s[32:35], s50 offen sc1
s_mov_b64 exec, -1
L_ad28:
L_nw26:
s_cmp_ge_u32 s42, 27
s_cbranch_scc0 L_p3
s_add_u32 m0, s61, 106496
s_mov_b32 s50, 0
buffer_load_dwordx4 v21, s[24:27], s50 offen lds
s_add_u32 m0, s61, 110592
s_mov_b32 s50, 40960
buffer_load_dwordx4 v21, s[24:27], s50 offen lds
s_add_u32 m0, s61, 114688
s_mov_b32 s50, 81920
buffer_load_dwordx4 v21, s[24:27], s50 offen lds
s_add_u32 m0, s61, 118784
s_mov_b32 s50, 122880
buffer_load_dwordx4 v21, s[24:27], s50 offen lds
s_add_u32 m0, s61, 122880
s_mov_b32 s50, 163840
buffer_load_dwordx4 v21, s[24:27], s50 offen lds
s_add_u32 m0, s61, 126976
s_mov_b32 s50, 204800
buffer_load_dwordx4 v21, s[24:27], s50 offen lds
s_add_u32 m0, s61, 131072
s_mov_b32 s50, 245760
buffer_load_dwordx4 v21, s[24:27], s50 offen lds
s_add_u32 m0, s61, 135168
s_mov_b32 s50, 286720
buffer_load_dwordx4 v21, s[24:27], s50 offen lds
s_add_u32 m0, s61, 139264
s_mov_b32 s50, 327680
buffer_load_dwordx4 v21, s[24:27], s50 offen lds
s_add_u32 m0, s61, 143360
s_mov_b32 s50, 368640
buffer_load_dwordx4 v21, s[24:27], s50 offen lds
s_add_u32 m0, s61, 147456
s_mov_b32 s50, 409600
buffer_load_dwordx4 v21, s[24:27], s50 offen lds
s_add_u32 m0, s61, 151552
s_mov_b32 s50, 450560
buffer_load_dwordx4 v21, s[24:27], s50 offen lds
s_add_u32 m0, s61, 155648
s_mov_b32 s50, 491520
buffer_load_dwordx4 v21, s[24:27], s50 offen lds
s_add_u32 m0, s61, 159744
s_mov_b32 s50, 532480
buffer_load_dwordx4 v21, s[24:27], s50 offen lds
s_add_u32 m0, s61, 0
s_mov_b32 s50, 573440
buffer_load_dwordx4 v21, s[24:27], s50 offen lds
s_add_u32 m0, s61, 4096
s_mov_b32 s50, 614400
buffer_load_dwordx4 v21, s[24:27], s50 offen lds
s_add_u32 m0, s61, 8192
s_mov_b32 s50, 655360
buffer_load_dwordx4 v21, s[24:27], s50 offen lds
s_add_u32 m0, s61, 12288
s_mov_b32 s50, 696320
buffer_load_dwordx4 v21, s[24:27], s50 offen lds
s_add_u32 m0, s61, 16384
s_mov_b32 s50, 737280
buffer_load_dwordx4 v21, s[24:27], s50 offen lds
s_add_u32 m0, s61, 20480
s_mov_b32 s50, 778240
buffer_load_dwordx4 v21, s[24:27], s50 offen lds
s_add_u32 m0, s61, 24576
s_mov_b32 s50, 819200
buffer_load_dwordx4 v21, s[24:27], s50 offen lds
s_add_u32 m0, s61, 28672
s_mov_b32 s50, 860160
buffer_load_dwordx4 v21, s[24:27], s50 offen lds
s_add_u32 m0, s61, 32768
s_mov_b32 s50, 901120
buffer_load_dwordx4 v21, s[24:27], s50 offen lds
s_add_u32 m0, s61, 36864
s_mov_b32 s50, 942080
buffer_load_dwordx4 v21, s[24:27], s50 offen lds
s_add_u32 m0, s61, 40960
s_mov_b32 s50, 983040
buffer_load_dwordx4 v21, s[24:27], s50 offen lds
s_add_u32 m0, s61, 45056
s_mov_b32 s50, 1024000
buffer_load_dwordx4 v21, s[24:27], s50 offen lds
s_add_u32 m0, s61, 49152
s_mov_b32 s50, 1064960
buffer_load_dwordx4 v21, s[24:27], s50 offen lds
s_add_u32 m0, s61, 53248
s_mov_b32 s50, 1105920
buffer_load_dwordx4 v21, s[24:27], s50 offen lds
s_add_u32 m0, s61, 57344
s_mov_b32 s50, 1146880
buffer_load_dwordx4 v21, s[24:27], s50 offen lds
s_add_u32 m0, s61, 61440
s_mov_b32 s50, 1187840
buffer_load_dwordx4 v21, s[24:27], s50 offen lds
s_add_u32 m0, s61, 65536
s_mov_b32 s50, 1228800
buffer_load_dwordx4 v21, s[24:27], s50 offen lds
s_add_u32 m0, s61, 69632
s_mov_b32 s50, 1269760
buffer_load_dwordx4 v21, s[24:27], s50 offen lds
s_add_u32 m0, s61, 73728
s_mov_b32 s50, 1310720
buffer_load_dwordx4 v21, s[24:27], s50 offen lds
s_add_u32 m0, s61, 77824
s_mov_b32 s50, 1351680
buffer_load_dwordx4 v21, s[24:27], s50 offen lds
s_add_u32 m0, s61, 81920
s_mov_b32 s50, 1392640
buffer_load_dwordx4 v21, s[24:27], s50 offen lds
s_add_u32 m0, s61, 86016
s_mov_b32 s50, 1433600
buffer_load_dwordx4 v21, s[24:27], s50 offen lds
s_add_u32 m0, s61, 90112
s_mov_b32 s50, 1474560
buffer_load_dwordx4 v21, s[24:27], s50 offen lds
s_add_u32 m0, s61, 94208
s_mov_b32 s50, 1515520
buffer_load_dwordx4 v21, s[24:27], s50 offen lds
s_add_u32 m0, s61, 98304
s_mov_b32 s50, 1556480
buffer_load_dwordx4 v21, s[24:27], s50 offen lds
s_add_u32 m0, s61, 102400
s_mov_b32 s50, 1597440
buffer_load_dwordx4 v21, s[24:27], s50 offen lds
s_waitcnt vmcnt(0)
s_branch L_p4
L_p3:
s_cmp_lg_u32 s40, 0
s_cbranch_scc1 L_nw29
s_cmp_eq_u32 s84, 0
s_cbranch_scc1 L_ps30
s_lshl_b32 s50, s41, 7
s_add_u32 s50, s50, 17408
v_min_u32 v60, 29, v1
v_lshlrev_b32 v60, 2, v60
s_mov_b32 s51, 400000
L_pf32:
buffer_load_dword v61, v60, s[32:35], s50 offen sc1
s_waitcnt vmcnt(0)
v_cmp_eq_u32 vcc, 0, v61
s_nop 1
s_nop 2
s_cbranch_vccz L_pe31
s_sub_u32 s51, s51, 1
s_cmp_lg_u32 s51, 0
s_cbranch_scc1 L_pf32
s_branch L_pe31
L_ps30:
s_lshl_b32 s50, s41, 8
s_add_u32 s50, s50, 6144
v_mov_b32 v60, 0
s_mov_b32 s51, 400000
L_poll33:
buffer_load_dword v61, v60, s[32:35], s50 offen sc1
s_waitcnt vmcnt(0)
v_readfirstlane_b32 s52, v61
s_nop 0
s_cmp_ge_u32 s52, 30
s_nop 2
s_cbranch_scc1 L_pd34
s_sub_u32 s51, s51, 1
s_cmp_lg_u32 s51, 0
s_cbranch_scc1 L_poll33
L_pd34:
L_pe31:
L_nw29:
s_barrier
s_mov_b32 s62, 0
buffer_load_dwordx4 a[0:3], v5, s[32:35], s62 offen offset:0 sc1
buffer_load_dwordx4 a[4:7], v20, s[32:35], s62 offen offset:0 sc1
buffer_load_dwordx4 a[8:11], v23, s[32:35], s62 offen offset:0 sc1
buffer_load_dwordx4 a[12:15], v24, s[32:35], s62 offen offset:0 sc1
buffer_load_dwordx4 a[16:19], v5, s[32:35], s62 offen offset:1024 sc1
buffer_load_dwordx4 a[20:23], v20, s[32:35], s62 offen offset:1024 sc1
buffer_load_dwordx4 a[24:27], v23, s[32:35], s62 offen offset:1024 sc1
buffer_load_dwordx4 a[28:31], v24, s[32:35], s62 offen offset:1024 sc1
buffer_load_dwordx4 a[32:35], v5, s[32:35], s62 offen offset:2048 sc1
buffer_load_dwordx4 a[36:39], v20, s[32:35], s62 offen offset:2048 sc1
buffer_load_dwordx4 a[40:43], v23, s[32:35], s62 offen offset:2048 sc1
buffer_load_dwordx4 a[44:47], v24, s[32:35], s62 offen offset:2048 sc1
v_mov_b32 v60, 0
ds_read_b64_tr_b16 v[224:225], v48 offset:0
ds_read_b64_tr_b16 v[226:227], v48 offset:2048
ds_read_b64_tr_b16 v[228:229], v49 offset:0
ds_read_b64_tr_b16 v[230:231], v49 offset:2048
ds_read_b64_tr_b16 v[232:233], v50 offset:0
ds_read_b64_tr_b16 v[234:235], v50 offset:2048
ds_read_b64_tr_b16 v[236:237], v51 offset:0
ds_read_b64_tr_b16 v[238:239], v51 offset:2048
ds_read_b64_tr_b16 v[240:241], v48 offset:4096
ds_read_b64_tr_b16 v[242:243], v48 offset:6144
s_waitcnt vmcnt(8)
s_waitcnt lgkmcnt(8)
v_mfma_f32_16x16x32_bf16 v[64:67], v[224:227], a[0:3], 0
ds_read_b64_tr_b16 v[244:245], v49 offset:4096
v_mfma_f32_16x16x32_bf16 v[96:99], v[224:227], a[4:7], 0
ds_read_b64_tr_b16 v[246:247], v49 offset:6144
v_mfma_f32_16x16x32_bf16 v[128:131], v[224:227], a[8:11], 0
buffer_load_dwordx4 a[48:51], v5, s[32:35], s62 offen offset:3072 sc1
v_mfma_f32_16x16x32_bf16 v[160:163], v[224:227], a[12:15], 0
s_waitcnt lgkmcnt(8)
v_mfma_f32_16x16x32_bf16 v[68:71], v[228:231], a[0:3], 0
ds_read_b64_tr_b16 v[224:225], v50 offset:4096
s_add_u32 m0, s61, 0
v_mfma_f32_16x16x32_bf16 v[100:103], v[228:231], a[4:7], 0
ds_read_b64_tr_b16 v[226:227], v50 offset:6144
s_mov_b32 s50, 774144
v_mfma_f32_16x16x32_bf16 v[132:135], v[228:231], a[8:11], 0
buffer_load_dwordx4 v22, s[16:19], s50 offen lds
v_mfma_f32_16x16x32_bf16 v[164:167], v[228:231], a[12:15], 0
s_waitcnt lgkmcnt(8)
v_mfma_f32_16x16x32_bf16 v[72:75], v[232:235], a[0:3], 0
ds_read_b64_tr_b16 v[228:229], v51 offset:4096
v_mfma_f32_16x16x32_bf16 v[104:107], v[232:235], a[4:7], 0
ds_read_b64_tr_b16 v[230:231], v51 offset:6144
v_mfma_f32_16x16x32_bf16 v[136:139], v[232:235], a[8:11], 0
buffer_load_dwordx4 a[52:55], v20, s[32:35], s62 offen offset:3072 sc1
v_mfma_f32_16x16x32_bf16 v[168:171], v[232:235], a[12:15], 0
s_waitcnt lgkmcnt(8)
v_mfma_f32_16x16x32_bf16 v[76:79], v[236:239], a[0:3], 0
ds_read_b64_tr_b16 v[232:233], v48 offset:8192
s_add_u32 s51, s53, 0
v_mfma_f32_16x16x32_bf16 v[108:111], v[236:239], a[4:7], 0
ds_read_b64_tr_b16 v[234:235], v48 offset:10240
v_mfma_f32_16x16x32_bf16 v[140:143], v[236:239], a[8:11], 0
buffer_load_dwordx2 v[6:7], v58, s[32:35], s51 offen offset:0 sc1
v_mfma_f32_16x16x32_bf16 v[172:175], v[236:239], a[12:15], 0
s_waitcnt lgkmcnt(8)
v_mfma_f32_16x16x32_bf16 v[80:83], v[240:243], a[0:3], 0
ds_read_b64_tr_b16 v[236:237], v49 offset:8192
v_mfma_f32_16x16x32_bf16 v[112:115], v[240:243], a[4:7], 0
ds_read_b64_tr_b16 v[238:239], v49 offset:10240
v_mfma_f32_16x16x32_bf16 v[144:147], v[240:243], a[8:11], 0
buffer_load_dwordx4 a[56:59], v23, s[32:35], s62 offen offset:3072 sc1
v_mfma_f32_16x16x32_bf16 v[176:179], v[240:243], a[12:15], 0
s_waitcnt lgkmcnt(8)
v_mfma_f32_16x16x32_bf16 v[84:87], v[244:247], a[0:3], 0
ds_read_b64_tr_b16 v[240:241], v50 offset:8192
s_add_u32 m0, s61, 4096
v_mfma_f32_16x16x32_bf16 v[116:119], v[244:247], a[4:7], 0
ds_read_b64_tr_b16 v[242:243], v50 offset:10240
s_mov_b32 s50, 774144
v_mfma_f32_16x16x32_bf16 v[148:151], v[244:247], a[8:11], 0
buffer_load_dwordx4 v22, s[20:23], s50 offen lds
v_mfma_f32_16x16x32_bf16 v[180:183], v[244:247], a[12:15], 0
s_waitcnt lgkmcnt(8)
v_mfma_f32_16x16x32_bf16 v[88:91], v[224:227], a[0:3], 0
ds_read_b64_tr_b16 v[244:245], v51 offset:8192
v_mfma_f32_16x16x32_bf16 v[120:123], v[224:227], a[4:7], 0
ds_read_b64_tr_b16 v[246:247], v51 offset:10240
v_mfma_f32_16x16x32_bf16 v[152:155], v[224:227], a[8:11], 0
buffer_load_dwordx4 a[60:63], v24, s[32:35], s62 offen offset:3072 sc1
v_mfma_f32_16x16x32_bf16 v[184:187], v[224:227], a[12:15], 0
s_waitcnt lgkmcnt(8)
v_mfma_f32_16x16x32_bf16 v[92:95], v[228:231], a[0:3], 0
ds_read_b64_tr_b16 v[224:225], v48 offset:12288
s_add_u32 s51, s53, 0
v_mfma_f32_16x16x32_bf16 v[124:127], v[228:231], a[4:7], 0
ds_read_b64_tr_b16 v[226:227], v48 offset:14336
v_mfma_f32_16x16x32_bf16 v[156:159], v[228:231], a[8:11], 0
buffer_load_dwordx2 v[8:9], v58, s[32:35], s51 offen offset:512 sc1
v_mfma_f32_16x16x32_bf16 v[188:191], v[228:231], a[12:15], 0
s_waitcnt vmcnt(12)
s_waitcnt lgkmcnt(8)
v_mfma_f32_16x16x32_bf16 v[64:67], v[232:235], a[16:19], v[64:67]
ds_read_b64_tr_b16 v[228:229], v49 offset:12288
s_mov_b32 s62, 4096
v_mfma_f32_16x16x32_bf16 v[96:99], v[232:235], a[20:23], v[96:99]
ds_read_b64_tr_b16 v[230:231], v49 offset:14336
v_mfma_f32_16x16x32_bf16 v[128:131], v[232:235], a[24:27], v[128:131]
buffer_load_dwordx4 a[64:67], v5, s[32:35], s62 offen offset:0 sc1
v_mfma_f32_16x16x32_bf16 v[160:163], v[232:235], a[28:31], v[160:163]
s_waitcnt lgkmcnt(8)
v_mfma_f32_16x16x32_bf16 v[68:71], v[236:239], a[16:19], v[68:71]
ds_read_b64_tr_b16 v[232:233], v50 offset:12288
s_add_u32 m0, s61, 8192
v_mfma_f32_16x16x32_bf16 v[100:103], v[236:239], a[20:23], v[100:103]
ds_read_b64_tr_b16 v[234:235], v50 offset:14336
s_mov_b32 s50, 884736
v_mfma_f32_16x16x32_bf16 v[132:135], v[236:239], a[24:27], v[132:135]
buffer_load_dwordx4 v22, s[16:19], s50 offen lds
v_mfma_f32_16x16x32_bf16 v[164:167], v[236:239], a[28:31], v[164:167]
s_waitcnt lgkmcnt(8)
v_mfma_f32_16x16x32_bf16 v[72:75], v[240:243], a[16:19], v[72:75]
ds_read_b64_tr_b16 v[236:237], v51 offset:12288
v_mfma_f32_16x16x32_bf16 v[104:107], v[240:243], a[20:23], v[104:107]
ds_read_b64_tr_b16 v[238:239], v51 offset:14336
v_mfma_f32_16x16x32_bf16 v[136:139], v[240:243], a[24:27], v[136:139]
buffer_load_dwordx4 a[68:71], v20, s[32:35], s62 offen offset:0 sc1
v_mfma_f32_16x16x32_bf16 v[168:171], v[240:243], a[28:31], v[168:171]
s_waitcnt lgkmcnt(8)
v_mfma_f32_16x16x32_bf16 v[76:79], v[244:247], a[16:19], v[76:79]
ds_read_b64_tr_b16 v[240:241], v48 offset:16384
s_add_u32 s51, s53, 0
v_mfma_f32_16x16x32_bf16 v[108:111], v[244:247], a[20:23], v[108:111]
ds_read_b64_tr_b16 v[242:243], v48 offset:18432
v_mfma_f32_16x16x32_bf16 v[140:143], v[244:247], a[24:27], v[140:143]
buffer_load_dwordx2 v[10:11], v58, s[32:35], s51 offen offset:1024 sc1
v_mfma_f32_16x16x32_bf16 v[172:175], v[244:247], a[28:31], v[172:175]
s_waitcnt lgkmcnt(8)
v_mfma_f32_16x16x32_bf16 v[80:83], v[224:227], a[16:19], v[80:83]
ds_read_b64_tr_b16 v[244:245], v49 offset:16384
v_mfma_f32_16x16x32_bf16 v[112:115], v[224:227], a[20:23], v[112:115]
ds_read_b64_tr_b16 v[246:247], v49 offset:18432
v_mfma_f32_16x16x32_bf16 v[144:147], v[224:227], a[24:27], v[144:147]
buffer_load_dwordx4 a[72:75], v23, s[32:35], s62 offen offset:0 sc1
v_mfma_f32_16x16x32_bf16 v[176:179], v[224:227], a[28:31], v[176:179]
s_waitcnt lgkmcnt(8)
v_mfma_f32_16x16x32_bf16 v[84:87], v[228:231], a[16:19], v[84:87]
ds_read_b64_tr_b16 v[224:225], v50 offset:16384
s_add_u32 m0, s61, 12288
v_mfma_f32_16x16x32_bf16 v[116:119], v[228:231], a[20:23], v[116:119]
ds_read_b64_tr_b16 v[226:227], v50 offset:18432
s_mov_b32 s50, 884736
v_mfma_f32_16x16x32_bf16 v[148:151], v[228:231], a[24:27], v[148:151]
buffer_load_dwordx4 v22, s[20:23], s50 offen lds
v_mfma_f32_16x16x32_bf16 v[180:183], v[228:231], a[28:31], v[180:183]
s_waitcnt lgkmcnt(8)
v_mfma_f32_16x16x32_bf16 v[88:91], v[232:235], a[16:19], v[88:91]
ds_read_b64_tr_b16 v[228:229], v51 offset:16384
v_mfma_f32_16x16x32_bf16 v[120:123], v[232:235], a[20:23], v[120:123]
ds_read_b64_tr_b16 v[230:231], v51 offset:18432
v_mfma_f32_16x16x32_bf16 v[152:155], v[232:235], a[24:27], v[152:155]
buffer_load_dwordx4 a[76:79], v24, s[32:35], s62 offen offset:0 sc1
v_mfma_f32_16x16x32_bf16 v[184:187], v[232:235], a[28:31], v[184:187]
s_waitcnt lgkmcnt(8)
v_mfma_f32_16x16x32_bf16 v[92:95], v[236:239], a[16:19], v[92:95]
ds_read_b64_tr_b16 v[232:233], v48 offset:20480
s_add_u32 s51, s53, 0
v_mfma_f32_16x16x32_bf16 v[124:127], v[236:239], a[20:23], v[124:127]
ds_read_b64_tr_b16 v[234:235], v48 offset:22528
v_mfma_f32_16x16x32_bf16 v[156:159], v[236:239], a[24:27], v[156:159]
buffer_load_dwordx2 v[12:13], v58, s[32:35], s51 offen offset:1536 sc1
v_mfma_f32_16x16x32_bf16 v[188:191], v[236:239], a[28:31], v[188:191]
s_waitcnt vmcnt(16)
s_waitcnt lgkmcnt(8)
v_mfma_f32_16x16x32_bf16 v[64:67], v[240:243], a[32:35], v[64:67]
ds_read_b64_tr_b16 v[236:237], v49 offset:20480
v_mfma_f32_16x16x32_bf16 v[96:99], v[240:243], a[36:39], v[96:99]
ds_read_b64_tr_b16 v[238:239], v49 offset:22528
v_mfma_f32_16x16x32_bf16 v[128:131], v[240:243], a[40:43], v[128:131]
buffer_load_dwordx4 a[80:83], v5, s[32:35], s62 offen offset:1024 sc1
v_mfma_f32_16x16x32_bf16 v[160:163], v[240:243], a[44:47], v[160:163]
s_waitcnt lgkmcnt(8)
v_mfma_f32_16x16x32_bf16 v[68:71], v[244:247], a[32:35], v[68:71]
ds_read_b64_tr_b16 v[240:241], v50 offset:20480
s_add_u32 m0, s61, 16384
v_mfma_f32_16x16x32_bf16 v[100:103], v[244:247], a[36:39], v[100:103]
ds_read_b64_tr_b16 v[242:243], v50 offset:22528
s_mov_b32 s50, 995328
v_mfma_f32_16x16x32_bf16 v[132:135], v[244:247], a[40:43], v[132:135]
buffer_load_dwordx4 v22, s[16:19], s50 offen lds
v_mfma_f32_16x16x32_bf16 v[164:167], v[244:247], a[44:47], v[164:167]
s_waitcnt lgkmcnt(8)
v_mfma_f32_16x16x32_bf16 v[72:75], v[224:227], a[32:35], v[72:75]
ds_read_b64_tr_b16 v[244:245], v51 offset:20480
v_mfma_f32_16x16x32_bf16 v[104:107], v[224:227], a[36:39], v[104:107]
ds_read_b64_tr_b16 v[246:247], v51 offset:22528
v_mfma_f32_16x16x32_bf16 v[136:139], v[224:227], a[40:43], v[136:139]
buffer_load_dwordx4 a[84:87], v20, s[32:35], s62 offen offset:1024 sc1
v_mfma_f32_16x16x32_bf16 v[168:171], v[224:227], a[44:47], v[168:171]
s_waitcnt lgkmcnt(8)
v_mfma_f32_16x16x32_bf16 v[76:79], v[228:231], a[32:35], v[76:79]
ds_read_b64_tr_b16 v[224:225], v48 offset:24576
s_add_u32 s51, s53, 0
v_mfma_f32_16x16x32_bf16 v[108:111], v[228:231], a[36:39], v[108:111]
ds_read_b64_tr_b16 v[226:227], v48 offset:26624
v_mfma_f32_16x16x32_bf16 v[140:143], v[228:231], a[40:43], v[140:143]
buffer_load_dwordx2 v[14:15], v58, s[32:35], s51 offen offset:2048 sc1
v_mfma_f32_16x16x32_bf16 v[172:175], v[228:231], a[44:47], v[172:175]
s_waitcnt lgkmcnt(8)
v_mfma_f32_16x16x32_bf16 v[80:83], v[232:235], a[32:35], v[80:83]
ds_read_b64_tr_b16 v[228:229], v49 offset:24576
v_mfma_f32_16x16x32_bf16 v[112:115], v[232:235], a[36:39], v[112:115]
ds_read_b64_tr_b16 v[230:231], v49 offset:26624
v_mfma_f32_16x16x32_bf16 v[144:147], v[232:235], a[40:43], v[144:147]
buffer_load_dwordx4 a[88:91], v23, s[32:35], s62 offen offset:1024 sc1
v_mfma_f32_16x16x32_bf16 v[176:179], v[232:235], a[44:47], v[176:179]
s_waitcnt lgkmcnt(8)
v_mfma_f32_16x16x32_bf16 v[84:87], v[236:239], a[32:35], v[84:87]
ds_read_b64_tr_b16 v[232:233], v50 offset:24576
s_add_u32 m0, s61, 20480
v_mfma_f32_16x16x32_bf16 v[116:119], v[236:239], a[36:39], v[116:119]
ds_read_b64_tr_b16 v[234:235], v50 offset:26624
s_mov_b32 s50, 995328
v_mfma_f32_16x16x32_bf16 v[148:151], v[236:239], a[40:43], v[148:151]
buffer_load_dwordx4 v22, s[20:23], s50 offen lds
v_mfma_f32_16x16x32_bf16 v[180:183], v[236:239], a[44:47], v[180:183]
s_waitcnt lgkmcnt(8)
v_mfma_f32_16x16x32_bf16 v[88:91], v[240:243], a[32:35], v[88:91]
ds_read_b64_tr_b16 v[236:237], v51 offset:24576
v_mfma_f32_16x16x32_bf16 v[120:123], v[240:243], a[36:39], v[120:123]
ds_read_b64_tr_b16 v[238:239], v51 offset:26624
v_mfma_f32_16x16x32_bf16 v[152:155], v[240:243], a[40:43], v[152:155]
buffer_load_dwordx4 a[92:95], v24, s[32:35], s62 offen offset:1024 sc1
v_mfma_f32_16x16x32_bf16 v[184:187], v[240:243], a[44:47], v[184:187]
s_waitcnt lgkmcnt(8)
v_mfma_f32_16x16x32_bf16 v[92:95], v[244:247], a[32:35], v[92:95]
ds_read_b64_tr_b16 v[240:241], v48 offset:28672
s_add_u32 s51, s53, 2560
v_mfma_f32_16x16x32_bf16 v[124:127], v[244:247], a[36:39], v[124:127]
ds_read_b64_tr_b16 v[242:243], v48 offset:30720
v_mfma_f32_16x16x32_bf16 v[156:159], v[244:247], a[40:43], v[156:159]
buffer_load_dwordx2 v[16:17], v58, s[32:35], s51 offen offset:0 sc1
v_mfma_f32_16x16x32_bf16 v[188:191], v[244:247], a[44:47], v[188:191]
s_waitcnt vmcnt(17)
s_waitcnt lgkmcnt(8)
v_mfma_f32_16x16x32_bf16 v[64:67], v[224:227], a[48:51], v[64:67]
ds_read_b64_tr_b16 v[244:245], v49 offset:28672
v_mfma_f32_16x16x32_bf16 v[96:99], v[224:227], a[52:55], v[96:99]
ds_read_b64_tr_b16 v[246:247], v49 offset:30720
v_mfma_f32_16x16x32_bf16 v[128:131], v[224:227], a[56:59], v[128:131]
buffer_load_dwordx4 a[96:99], v5, s[32:35], s62 offen offset:2048 sc1
v_mfma_f32_16x16x32_bf16 v[160:163], v[224:227], a[60:63], v[160:163]
s_waitcnt lgkmcnt(8)
v_mfma_f32_16x16x32_bf16 v[68:71], v[228:231], a[48:51], v[68:71]
ds_read_b64_tr_b16 v[224:225], v50 offset:28672
s_add_u32 m0, s61, 24576
v_mfma_f32_16x16x32_bf16 v[100:103], v[228:231], a[52:55], v[100:103]
ds_read_b64_tr_b16 v[226:227], v50 offset:30720
s_mov_b32 s50, 1105920
v_mfma_f32_16x16x32_bf16 v[132:135], v[228:231], a[56:59], v[132:135]
buffer_load_dwordx4 v22, s[16:19], s50 offen lds
v_mfma_f32_16x16x32_bf16 v[164:167], v[228:231], a[60:63], v[164:167]
s_waitcnt lgkmcnt(8)
v_mfma_f32_16x16x32_bf16 v[72:75], v[232:235], a[48:51], v[72:75]
ds_read_b64_tr_b16 v[228:229], v51 offset:28672
v_mfma_f32_16x16x32_bf16 v[104:107], v[232:235], a[52:55], v[104:107]
ds_read_b64_tr_b16 v[230:231], v51 offset:30720
v_mfma_f32_16x16x32_bf16 v[136:139], v[232:235], a[56:59], v[136:139]
buffer_load_dwordx4 a[100:103], v20, s[32:35], s62 offen offset:2048 sc1
v_mfma_f32_16x16x32_bf16 v[168:171], v[232:235], a[60:63], v[168:171]
s_waitcnt lgkmcnt(8)
v_mfma_f32_16x16x32_bf16 v[76:79], v[236:239], a[48:51], v[76:79]
ds_read_b64_tr_b16 v[232:233], v48 offset:32768
s_add_u32 s51, s53, 2560
v_mfma_f32_16x16x32_bf16 v[108:111], v[236:239], a[52:55], v[108:111]
ds_read_b64_tr_b16 v[234:235], v48 offset:34816
v_mfma_f32_16x16x32_bf16 v[140:143], v[236:239], a[56:59], v[140:143]
buffer_load_dwordx2 v[18:19], v58, s[32:35], s51 offen offset:512 sc1
v_mfma_f32_16x16x32_bf16 v[172:175], v[236:239], a[60:63], v[172:175]
s_waitcnt lgkmcnt(8)
v_mfma_f32_16x16x32_bf16 v[80:83], v[240:243], a[48:51], v[80:83]
ds_read_b64_tr_b16 v[236:237], v49 offset:32768
v_mfma_f32_16x16x32_bf16 v[112:115], v[240:243], a[52:55], v[112:115]
ds_read_b64_tr_b16 v[238:239], v49 offset:34816
v_mfma_f32_16x16x32_bf16 v[144:147], v[240:243], a[56:59], v[144:147]
buffer_load_dwordx4 a[104:107], v23, s[32:35], s62 offen offset:2048 sc1
v_mfma_f32_16x16x32_bf16 v[176:179], v[240:243], a[60:63], v[176:179]
s_waitcnt lgkmcnt(8)
v_mfma_f32_16x16x32_bf16 v[84:87], v[244:247], a[48:51], v[84:87]
ds_read_b64_tr_b16 v[240:241], v50 offset:32768
s_add_u32 m0, s61, 28672
v_mfma_f32_16x16x32_bf16 v[116:119], v[244:247], a[52:55], v[116:119]
ds_read_b64_tr_b16 v[242:243], v50 offset:34816
s_mov_b32 s50, 1105920
v_mfma_f32_16x16x32_bf16 v[148:151], v[244:247], a[56:59], v[148:151]
buffer_load_dwordx4 v22, s[20:23], s50 offen lds
v_mfma_f32_16x16x32_bf16 v[180:183], v[244:247], a[60:63], v[180:183]
s_waitcnt lgkmcnt(8)
v_mfma_f32_16x16x32_bf16 v[88:91], v[224:227], a[48:51], v[88:91]
ds_read_b64_tr_b16 v[244:245], v51 offset:32768
v_mfma_f32_16x16x32_bf16 v[120:123], v[224:227], a[52:55], v[120:123]
ds_read_b64_tr_b16 v[246:247], v51 offset:34816
v_mfma_f32_16x16x32_bf16 v[152:155], v[224:227], a[56:59], v[152:155]
buffer_load_dwordx4 a[108:111], v24, s[32:35], s62 offen offset:2048 sc1
v_mfma_f32_16x16x32_bf16 v[184:187], v[224:227], a[60:63], v[184:187]
s_waitcnt lgkmcnt(8)
v_mfma_f32_16x16x32_bf16 v[92:95], v[228:231], a[48:51], v[92:95]
ds_read_b64_tr_b16 v[224:225], v48 offset:36864
s_add_u32 s51, s53, 2560
v_mfma_f32_16x16x32_bf16 v[124:127], v[228:231], a[52:55], v[124:127]
ds_read_b64_tr_b16 v[226:227], v48 offset:38912
v_mfma_f32_16x16x32_bf16 v[156:159], v[228:231], a[56:59], v[156:159]
buffer_load_dwordx2 v[26:27], v58, s[32:35], s51 offen offset:1024 sc1
v_mfma_f32_16x16x32_bf16 v[188:191], v[228:231], a[60:63], v[188:191]
s_waitcnt vmcnt(17)
s_waitcnt lgkmcnt(8)
v_mfma_f32_16x16x32_bf16 v[64:67], v[232:235], a[64:67], v[64:67]
ds_read_b64_tr_b16 v[228:229], v49 offset:36864
v_mfma_f32_16x16x32_bf16 v[96:99], v[232:235], a[68:71], v[96:99]
ds_read_b64_tr_b16 v[230:231], v49 offset:38912
v_mfma_f32_16x16x32_bf16 v[128:131], v[232:235], a[72:75], v[128:131]
buffer_load_dwordx4 a[112:115], v5, s[32:35], s62 offen offset:3072 sc1
v_mfma_f32_16x16x32_bf16 v[160:163], v[232:235], a[76:79], v[160:163]
s_waitcnt lgkmcnt(8)
v_mfma_f32_16x16x32_bf16 v[68:71], v[236:239], a[64:67], v[68:71]
ds_read_b64_tr_b16 v[232:233], v50 offset:36864
s_add_u32 m0, s61, 32768
v_mfma_f32_16x16x32_bf16 v[100:103], v[236:239], a[68:71], v[100:103]
ds_read_b64_tr_b16 v[234:235], v50 offset:38912
s_mov_b32 s50, 1216512
v_mfma_f32_16x16x32_bf16 v[132:135], v[236:239], a[72:75], v[132:135]
buffer_load_dwordx4 v22, s[16:19], s50 offen lds
v_mfma_f32_16x16x32_bf16 v[164:167], v[236:239], a[76:79], v[164:167]
s_waitcnt lgkmcnt(8)
v_mfma_f32_16x16x32_bf16 v[72:75], v[240:243], a[64:67], v[72:75]
ds_read_b64_tr_b16 v[236:237], v51 offset:36864
v_mfma_f32_16x16x32_bf16 v[104:107], v[240:243], a[68:71], v[104:107]
ds_read_b64_tr_b16 v[238:239], v51 offset:38912
v_mfma_f32_16x16x32_bf16 v[136:139], v[240:243], a[72:75], v[136:139]
buffer_load_dwordx4 a[116:119], v20, s[32:35], s62 offen offset:3072 sc1
v_mfma_f32_16x16x32_bf16 v[168:171], v[240:243], a[76:79], v[168:171]
s_waitcnt lgkmcnt(8)
v_mfma_f32_16x16x32_bf16 v[76:79], v[244:247], a[64:67], v[76:79]
ds_read_b64_tr_b16 v[240:241], v48 offset:40960
s_add_u32 s51, s53, 2560
v_mfma_f32_16x16x32_bf16 v[108:111], v[244:247], a[68:71], v[108:111]
ds_read_b64_tr_b16 v[242:243], v48 offset:43008
v_mfma_f32_16x16x32_bf16 v[140:143], v[244:247], a[72:75], v[140:143]
buffer_load_dwordx2 v[28:29], v58, s[32:35], s51 offen offset:1536 sc1
v_mfma_f32_16x16x32_bf16 v[172:175], v[244:247], a[76:79], v[172:175]
s_waitcnt lgkmcnt(8)
v_mfma_f32_16x16x32_bf16 v[80:83], v[224:227], a[64:67], v[80:83]
ds_read_b64_tr_b16 v[244:245], v49 offset:40960
v_mfma_f32_16x16x32_bf16 v[112:115], v[224:227], a[68:71], v[112:115]
ds_read_b64_tr_b16 v[246:247], v49 offset:43008
v_mfma_f32_16x16x32_bf16 v[144:147], v[224:227], a[72:75], v[144:147]
buffer_load_dwordx4 a[120:123], v23, s[32:35], s62 offen offset:3072 sc1
v_mfma_f32_16x16x32_bf16 v[176:179], v[224:227], a[76:79], v[176:179]
s_waitcnt lgkmcnt(8)
v_mfma_f32_16x16x32_bf16 v[84:87], v[228:231], a[64:67], v[84:87]
ds_read_b64_tr_b16 v[224:225], v50 offset:40960
s_add_u32 m0, s61, 36864
v_mfma_f32_16x16x32_bf16 v[116:119], v[228:231], a[68:71], v[116:119]
ds_read_b64_tr_b16 v[226:227], v50 offset:43008
s_mov_b32 s50, 1216512
v_mfma_f32_16x16x32_bf16 v[148:151], v[228:231], a[72:75], v[148:151]
buffer_load_dwordx4 v22, s[20:23], s50 offen lds
v_mfma_f32_16x16x32_bf16 v[180:183], v[228:231], a[76:79], v[180:183]
s_waitcnt lgkmcnt(8)
v_mfma_f32_16x16x32_bf16 v[88:91], v[232:235], a[64:67], v[88:91]
ds_read_b64_tr_b16 v[228:229], v51 offset:40960
v_mfma_f32_16x16x32_bf16 v[120:123], v[232:235], a[68:71], v[120:123]
ds_read_b64_tr_b16 v[230:231], v51 offset:43008
v_mfma_f32_16x16x32_bf16 v[152:155], v[232:235], a[72:75], v[152:155]
buffer_load_dwordx4 a[124:127], v24, s[32:35], s62 offen offset:3072 sc1
v_mfma_f32_16x16x32_bf16 v[184:187], v[232:235], a[76:79], v[184:187]
s_waitcnt lgkmcnt(8)
v_mfma_f32_16x16x32_bf16 v[92:95], v[236:239], a[64:67], v[92:95]
ds_read_b64_tr_b16 v[232:233], v48 offset:45056
s_add_u32 s51, s53, 2560
v_mfma_f32_16x16x32_bf16 v[124:127], v[236:239], a[68:71], v[124:127]
ds_read_b64_tr_b16 v[234:235], v48 offset:47104
v_mfma_f32_16x16x32_bf16 v[156:159], v[236:239], a[72:75], v[156:159]
buffer_load_dwordx2 v[30:31], v58, s[32:35], s51 offen offset:2048 sc1
v_mfma_f32_16x16x32_bf16 v[188:191], v[236:239], a[76:79], v[188:191]
s_waitcnt vmcnt(17)
s_waitcnt lgkmcnt(8)
v_mfma_f32_16x16x32_bf16 v[64:67], v[240:243], a[80:83], v[64:67]
ds_read_b64_tr_b16 v[236:237], v49 offset:45056
s_mov_b32 s62, 8192
v_mfma_f32_16x16x32_bf16 v[96:99], v[240:243], a[84:87], v[96:99]
ds_read_b64_tr_b16 v[238:239], v49 offset:47104
v_mfma_f32_16x16x32_bf16 v[128:131], v[240:243], a[88:91], v[128:131]
buffer_load_dwordx4 a[128:131], v5, s[32:35], s62 offen offset:0 sc1
v_mfma_f32_16x16x32_bf16 v[160:163], v[240:243], a[92:95], v[160:163]
s_waitcnt lgkmcnt(8)
v_mfma_f32_16x16x32_bf16 v[68:71], v[244:247], a[80:83], v[68:71]
ds_read_b64_tr_b16 v[240:241], v50 offset:45056
s_add_u32 m0, s61, 40960
v_mfma_f32_16x16x32_bf16 v[100:103], v[244:247], a[84:87], v[100:103]
ds_read_b64_tr_b16 v[242:243], v50 offset:47104
s_mov_b32 s50, 1327104
v_mfma_f32_16x16x32_bf16 v[132:135], v[244:247], a[88:91], v[132:135]
buffer_load_dwordx4 v22, s[16:19], s50 offen lds
v_mfma_f32_16x16x32_bf16 v[164:167], v[244:247], a[92:95], v[164:167]
s_waitcnt lgkmcnt(8)
v_mfma_f32_16x16x32_bf16 v[72:75], v[224:227], a[80:83], v[72:75]
ds_read_b64_tr_b16 v[244:245], v51 offset:45056
v_mfma_f32_16x16x32_bf16 v[104:107], v[224:227], a[84:87], v[104:107]
ds_read_b64_tr_b16 v[246:247], v51 offset:47104
v_mfma_f32_16x16x32_bf16 v[136:139], v[224:227], a[88:91], v[136:139]
buffer_load_dwordx4 a[132:135], v20, s[32:35], s62 offen offset:0 sc1
v_mfma_f32_16x16x32_bf16 v[168:171], v[224:227], a[92:95], v[168:171]
s_waitcnt lgkmcnt(8)
v_mfma_f32_16x16x32_bf16 v[76:79], v[228:231], a[80:83], v[76:79]
ds_read_b64_tr_b16 v[224:225], v48 offset:49152
s_add_u32 s51, s53, 5120
v_mfma_f32_16x16x32_bf16 v[108:111], v[228:231], a[84:87], v[108:111]
ds_read_b64_tr_b16 v[226:227], v48 offset:51200
v_mfma_f32_16x16x32_bf16 v[140:143], v[228:231], a[88:91], v[140:143]
buffer_load_dwordx2 v[32:33], v58, s[32:35], s51 offen offset:0 sc1
v_mfma_f32_16x16x32_bf16 v[172:175], v[228:231], a[92:95], v[172:175]
s_waitcnt lgkmcnt(8)
v_mfma_f32_16x16x32_bf16 v[80:83], v[232:235], a[80:83], v[80:83]
ds_read_b64_tr_b16 v[228:229], v49 offset:49152
v_mfma_f32_16x16x32_bf16 v[112:115], v[232:235], a[84:87], v[112:115]
ds_read_b64_tr_b16 v[230:231], v49 offset:51200
v_mfma_f32_16x16x32_bf16 v[144:147], v[232:235], a[88:91], v[144:147]
buffer_load_dwordx4 a[136:139], v23, s[32:35], s62 offen offset:0 sc1
v_mfma_f32_16x16x32_bf16 v[176:179], v[232:235], a[92:95], v[176:179]
s_waitcnt lgkmcnt(8)
v_mfma_f32_16x16x32_bf16 v[84:87], v[236:239], a[80:83], v[84:87]
ds_read_b64_tr_b16 v[232:233], v50 offset:49152
s_add_u32 m0, s61, 45056
v_mfma_f32_16x16x32_bf16 v[116:119], v[236:239], a[84:87], v[116:119]
ds_read_b64_tr_b16 v[234:235], v50 offset:51200
s_mov_b32 s50, 1327104
v_mfma_f32_16x16x32_bf16 v[148:151], v[236:239], a[88:91], v[148:151]
buffer_load_dwordx4 v22, s[20:23], s50 offen lds
v_mfma_f32_16x16x32_bf16 v[180:183], v[236:239], a[92:95], v[180:183]
s_waitcnt lgkmcnt(8)
v_mfma_f32_16x16x32_bf16 v[88:91], v[240:243], a[80:83], v[88:91]
ds_read_b64_tr_b16 v[236:237], v51 offset:49152
v_mfma_f32_16x16x32_bf16 v[120:123], v[240:243], a[84:87], v[120:123]
ds_read_b64_tr_b16 v[238:239], v51 offset:51200
v_mfma_f32_16x16x32_bf16 v[152:155], v[240:243], a[88:91], v[152:155]
buffer_load_dwordx4 a[140:143], v24, s[32:35], s62 offen offset:0 sc1
v_mfma_f32_16x16x32_bf16 v[184:187], v[240:243], a[92:95], v[184:187]
s_waitcnt lgkmcnt(8)
v_mfma_f32_16x16x32_bf16 v[92:95], v[244:247], a[80:83], v[92:95]
ds_read_b64_tr_b16 v[240:241], v48 offset:53248
s_add_u32 s51, s53, 5120
v_mfma_f32_16x16x32_bf16 v[124:127], v[244:247], a[84:87], v[124:127]
ds_read_b64_tr_b16 v[242:243], v48 offset:55296
v_mfma_f32_16x16x32_bf16 v[156:159], v[244:247], a[88:91], v[156:159]
buffer_load_dwordx2 v[34:35], v58, s[32:35], s51 offen offset:512 sc1
v_mfma_f32_16x16x32_bf16 v[188:191], v[244:247], a[92:95], v[188:191]
s_waitcnt vmcnt(17)
s_waitcnt lgkmcnt(8)
v_mfma_f32_16x16x32_bf16 v[64:67], v[224:227], a[96:99], v[64:67]
ds_read_b64_tr_b16 v[244:245], v49 offset:53248
v_mfma_f32_16x16x32_bf16 v[96:99], v[224:227], a[100:103], v[96:99]
ds_read_b64_tr_b16 v[246:247], v49 offset:55296
v_mfma_f32_16x16x32_bf16 v[128:131], v[224:227], a[104:107], v[128:131]
buffer_load_dwordx4 a[144:147], v5, s[32:35], s62 offen offset:1024 sc1
v_mfma_f32_16x16x32_bf16 v[160:163], v[224:227], a[108:111], v[160:163]
s_waitcnt lgkmcnt(8)
v_mfma_f32_16x16x32_bf16 v[68:71], v[228:231], a[96:99], v[68:71]
ds_read_b64_tr_b16 v[224:225], v50 offset:53248
s_add_u32 m0, s61, 49152
v_mfma_f32_16x16x32_bf16 v[100:103], v[228:231], a[100:103], v[100:103]
ds_read_b64_tr_b16 v[226:227], v50 offset:55296
s_mov_b32 s50, 1437696
v_mfma_f32_16x16x32_bf16 v[132:135], v[228:231], a[104:107], v[132:135]
buffer_load_dwordx4 v22, s[16:19], s50 offen lds
v_mfma_f32_16x16x32_bf16 v[164:167], v[228:231], a[108:111], v[164:167]
s_waitcnt lgkmcnt(8)
v_mfma_f32_16x16x32_bf16 v[72:75], v[232:235], a[96:99], v[72:75]
ds_read_b64_tr_b16 v[228:229], v51 offset:53248
v_mfma_f32_16x16x32_bf16 v[104:107], v[232:235], a[100:103], v[104:107]
ds_read_b64_tr_b16 v[230:231], v51 offset:55296
v_mfma_f32_16x16x32_bf16 v[136:139], v[232:235], a[104:107], v[136:139]
buffer_load_dwordx4 a[148:151], v20, s[32:35], s62 offen offset:1024 sc1
v_mfma_f32_16x16x32_bf16 v[168:171], v[232:235], a[108:111], v[168:171]
s_waitcnt lgkmcnt(8)
v_mfma_f32_16x16x32_bf16 v[76:79], v[236:239], a[96:99], v[76:79]
s_add_u32 s51, s53, 5120
buffer_load_dwordx2 v[36:37], v58, s[32:35], s51 offen offset:1024 sc1
s_barrier
v_add_u32 v48, 0xfffe6000, v48
v_add_u32 v49, 0xfffe6000, v49
v_add_u32 v50, 0xfffe6000, v50
v_add_u32 v51, 0xfffe6000, v51
ds_read_b64_tr_b16 v[232:233], v48 offset:0
v_mfma_f32_16x16x32_bf16 v[108:111], v[236:239], a[100:103], v[108:111]
ds_read_b64_tr_b16 v[234:235], v48 offset:2048
v_mfma_f32_16x16x32_bf16 v[140:143], v[236:239], a[104:107], v[140:143]
v_mfma_f32_16x16x32_bf16 v[172:175], v[236:239], a[108:111], v[172:175]
s_waitcnt lgkmcnt(8)
v_mfma_f32_16x16x32_bf16 v[80:83], v[240:243], a[96:99], v[80:83]
ds_read_b64_tr_b16 v[236:237], v49 offset:0
v_mfma_f32_16x16x32_bf16 v[112:115], v[240:243], a[100:103], v[112:115]
ds_read_b64_tr_b16 v[238:239], v49 offset:2048
v_mfma_f32_16x16x32_bf16 v[144:147], v[240:243], a[104:107], v[144:147]
buffer_load_dwordx4 a[152:155], v23, s[32:35], s62 offen offset:1024 sc1
v_mfma_f32_16x16x32_bf16 v[176:179], v[240:243], a[108:111], v[176:179]
s_waitcnt lgkmcnt(8)
v_mfma_f32_16x16x32_bf16 v[84:87], v[244:247], a[96:99], v[84:87]
ds_read_b64_tr_b16 v[240:241], v50 offset:0
s_add_u32 m0, s61, 53248
v_mfma_f32_16x16x32_bf16 v[116:119], v[244:247], a[100:103], v[116:119]
ds_read_b64_tr_b16 v[242:243], v50 offset:2048
s_mov_b32 s50, 1437696
v_mfma_f32_16x16x32_bf16 v[148:151], v[244:247], a[104:107], v[148:151]
buffer_load_dwordx4 v22, s[20:23], s50 offen lds
v_mfma_f32_16x16x32_bf16 v[180:183], v[244:247], a[108:111], v[180:183]
s_waitcnt lgkmcnt(8)
v_mfma_f32_16x16x32_bf16 v[88:91], v[224:227], a[96:99], v[88:91]
ds_read_b64_tr_b16 v[244:245], v51 offset:0
v_mfma_f32_16x16x32_bf16 v[120:123], v[224:227], a[100:103], v[120:123]
ds_read_b64_tr_b16 v[246:247], v51 offset:2048
v_mfma_f32_16x16x32_bf16 v[152:155], v[224:227], a[104:107], v[152:155]
buffer_load_dwordx4 a[156:159], v24, s[32:35], s62 offen offset:1024 sc1
v_mfma_f32_16x16x32_bf16 v[184:187], v[224:227], a[108:111], v[184:187]
s_waitcnt lgkmcnt(8)
v_mfma_f32_16x16x32_bf16 v[92:95], v[228:231], a[96:99], v[92:95]
ds_read_b64_tr_b16 v[224:225], v48 offset:4096
s_add_u32 s51, s53, 5120
v_mfma_f32_16x16x32_bf16 v[124:127], v[228:231], a[100:103], v[124:127]
ds_read_b64_tr_b16 v[226:227], v48 offset:6144
v_mfma_f32_16x16x32_bf16 v[156:159], v[228:231], a[104:107], v[156:159]
buffer_load_dwordx2 v[38:39], v58, s[32:35], s51 offen offset:1536 sc1
v_mfma_f32_16x16x32_bf16 v[188:191], v[228:231], a[108:111], v[188:191]
s_waitcnt vmcnt(17)
s_waitcnt lgkmcnt(8)
v_mfma_f32_16x16x32_bf16 v[64:67], v[232:235], a[112:115], v[64:67]
ds_read_b64_tr_b16 v[228:229], v49 offset:4096
v_mfma_f32_16x16x32_bf16 v[96:99], v[232:235], a[116:119], v[96:99]
ds_read_b64_tr_b16 v[230:231], v49 offset:6144
v_mfma_f32_16x16x32_bf16 v[128:131], v[232:235], a[120:123], v[128:131]
buffer_load_dwordx4 a[160:163], v5, s[32:35], s62 offen offset:2048 sc1
v_mfma_f32_16x16x32_bf16 v[160:163], v[232:235], a[124:127], v[160:163]
s_waitcnt lgkmcnt(8)
v_mfma_f32_16x16x32_bf16 v[68:71], v[236:239], a[112:115], v[68:71]
ds_read_b64_tr_b16 v[232:233], v50 offset:4096
s_add_u32 m0, s61, 57344
v_mfma_f32_16x16x32_bf16 v[100:103], v[236:239], a[116:119], v[100:103]
ds_read_b64_tr_b16 v[234:235], v50 offset:6144
s_mov_b32 s50, 1548288
v_mfma_f32_16x16x32_bf16 v[132:135], v[236:239], a[120:123], v[132:135]
buffer_load_dwordx4 v22, s[16:19], s50 offen lds
v_mfma_f32_16x16x32_bf16 v[164:167], v[236:239], a[124:127], v[164:167]
s_waitcnt lgkmcnt(8)
v_mfma_f32_16x16x32_bf16 v[72:75], v[240:243], a[112:115], v[72:75]
ds_read_b64_tr_b16 v[236:237], v51 offset:4096
v_mfma_f32_16x16x32_bf16 v[104:107], v[240:243], a[116:119], v[104:107]
ds_read_b64_tr_b16 v[238:239], v51 offset:6144
v_mfma_f32_16x16x32_bf16 v[136:139], v[240:243], a[120:123], v[136:139]
buffer_load_dwordx4 a[164:167], v20, s[32:35], s62 offen offset:2048 sc1
v_mfma_f32_16x16x32_bf16 v[168:171], v[240:243], a[124:127], v[168:171]
s_waitcnt lgkmcnt(8)
v_mfma_f32_16x16x32_bf16 v[76:79], v[244:247], a[112:115], v[76:79]
ds_read_b64_tr_b16 v[240:241], v48 offset:8192
s_add_u32 s51, s53, 5120
v_mfma_f32_16x16x32_bf16 v[108:111], v[244:247], a[116:119], v[108:111]
ds_read_b64_tr_b16 v[242:243], v48 offset:10240
v_mfma_f32_16x16x32_bf16 v[140:143], v[244:247], a[120:123], v[140:143]
buffer_load_dwordx2 v[40:41], v58, s[32:35], s51 offen offset:2048 sc1
v_mfma_f32_16x16x32_bf16 v[172:175], v[244:247], a[124:127], v[172:175]
s_waitcnt lgkmcnt(8)
v_mfma_f32_16x16x32_bf16 v[80:83], v[224:227], a[112:115], v[80:83]
ds_read_b64_tr_b16 v[244:245], v49 offset:8192
v_mfma_f32_16x16x32_bf16 v[112:115], v[224:227], a[116:119], v[112:115]
ds_read_b64_tr_b16 v[246:247], v49 offset:10240
v_mfma_f32_16x16x32_bf16 v[144:147], v[224:227], a[120:123], v[144:147]
buffer_load_dwordx4 a[168:171], v23, s[32:35], s62 offen offset:2048 sc1
v_mfma_f32_16x16x32_bf16 v[176:179], v[224:227], a[124:127], v[176:179]
s_add_u32 m0, s61, 106496
s_waitcnt lgkmcnt(8)
v_mfma_f32_16x16x32_bf16 v[84:87], v[228:231], a[112:115], v[84:87]
ds_read_b64_tr_b16 v[224:225], v50 offset:8192
s_mov_b32 s50, 0
v_mfma_f32_16x16x32_bf16 v[116:119], v[228:231], a[116:119], v[116:119]
ds_read_b64_tr_b16 v[226:227], v50 offset:10240
v_mfma_f32_16x16x32_bf16 v[148:151], v[228:231], a[120:123], v[148:151]
buffer_load_dwordx4 v21, s[24:27], s50 offen lds
v_mfma_f32_16x16x32_bf16 v[180:183], v[228:231], a[124:127], v[180:183]
s_add_u32 m0, s61, 61440
s_waitcnt lgkmcnt(8)
v_mfma_f32_16x16x32_bf16 v[88:91], v[232:235], a[112:115], v[88:91]
ds_read_b64_tr_b16 v[228:229], v51 offset:8192
s_mov_b32 s50, 1548288
v_mfma_f32_16x16x32_bf16 v[120:123], v[232:235], a[116:119], v[120:123]
ds_read_b64_tr_b16 v[230:231], v51 offset:10240
v_mfma_f32_16x16x32_bf16 v[152:155], v[232:235], a[120:123], v[152:155]
buffer_load_dwordx4 v22, s[20:23], s50 offen lds
v_mfma_f32_16x16x32_bf16 v[184:187], v[232:235], a[124:127], v[184:187]
buffer_load_dwordx4 a[172:175], v24, s[32:35], s62 offen offset:2048 sc1
s_waitcnt lgkmcnt(8)
v_mfma_f32_16x16x32_bf16 v[92:95], v[236:239], a[112:115], v[92:95]
ds_read_b64_tr_b16 v[232:233], v48 offset:12288
s_add_u32 s51, s53, 7680
v_mfma_f32_16x16x32_bf16 v[124:127], v[236:239], a[116:119], v[124:127]
ds_read_b64_tr_b16 v[234:235], v48 offset:14336
v_mfma_f32_16x16x32_bf16 v[156:159], v[236:239], a[120:123], v[156:159]
buffer_load_dwordx2 v[42:43], v58, s[32:35], s51 offen offset:0 sc1
v_mfma_f32_16x16x32_bf16 v[188:191], v[236:239], a[124:127], v[188:191]
s_waitcnt vmcnt(18)
s_waitcnt lgkmcnt(8)
v_mfma_f32_16x16x32_bf16 v[64:67], v[240:243], a[128:131], v[64:67]
ds_read_b64_tr_b16 v[236:237], v49 offset:12288
v_mfma_f32_16x16x32_bf16 v[96:99], v[240:243], a[132:135], v[96:99]
ds_read_b64_tr_b16 v[238:239], v49 offset:14336
v_mfma_f32_16x16x32_bf16 v[128:131], v[240:243], a[136:139], v[128:131]
buffer_load_dwordx4 a[176:179], v5, s[32:35], s62 offen offset:3072 sc1
v_mfma_f32_16x16x32_bf16 v[160:163], v[240:243], a[140:143], v[160:163]
s_add_u32 m0, s61, 110592
s_waitcnt lgkmcnt(8)
v_mfma_f32_16x16x32_bf16 v[68:71], v[244:247], a[128:131], v[68:71]
ds_read_b64_tr_b16 v[240:241], v50 offset:12288
s_mov_b32 s50, 40960
v_mfma_f32_16x16x32_bf16 v[100:103], v[244:247], a[132:135], v[100:103]
ds_read_b64_tr_b16 v[242:243], v50 offset:14336
v_mfma_f32_16x16x32_bf16 v[132:135], v[244:247], a[136:139], v[132:135]
buffer_load_dwordx4 v21, s[24:27], s50 offen lds
v_mfma_f32_16x16x32_bf16 v[164:167], v[244:247], a[140:143], v[164:167]
s_add_u32 m0, s61, 65536
s_waitcnt lgkmcnt(8)
v_mfma_f32_16x16x32_bf16 v[72:75], v[224:227], a[128:131], v[72:75]
ds_read_b64_tr_b16 v[244:245], v51 offset:12288
s_mov_b32 s50, 1658880
v_mfma_f32_16x16x32_bf16 v[104:107], v[224:227], a[132:135], v[104:107]
ds_read_b64_tr_b16 v[246:247], v51 offset:14336
v_mfma_f32_16x16x32_bf16 v[136:139], v[224:227], a[136:139], v[136:139]
buffer_load_dwordx4 v22, s[16:19], s50 offen lds
v_mfma_f32_16x16x32_bf16 v[168:171], v[224:227], a[140:143], v[168:171]
buffer_load_dwordx4 a[180:183], v20, s[32:35], s62 offen offset:3072 sc1
s_waitcnt lgkmcnt(8)
v_mfma_f32_16x16x32_bf16 v[76:79], v[228:231], a[128:131], v[76:79]
ds_read_b64_tr_b16 v[224:225], v48 offset:16384
s_add_u32 s51, s53, 7680
v_mfma_f32_16x16x32_bf16 v[108:111], v[228:231], a[132:135], v[108:111]
ds_read_b64_tr_b16 v[226:227], v48 offset:18432
v_mfma_f32_16x16x32_bf16 v[140:143], v[228:231], a[136:139], v[140:143]
buffer_load_dwordx2 v[44:45], v58, s[32:35], s51 offen offset:512 sc1
v_mfma_f32_16x16x32_bf16 v[172:175], v[228:231], a[140:143], v[172:175]
s_waitcnt lgkmcnt(8)
v_mfma_f32_16x16x32_bf16 v[80:83], v[232:235], a[128:131], v[80:83]
ds_read_b64_tr_b16 v[228:229], v49 offset:16384
v_mfma_f32_16x16x32_bf16 v[112:115], v[232:235], a[132:135], v[112:115]
ds_read_b64_tr_b16 v[230:231], v49 offset:18432
v_mfma_f32_16x16x32_bf16 v[144:147], v[232:235], a[136:139], v[144:147]
buffer_load_dwordx4 a[184:187], v23, s[32:35], s62 offen offset:3072 sc1
v_mfma_f32_16x16x32_bf16 v[176:179], v[232:235], a[140:143], v[176:179]
s_add_u32 m0, s61, 114688
s_waitcnt lgkmcnt(8)
v_mfma_f32_16x16x32_bf16 v[84:87], v[236:239], a[128:131], v[84:87]
ds_read_b64_tr_b16 v[232:233], v50 offset:16384
s_mov_b32 s50, 81920
v_mfma_f32_16x16x32_bf16 v[116:119], v[236:239], a[132:135], v[116:119]
ds_read_b64_tr_b16 v[234:235], v50 offset:18432
v_mfma_f32_16x16x32_bf16 v[148:151], v[236:239], a[136:139], v[148:151]
buffer_load_dwordx4 v21, s[24:27], s50 offen lds
v_mfma_f32_16x16x32_bf16 v[180:183], v[236:239], a[140:143], v[180:183]
s_add_u32 m0, s61, 69632
s_waitcnt lgkmcnt(8)
v_mfma_f32_16x16x32_bf16 v[88:91], v[240:243], a[128:131], v[88:91]
ds_read_b64_tr_b16 v[236:237], v51 offset:16384
s_mov_b32 s50, 1658880
v_mfma_f32_16x16x32_bf16 v[120:123], v[240:243], a[132:135], v[120:123]
ds_read_b64_tr_b16 v[238:239], v51 offset:18432
v_mfma_f32_16x16x32_bf16 v[152:155], v[240:243], a[136:139], v[152:155]
buffer_load_dwordx4 v22, s[20:23], s50 offen lds
v_mfma_f32_16x16x32_bf16 v[184:187], v[240:243], a[140:143], v[184:187]
buffer_load_dwordx4 a[188:191], v24, s[32:35], s62 offen offset:3072 sc1
s_waitcnt lgkmcnt(8)
v_mfma_f32_16x16x32_bf16 v[92:95], v[244:247], a[128:131], v[92:95]
ds_read_b64_tr_b16 v[240:241], v48 offset:20480
s_add_u32 s51, s53, 7680
v_mfma_f32_16x16x32_bf16 v[124:127], v[244:247], a[132:135], v[124:127]
ds_read_b64_tr_b16 v[242:243], v48 offset:22528
v_mfma_f32_16x16x32_bf16 v[156:159], v[244:247], a[136:139], v[156:159]
buffer_load_dwordx2 v[52:53], v58, s[32:35], s51 offen offset:1024 sc1
v_mfma_f32_16x16x32_bf16 v[188:191], v[244:247], a[140:143], v[188:191]
s_waitcnt vmcnt(20)
s_waitcnt lgkmcnt(8)
v_mfma_f32_16x16x32_bf16 v[64:67], v[224:227], a[144:147], v[64:67]
ds_read_b64_tr_b16 v[244:245], v49 offset:20480
s_mov_b32 s62, 12288
v_mfma_f32_16x16x32_bf16 v[96:99], v[224:227], a[148:151], v[96:99]
ds_read_b64_tr_b16 v[246:247], v49 offset:22528
v_mfma_f32_16x16x32_bf16 v[128:131], v[224:227], a[152:155], v[128:131]
buffer_load_dwordx4 a[192:195], v5, s[32:35], s62 offen offset:0 sc1
v_mfma_f32_16x16x32_bf16 v[160:163], v[224:227], a[156:159], v[160:163]
s_add_u32 m0, s61, 118784
s_waitcnt lgkmcnt(8)
v_mfma_f32_16x16x32_bf16 v[68:71], v[228:231], a[144:147], v[68:71]
ds_read_b64_tr_b16 v[224:225], v50 offset:20480
s_mov_b32 s50, 122880
v_mfma_f32_16x16x32_bf16 v[100:103], v[228:231], a[148:151], v[100:103]
ds_read_b64_tr_b16 v[226:227], v50 offset:22528
v_mfma_f32_16x16x32_bf16 v[132:135], v[228:231], a[152:155], v[132:135]
buffer_load_dwordx4 v21, s[24:27], s50 offen lds
v_mfma_f32_16x16x32_bf16 v[164:167], v[228:231], a[156:159], v[164:167]
s_add_u32 m0, s61, 73728
s_waitcnt lgkmcnt(8)
v_mfma_f32_16x16x32_bf16 v[72:75], v[232:235], a[144:147], v[72:75]
ds_read_b64_tr_b16 v[228:229], v51 offset:20480
s_mov_b32 s50, 1769472
v_mfma_f32_16x16x32_bf16 v[104:107], v[232:235], a[148:151], v[104:107]
ds_read_b64_tr_b16 v[230:231], v51 offset:22528
v_mfma_f32_16x16x32_bf16 v[136:139], v[232:235], a[152:155], v[136:139]
buffer_load_dwordx4 v22, s[16:19], s50 offen lds
v_mfma_f32_16x16x32_bf16 v[168:171], v[232:235], a[156:159], v[168:171]
buffer_load_dwordx4 a[196:199], v20, s[32:35], s62 offen offset:0 sc1
s_waitcnt lgkmcnt(8)
v_mfma_f32_16x16x32_bf16 v[76:79], v[236:239], a[144:147], v[76:79]
s_add_u32 s51, s53, 7680
buffer_load_dwordx2 v[54:55], v58, s[32:35], s51 offen offset:1536 sc1
s_barrier
ds_read_b64_tr_b16 v[232:233], v48 offset:24576
v_mfma_f32_16x16x32_bf16 v[108:111], v[236:239], a[148:151], v[108:111]
ds_read_b64_tr_b16 v[234:235], v48 offset:26624
v_mfma_f32_16x16x32_bf16 v[140:143], v[236:239], a[152:155], v[140:143]
v_mfma_f32_16x16x32_bf16 v[172:175], v[236:239], a[156:159], v[172:175]
s_waitcnt lgkmcnt(8)
v_mfma_f32_16x16x32_bf16 v[80:83], v[240:243], a[144:147], v[80:83]
ds_read_b64_tr_b16 v[236:237], v49 offset:24576
v_mfma_f32_16x16x32_bf16 v[112:115], v[240:243], a[148:151], v[112:115]
ds_read_b64_tr_b16 v[238:239], v49 offset:26624
v_mfma_f32_16x16x32_bf16 v[144:147], v[240:243], a[152:155], v[144:147]
buffer_load_dwordx4 a[200:203], v23, s[32:35], s62 offen offset:0 sc1
v_mfma_f32_16x16x32_bf16 v[176:179], v[240:243], a[156:159], v[176:179]
s_add_u32 m0, s61, 122880
s_waitcnt lgkmcnt(8)
v_mfma_f32_16x16x32_bf16 v[84:87], v[244:247], a[144:147], v[84:87]
ds_read_b64_tr_b16 v[240:241], v50 offset:24576
s_mov_b32 s50, 163840
v_mfma_f32_16x16x32_bf16 v[116:119], v[244:247], a[148:151], v[116:119]
ds_read_b64_tr_b16 v[242:243], v50 offset:26624
v_mfma_f32_16x16x32_bf16 v[148:151], v[244:247], a[152:155], v[148:151]
buffer_load_dwordx4 v21, s[24:27], s50 offen lds
v_mfma_f32_16x16x32_bf16 v[180:183], v[244:247], a[156:159], v[180:183]
s_add_u32 m0, s61, 77824
s_waitcnt lgkmcnt(8)
v_mfma_f32_16x16x32_bf16 v[88:91], v[224:227], a[144:147], v[88:91]
ds_read_b64_tr_b16 v[244:245], v51 offset:24576
s_mov_b32 s50, 1769472
v_mfma_f32_16x16x32_bf16 v[120:123], v[224:227], a[148:151], v[120:123]
ds_read_b64_tr_b16 v[246:247], v51 offset:26624
v_mfma_f32_16x16x32_bf16 v[152:155], v[224:227], a[152:155], v[152:155]
buffer_load_dwordx4 v22, s[20:23], s50 offen lds
v_mfma_f32_16x16x32_bf16 v[184:187], v[224:227], a[156:159], v[184:187]
buffer_load_dwordx4 a[204:207], v24, s[32:35], s62 offen offset:0 sc1
s_waitcnt lgkmcnt(8)
v_mfma_f32_16x16x32_bf16 v[92:95], v[228:231], a[144:147], v[92:95]
ds_read_b64_tr_b16 v[224:225], v48 offset:28672
s_add_u32 s51, s53, 7680
v_mfma_f32_16x16x32_bf16 v[124:127], v[228:231], a[148:151], v[124:127]
ds_read_b64_tr_b16 v[226:227], v48 offset:30720
v_mfma_f32_16x16x32_bf16 v[156:159], v[228:231], a[152:155], v[156:159]
buffer_load_dwordx2 v[56:57], v58, s[32:35], s51 offen offset:2048 sc1
v_mfma_f32_16x16x32_bf16 v[188:191], v[228:231], a[156:159], v[188:191]
s_waitcnt vmcnt(21)
s_waitcnt lgkmcnt(8)
v_mfma_f32_16x16x32_bf16 v[64:67], v[232:235], a[160:163], v[64:67]
ds_read_b64_tr_b16 v[228:229], v49 offset:28672
v_mfma_f32_16x16x32_bf16 v[96:99], v[232:235], a[164:167], v[96:99]
ds_read_b64_tr_b16 v[230:231], v49 offset:30720
v_mfma_f32_16x16x32_bf16 v[128:131], v[232:235], a[168:171], v[128:131]
buffer_load_dwordx4 a[208:211], v5, s[32:35], s62 offen offset:1024 sc1
v_mfma_f32_16x16x32_bf16 v[160:163], v[232:235], a[172:175], v[160:163]
s_add_u32 m0, s61, 126976
s_mov_b32 s50, 204800
buffer_load_dwordx4 v21, s[24:27], s50 offen lds
s_waitcnt lgkmcnt(8)
v_mfma_f32_16x16x32_bf16 v[68:71], v[236:239], a[160:163], v[68:71]
ds_read_b64_tr_b16 v[232:233], v50 offset:28672
s_add_u32 m0, s61, 81920
v_mfma_f32_16x16x32_bf16 v[100:103], v[236:239], a[164:167], v[100:103]
ds_read_b64_tr_b16 v[234:235], v50 offset:30720
s_mov_b32 s50, 1880064
v_mfma_f32_16x16x32_bf16 v[132:135], v[236:239], a[168:171], v[132:135]
buffer_load_dwordx4 v22, s[16:19], s50 offen lds
v_mfma_f32_16x16x32_bf16 v[164:167], v[236:239], a[172:175], v[164:167]
s_waitcnt lgkmcnt(8)
v_mfma_f32_16x16x32_bf16 v[72:75], v[240:243], a[160:163], v[72:75]
ds_read_b64_tr_b16 v[236:237], v51 offset:28672
v_mfma_f32_16x16x32_bf16 v[104:107], v[240:243], a[164:167], v[104:107]
ds_read_b64_tr_b16 v[238:239], v51 offset:30720
v_mfma_f32_16x16x32_bf16 v[136:139], v[240:243], a[168:171], v[136:139]
buffer_load_dwordx4 a[212:215], v20, s[32:35], s62 offen offset:1024 sc1
v_mfma_f32_16x16x32_bf16 v[168:171], v[240:243], a[172:175], v[168:171]
s_waitcnt lgkmcnt(8)
v_mfma_f32_16x16x32_bf16 v[76:79], v[244:247], a[160:163], v[76:79]
ds_read_b64_tr_b16 v[240:241], v48 offset:32768
v_mfma_f32_16x16x32_bf16 v[108:111], v[244:247], a[164:167], v[108:111]
ds_read_b64_tr_b16 v[242:243], v48 offset:34816
v_mfma_f32_16x16x32_bf16 v[140:143], v[244:247], a[168:171], v[140:143]
v_mfma_f32_16x16x32_bf16 v[172:175], v[244:247], a[172:175], v[172:175]
s_waitcnt lgkmcnt(8)
v_mfma_f32_16x16x32_bf16 v[80:83], v[224:227], a[160:163], v[80:83]
ds_read_b64_tr_b16 v[244:245], v49 offset:32768
v_mfma_f32_16x16x32_bf16 v[112:115], v[224:227], a[164:167], v[112:115]
ds_read_b64_tr_b16 v[246:247], v49 offset:34816
v_mfma_f32_16x16x32_bf16 v[144:147], v[224:227], a[168:171], v[144:147]
buffer_load_dwordx4 a[216:219], v23, s[32:35], s62 offen offset:1024 sc1
v_mfma_f32_16x16x32_bf16 v[176:179], v[224:227], a[172:175], v[176:179]
s_add_u32 m0, s61, 131072
s_waitcnt lgkmcnt(8)
v_mfma_f32_16x16x32_bf16 v[84:87], v[228:231], a[160:163], v[84:87]
ds_read_b64_tr_b16 v[224:225], v50 offset:32768
s_mov_b32 s50, 245760
v_mfma_f32_16x16x32_bf16 v[116:119], v[228:231], a[164:167], v[116:119]
ds_read_b64_tr_b16 v[226:227], v50 offset:34816
v_mfma_f32_16x16x32_bf16 v[148:151], v[228:231], a[168:171], v[148:151]
buffer_load_dwordx4 v21, s[24:27], s50 offen lds
v_mfma_f32_16x16x32_bf16 v[180:183], v[228:231], a[172:175], v[180:183]
s_add_u32 m0, s61, 86016
s_waitcnt lgkmcnt(8)
v_mfma_f32_16x16x32_bf16 v[88:91], v[232:235], a[160:163], v[88:91]
ds_read_b64_tr_b16 v[228:229], v51 offset:32768
s_mov_b32 s50, 1880064
v_mfma_f32_16x16x32_bf16 v[120:123], v[232:235], a[164:167], v[120:123]
ds_read_b64_tr_b16 v[230:231], v51 offset:34816
v_mfma_f32_16x16x32_bf16 v[152:155], v[232:235], a[168:171], v[152:155]
buffer_load_dwordx4 v22, s[20:23], s50 offen lds
v_mfma_f32_16x16x32_bf16 v[184:187], v[232:235], a[172:175], v[184:187]
buffer_load_dwordx4 a[220:223], v24, s[32:35], s62 offen offset:1024 sc1
s_waitcnt lgkmcnt(8)
v_mfma_f32_16x16x32_bf16 v[92:95], v[236:239], a[160:163], v[92:95]
ds_read_b64_tr_b16 v[232:233], v48 offset:36864
v_mfma_f32_16x16x32_bf16 v[124:127], v[236:239], a[164:167], v[124:127]
ds_read_b64_tr_b16 v[234:235], v48 offset:38912
v_mfma_f32_16x16x32_bf16 v[156:159], v[236:239], a[168:171], v[156:159]
v_mfma_f32_16x16x32_bf16 v[188:191], v[236:239], a[172:175], v[188:191]
s_waitcnt vmcnt(19)
s_waitcnt lgkmcnt(8)
v_mfma_f32_16x16x32_bf16 v[64:67], v[240:243], a[176:179], v[64:67]
ds_read_b64_tr_b16 v[236:237], v49 offset:36864
v_mfma_f32_16x16x32_bf16 v[96:99], v[240:243], a[180:183], v[96:99]
ds_read_b64_tr_b16 v[238:239], v49 offset:38912
v_mfma_f32_16x16x32_bf16 v[128:131], v[240:243], a[184:187], v[128:131]
buffer_load_dwordx4 a[224:227], v5, s[32:35], s62 offen offset:2048 sc1
v_mfma_f32_16x16x32_bf16 v[160:163], v[240:243], a[188:191], v[160:163]
s_add_u32 m0, s61, 135168
s_waitcnt lgkmcnt(8)
v_mfma_f32_16x16x32_bf16 v[68:71], v[244:247], a[176:179], v[68:71]
ds_read_b64_tr_b16 v[240:241], v50 offset:36864
s_mov_b32 s50, 286720
v_mfma_f32_16x16x32_bf16 v[100:103], v[244:247], a[180:183], v[100:103]
ds_read_b64_tr_b16 v[242:243], v50 offset:38912
v_mfma_f32_16x16x32_bf16 v[132:135], v[244:247], a[184:187], v[132:135]
buffer_load_dwordx4 v21, s[24:27], s50 offen lds
v_mfma_f32_16x16x32_bf16 v[164:167], v[244:247], a[188:191], v[164:167]
s_add_u32 m0, s61, 90112
s_waitcnt lgkmcnt(8)
v_mfma_f32_16x16x32_bf16 v[72:75], v[224:227], a[176:179], v[72:75]
ds_read_b64_tr_b16 v[244:245], v51 offset:36864
s_mov_b32 s50, 1990656
v_mfma_f32_16x16x32_bf16 v[104:107], v[224:227], a[180:183], v[104:107]
ds_read_b64_tr_b16 v[246:247], v51 offset:38912
v_mfma_f32_16x16x32_bf16 v[136:139], v[224:227], a[184:187], v[136:139]
buffer_load_dwordx4 v22, s[16:19], s50 offen lds
v_mfma_f32_16x16x32_bf16 v[168:171], v[224:227], a[188:191], v[168:171]
buffer_load_dwordx4 a[228:231], v20, s[32:35], s62 offen offset:2048 sc1
s_waitcnt lgkmcnt(8)
v_mfma_f32_16x16x32_bf16 v[76:79], v[228:231], a[176:179], v[76:79]
ds_read_b64_tr_b16 v[224:225], v48 offset:40960
v_mfma_f32_16x16x32_bf16 v[108:111], v[228:231], a[180:183], v[108:111]
ds_read_b64_tr_b16 v[226:227], v48 offset:43008
v_mfma_f32_16x16x32_bf16 v[140:143], v[228:231], a[184:187], v[140:143]
v_mfma_f32_16x16x32_bf16 v[172:175], v[228:231], a[188:191], v[172:175]
s_waitcnt lgkmcnt(8)
v_mfma_f32_16x16x32_bf16 v[80:83], v[232:235], a[176:179], v[80:83]
ds_read_b64_tr_b16 v[228:229], v49 offset:40960
v_mfma_f32_16x16x32_bf16 v[112:115], v[232:235], a[180:183], v[112:115]
ds_read_b64_tr_b16 v[230:231], v49 offset:43008
v_mfma_f32_16x16x32_bf16 v[144:147], v[232:235], a[184:187], v[144:147]
buffer_load_dwordx4 a[232:235], v23, s[32:35], s62 offen offset:2048 sc1
v_mfma_f32_16x16x32_bf16 v[176:179], v[232:235], a[188:191], v[176:179]
s_add_u32 m0, s61, 139264
s_waitcnt lgkmcnt(8)
v_mfma_f32_16x16x32_bf16 v[84:87], v[236:239], a[176:179], v[84:87]
ds_read_b64_tr_b16 v[232:233], v50 offset:40960
s_mov_b32 s50, 327680
v_mfma_f32_16x16x32_bf16 v[116:119], v[236:239], a[180:183], v[116:119]
ds_read_b64_tr_b16 v[234:235], v50 offset:43008
v_mfma_f32_16x16x32_bf16 v[148:151], v[236:239], a[184:187], v[148:151]
buffer_load_dwordx4 v21, s[24:27], s50 offen lds
v_mfma_f32_16x16x32_bf16 v[180:183], v[236:239], a[188:191], v[180:183]
s_add_u32 m0, s61, 94208
s_waitcnt lgkmcnt(8)
v_mfma_f32_16x16x32_bf16 v[88:91], v[240:243], a[176:179], v[88:91]
ds_read_b64_tr_b16 v[236:237], v51 offset:40960
s_mov_b32 s50, 1990656
v_mfma_f32_16x16x32_bf16 v[120:123], v[240:243], a[180:183], v[120:123]
ds_read_b64_tr_b16 v[238:239], v51 offset:43008
v_mfma_f32_16x16x32_bf16 v[152:155], v[240:243], a[184:187], v[152:155]
buffer_load_dwordx4 v22, s[20:23], s50 offen lds
v_mfma_f32_16x16x32_bf16 v[184:187], v[240:243], a[188:191], v[184:187]
buffer_load_dwordx4 a[236:239], v24, s[32:35], s62 offen offset:2048 sc1
s_waitcnt lgkmcnt(8)
v_mfma_f32_16x16x32_bf16 v[92:95], v[244:247], a[176:179], v[92:95]
ds_read_b64_tr_b16 v[240:241], v48 offset:45056
v_mfma_f32_16x16x32_bf16 v[124:127], v[244:247], a[180:183], v[124:127]
ds_read_b64_tr_b16 v[242:243], v48 offset:47104
v_mfma_f32_16x16x32_bf16 v[156:159], v[244:247], a[184:187], v[156:159]
v_mfma_f32_16x16x32_bf16 v[188:191], v[244:247], a[188:191], v[188:191]
s_waitcnt vmcnt(17)
s_waitcnt lgkmcnt(8)
v_mfma_f32_16x16x32_bf16 v[64:67], v[224:227], a[192:195], v[64:67]
ds_read_b64_tr_b16 v[244:245], v49 offset:45056
v_mfma_f32_16x16x32_bf16 v[96:99], v[224:227], a[196:199], v[96:99]
ds_read_b64_tr_b16 v[246:247], v49 offset:47104
v_mfma_f32_16x16x32_bf16 v[128:131], v[224:227], a[200:203], v[128:131]
buffer_load_dwordx4 a[240:243], v5, s[32:35], s62 offen offset:3072 sc1
v_mfma_f32_16x16x32_bf16 v[160:163], v[224:227], a[204:207], v[160:163]
s_add_u32 m0, s61, 143360
s_waitcnt lgkmcnt(8)
v_mfma_f32_16x16x32_bf16 v[68:71], v[228:231], a[192:195], v[68:71]
ds_read_b64_tr_b16 v[224:225], v50 offset:45056
s_mov_b32 s50, 368640
v_mfma_f32_16x16x32_bf16 v[100:103], v[228:231], a[196:199], v[100:103]
ds_read_b64_tr_b16 v[226:227], v50 offset:47104
v_mfma_f32_16x16x32_bf16 v[132:135], v[228:231], a[200:203], v[132:135]
buffer_load_dwordx4 v21, s[24:27], s50 offen lds
v_mfma_f32_16x16x32_bf16 v[164:167], v[228:231], a[204:207], v[164:167]
s_add_u32 m0, s61, 98304
s_waitcnt lgkmcnt(8)
v_mfma_f32_16x16x32_bf16 v[72:75], v[232:235], a[192:195], v[72:75]
ds_read_b64_tr_b16 v[228:229], v51 offset:45056
s_mov_b32 s50, 2101248
v_mfma_f32_16x16x32_bf16 v[104:107], v[232:235], a[196:199], v[104:107]
ds_read_b64_tr_b16 v[230:231], v51 offset:47104
v_mfma_f32_16x16x32_bf16 v[136:139], v[232:235], a[200:203], v[136:139]
buffer_load_dwordx4 v22, s[16:19], s50 offen lds
v_mfma_f32_16x16x32_bf16 v[168:171], v[232:235], a[204:207], v[168:171]
buffer_load_dwordx4 a[244:247], v20, s[32:35], s62 offen offset:3072 sc1
s_waitcnt lgkmcnt(8)
v_mfma_f32_16x16x32_bf16 v[76:79], v[236:239], a[192:195], v[76:79]
s_barrier
ds_read_b64_tr_b16 v[232:233], v48 offset:49152
v_mfma_f32_16x16x32_bf16 v[108:111], v[236:239], a[196:199], v[108:111]
ds_read_b64_tr_b16 v[234:235], v48 offset:51200
v_mfma_f32_16x16x32_bf16 v[140:143], v[236:239], a[200:203], v[140:143]
v_mfma_f32_16x16x32_bf16 v[172:175], v[236:239], a[204:207], v[172:175]
s_waitcnt lgkmcnt(8)
v_mfma_f32_16x16x32_bf16 v[80:83], v[240:243], a[192:195], v[80:83]
ds_read_b64_tr_b16 v[236:237], v49 offset:49152
v_mfma_f32_16x16x32_bf16 v[112:115], v[240:243], a[196:199], v[112:115]
ds_read_b64_tr_b16 v[238:239], v49 offset:51200
v_mfma_f32_16x16x32_bf16 v[144:147], v[240:243], a[200:203], v[144:147]
buffer_load_dwordx4 a[248:251], v23, s[32:35], s62 offen offset:3072 sc1
v_mfma_f32_16x16x32_bf16 v[176:179], v[240:243], a[204:207], v[176:179]
s_add_u32 m0, s61, 147456
s_waitcnt lgkmcnt(8)
v_mfma_f32_16x16x32_bf16 v[84:87], v[244:247], a[192:195], v[84:87]
ds_read_b64_tr_b16 v[240:241], v50 offset:49152
s_mov_b32 s50, 409600
v_mfma_f32_16x16x32_bf16 v[116:119], v[244:247], a[196:199], v[116:119]
ds_read_b64_tr_b16 v[242:243], v50 offset:51200
v_mfma_f32_16x16x32_bf16 v[148:151], v[244:247], a[200:203], v[148:151]
buffer_load_dwordx4 v21, s[24:27], s50 offen lds
v_mfma_f32_16x16x32_bf16 v[180:183], v[244:247], a[204:207], v[180:183]
s_add_u32 m0, s61, 102400
s_waitcnt lgkmcnt(8)
v_mfma_f32_16x16x32_bf16 v[88:91], v[224:227], a[192:195], v[88:91]
ds_read_b64_tr_b16 v[244:245], v51 offset:49152
s_mov_b32 s50, 2101248
v_mfma_f32_16x16x32_bf16 v[120:123], v[224:227], a[196:199], v[120:123]
ds_read_b64_tr_b16 v[246:247], v51 offset:51200
v_mfma_f32_16x16x32_bf16 v[152:155], v[224:227], a[200:203], v[152:155]
buffer_load_dwordx4 v22, s[20:23], s50 offen lds
v_mfma_f32_16x16x32_bf16 v[184:187], v[224:227], a[204:207], v[184:187]
buffer_load_dwordx4 a[252:255], v24, s[32:35], s62 offen offset:3072 sc1
s_waitcnt lgkmcnt(8)
v_mfma_f32_16x16x32_bf16 v[92:95], v[228:231], a[192:195], v[92:95]
ds_read_b64_tr_b16 v[224:225], v48 offset:53248
s_waitcnt vmcnt(24)
v_mfma_f32_16x16x32_bf16 v[124:127], v[228:231], a[196:199], v[124:127]
ds_read_b64_tr_b16 v[226:227], v48 offset:55296
s_mov_b32 s82, 0x3acccccd
v_mfma_f32_16x16x32_bf16 v[156:159], v[228:231], a[200:203], v[156:159]
s_mov_b32 s83, 0x3acccccd
v_mfma_f32_16x16x32_bf16 v[188:191], v[228:231], a[204:207], v[188:191]
v_pk_add_f32 v[6:7], v[6:7], v[8:9]
s_waitcnt vmcnt(16)
s_waitcnt lgkmcnt(8)
v_mfma_f32_16x16x32_bf16 v[64:67], v[232:235], a[208:211], v[64:67]
ds_read_b64_tr_b16 v[228:229], v49 offset:53248
s_mov_b32 s62, 16384
v_mfma_f32_16x16x32_bf16 v[96:99], v[232:235], a[212:215], v[96:99]
ds_read_b64_tr_b16 v[230:231], v49 offset:55296
v_mfma_f32_16x16x32_bf16 v[128:131], v[232:235], a[216:219], v[128:131]
buffer_load_dwordx4 a[0:3], v5, s[32:35], s62 offen offset:0 sc1
v_mfma_f32_16x16x32_bf16 v[160:163], v[232:235], a[220:223], v[160:163]
s_add_u32 m0, s61, 151552
s_mov_b32 s50, 450560
buffer_load_dwordx4 v21, s[24:27], s50 offen lds
s_waitcnt lgkmcnt(8)
v_mfma_f32_16x16x32_bf16 v[68:71], v[236:239], a[208:211], v[68:71]
ds_read_b64_tr_b16 v[232:233], v50 offset:53248
s_mov_b32 s50, 10240
v_mfma_f32_16x16x32_bf16 v[100:103], v[236:239], a[212:215], v[100:103]
ds_read_b64_tr_b16 v[234:235], v50 offset:55296
v_mfma_f32_16x16x32_bf16 v[132:135], v[236:239], a[216:219], v[132:135]
buffer_load_dword v61, v60, s[32:35], s50 offen sc1
v_mfma_f32_16x16x32_bf16 v[164:167], v[236:239], a[220:223], v[164:167]
v_pk_add_f32 v[16:17], v[16:17], v[18:19]
s_waitcnt lgkmcnt(8)
v_mfma_f32_16x16x32_bf16 v[72:75], v[240:243], a[208:211], v[72:75]
ds_read_b64_tr_b16 v[236:237], v51 offset:53248
v_mfma_f32_16x16x32_bf16 v[104:107], v[240:243], a[212:215], v[104:107]
ds_read_b64_tr_b16 v[238:239], v51 offset:55296
v_mfma_f32_16x16x32_bf16 v[136:139], v[240:243], a[216:219], v[136:139]
buffer_load_dwordx4 a[4:7], v20, s[32:35], s62 offen offset:0 sc1
v_mfma_f32_16x16x32_bf16 v[168:171], v[240:243], a[220:223], v[168:171]
v_pk_add_f32 v[32:33], v[32:33], v[34:35]
s_waitcnt lgkmcnt(8)
v_mfma_f32_16x16x32_bf16 v[76:79], v[244:247], a[208:211], v[76:79]
ds_read_b64_tr_b16 v[240:241], v48 offset:57344
v_mfma_f32_16x16x32_bf16 v[108:111], v[244:247], a[212:215], v[108:111]
ds_read_b64_tr_b16 v[242:243], v48 offset:59392
v_mfma_f32_16x16x32_bf16 v[140:143], v[244:247], a[216:219], v[140:143]
v_pk_add_f32 v[42:43], v[42:43], v[44:45]
v_mfma_f32_16x16x32_bf16 v[172:175], v[244:247], a[220:223], v[172:175]
v_pk_add_f32 v[6:7], v[6:7], v[10:11]
s_waitcnt lgkmcnt(8)
v_mfma_f32_16x16x32_bf16 v[80:83], v[224:227], a[208:211], v[80:83]
ds_read_b64_tr_b16 v[244:245], v49 offset:57344
v_mfma_f32_16x16x32_bf16 v[112:115], v[224:227], a[212:215], v[112:115]
ds_read_b64_tr_b16 v[246:247], v49 offset:59392
v_mfma_f32_16x16x32_bf16 v[144:147], v[224:227], a[216:219], v[144:147]
buffer_load_dwordx4 a[8:11], v23, s[32:35], s62 offen offset:0 sc1
v_mfma_f32_16x16x32_bf16 v[176:179], v[224:227], a[220:223], v[176:179]
s_add_u32 m0, s61, 155648
s_waitcnt lgkmcnt(8)
v_mfma_f32_16x16x32_bf16 v[84:87], v[228:231], a[208:211], v[84:87]
ds_read_b64_tr_b16 v[224:225], v50 offset:57344
s_mov_b32 s50, 491520
v_mfma_f32_16x16x32_bf16 v[116:119], v[228:231], a[212:215], v[116:119]
ds_read_b64_tr_b16 v[226:227], v50 offset:59392
v_mfma_f32_16x16x32_bf16 v[148:151], v[228:231], a[216:219], v[148:151]
buffer_load_dwordx4 v21, s[24:27], s50 offen lds
v_mfma_f32_16x16x32_bf16 v[180:183], v[228:231], a[220:223], v[180:183]
v_pk_add_f32 v[16:17], v[16:17], v[26:27]
s_waitcnt lgkmcnt(8)
v_mfma_f32_16x16x32_bf16 v[88:91], v[232:235], a[208:211], v[88:91]
ds_read_b64_tr_b16 v[228:229], v51 offset:57344
v_mfma_f32_16x16x32_bf16 v[120:123], v[232:235], a[212:215], v[120:123]
ds_read_b64_tr_b16 v[230:231], v51 offset:59392
v_mfma_f32_16x16x32_bf16 v[152:155], v[232:235], a[216:219], v[152:155]
buffer_load_dwordx4 a[12:15], v24, s[32:35], s62 offen offset:0 sc1
v_mfma_f32_16x16x32_bf16 v[184:187], v[232:235], a[220:223], v[184:187]
v_pk_add_f32 v[32:33], v[32:33], v[36:37]
s_waitcnt lgkmcnt(8)
v_mfma_f32_16x16x32_bf16 v[92:95], v[236:239], a[208:211], v[92:95]
ds_read_b64_tr_b16 v[232:233], v48 offset:61440
v_mfma_f32_16x16x32_bf16 v[124:127], v[236:239], a[212:215], v[124:127]
ds_read_b64_tr_b16 v[234:235], v48 offset:63488
v_mfma_f32_16x16x32_bf16 v[156:159], v[236:239], a[216:219], v[156:159]
v_pk_add_f32 v[42:43], v[42:43], v[52:53]
v_mfma_f32_16x16x32_bf16 v[188:191], v[236:239], a[220:223], v[188:191]
v_pk_add_f32 v[6:7], v[6:7], v[12:13]
s_waitcnt vmcnt(15)
s_waitcnt lgkmcnt(8)
v_mfma_f32_16x16x32_bf16 v[64:67], v[240:243], a[224:227], v[64:67]
ds_read_b64_tr_b16 v[236:237], v49 offset:61440
v_mfma_f32_16x16x32_bf16 v[96:99], v[240:243], a[228:231], v[96:99]
ds_read_b64_tr_b16 v[238:239], v49 offset:63488
v_mfma_f32_16x16x32_bf16 v[128:131], v[240:243], a[232:235], v[128:131]
buffer_load_dwordx4 a[16:19], v5, s[32:35], s62 offen offset:1024 sc1
v_mfma_f32_16x16x32_bf16 v[160:163], v[240:243], a[236:239], v[160:163]
s_add_u32 m0, s61, 159744
s_waitcnt lgkmcnt(8)
v_mfma_f32_16x16x32_bf16 v[68:71], v[244:247], a[224:227], v[68:71]
ds_read_b64_tr_b16 v[240:241], v50 offset:61440
s_mov_b32 s50, 532480
v_mfma_f32_16x16x32_bf16 v[100:103], v[244:247], a[228:231], v[100:103]
ds_read_b64_tr_b16 v[242:243], v50 offset:63488
v_mfma_f32_16x16x32_bf16 v[132:135], v[244:247], a[232:235], v[132:135]
buffer_load_dwordx4 v21, s[24:27], s50 offen lds
v_mfma_f32_16x16x32_bf16 v[164:167], v[244:247], a[236:239], v[164:167]
v_pk_add_f32 v[16:17], v[16:17], v[28:29]
s_waitcnt lgkmcnt(8)
v_mfma_f32_16x16x32_bf16 v[72:75], v[224:227], a[224:227], v[72:75]
ds_read_b64_tr_b16 v[244:245], v51 offset:61440
v_mfma_f32_16x16x32_bf16 v[104:107], v[224:227], a[228:231], v[104:107]
ds_read_b64_tr_b16 v[246:247], v51 offset:63488
v_mfma_f32_16x16x32_bf16 v[136:139], v[224:227], a[232:235], v[136:139]
buffer_load_dwordx4 a[20:23], v20, s[32:35], s62 offen offset:1024 sc1
v_mfma_f32_16x16x32_bf16 v[168:171], v[224:227], a[236:239], v[168:171]
v_pk_add_f32 v[32:33], v[32:33], v[38:39]
s_waitcnt lgkmcnt(8)
v_mfma_f32_16x16x32_bf16 v[76:79], v[228:231], a[224:227], v[76:79]
v_add_u32 v48, 0x10000, v48
v_add_u32 v49, 0x10000, v49
v_add_u32 v50, 0x10000, v50
v_add_u32 v51, 0x10000, v51
ds_read_b64_tr_b16 v[224:225], v48 offset:0
v_mfma_f32_16x16x32_bf16 v[108:111], v[228:231], a[228:231], v[108:111]
ds_read_b64_tr_b16 v[226:227], v48 offset:2048
v_mfma_f32_16x16x32_bf16 v[140:143], v[228:231], a[232:235], v[140:143]
v_pk_add_f32 v[42:43], v[42:43], v[54:55]
v_mfma_f32_16x16x32_bf16 v[172:175], v[228:231], a[236:239], v[172:175]
v_pk_add_f32 v[6:7], v[6:7], v[14:15]
s_waitcnt lgkmcnt(8)
v_mfma_f32_16x16x32_bf16 v[80:83], v[232:235], a[224:227], v[80:83]
ds_read_b64_tr_b16 v[228:229], v49 offset:0
v_mfma_f32_16x16x32_bf16 v[112:115], v[232:235], a[228:231], v[112:115]
ds_read_b64_tr_b16 v[230:231], v49 offset:2048
v_mfma_f32_16x16x32_bf16 v[144:147], v[232:235], a[232:235], v[144:147]
buffer_load_dwordx4 a[24:27], v23, s[32:35], s62 offen offset:1024 sc1
v_mfma_f32_16x16x32_bf16 v[176:179], v[232:235], a[236:239], v[176:179]
s_add_u32 m0, s61, 0
s_waitcnt lgkmcnt(8)
v_mfma_f32_16x16x32_bf16 v[84:87], v[236:239], a[224:227], v[84:87]
ds_read_b64_tr_b16 v[232:233], v50 offset:0
s_mov_b32 s50, 573440
v_mfma_f32_16x16x32_bf16 v[116:119], v[236:239], a[228:231], v[116:119]
ds_read_b64_tr_b16 v[234:235], v50 offset:2048
v_mfma_f32_16x16x32_bf16 v[148:151], v[236:239], a[232:235], v[148:151]
buffer_load_dwordx4 v21, s[24:27], s50 offen lds
v_mfma_f32_16x16x32_bf16 v[180:183], v[236:239], a[236:239], v[180:183]
v_pk_add_f32 v[16:17], v[16:17], v[30:31]
s_waitcnt lgkmcnt(8)
v_mfma_f32_16x16x32_bf16 v[88:91], v[240:243], a[224:227], v[88:91]
ds_read_b64_tr_b16 v[236:237], v51 offset:0
v_mfma_f32_16x16x32_bf16 v[120:123], v[240:243], a[228:231], v[120:123]
ds_read_b64_tr_b16 v[238:239], v51 offset:2048
v_mfma_f32_16x16x32_bf16 v[152:155], v[240:243], a[232:235], v[152:155]
buffer_load_dwordx4 a[28:31], v24, s[32:35], s62 offen offset:1024 sc1
v_mfma_f32_16x16x32_bf16 v[184:187], v[240:243], a[236:239], v[184:187]
v_pk_add_f32 v[32:33], v[32:33], v[40:41]
s_waitcnt lgkmcnt(8)
v_mfma_f32_16x16x32_bf16 v[92:95], v[244:247], a[224:227], v[92:95]
ds_read_b64_tr_b16 v[240:241], v48 offset:4096
v_mfma_f32_16x16x32_bf16 v[124:127], v[244:247], a[228:231], v[124:127]
ds_read_b64_tr_b16 v[242:243], v48 offset:6144
v_mfma_f32_16x16x32_bf16 v[156:159], v[244:247], a[232:235], v[156:159]
v_pk_add_f32 v[42:43], v[42:43], v[56:57]
v_mfma_f32_16x16x32_bf16 v[188:191], v[244:247], a[236:239], v[188:191]
v_mov_b32 v8, v6
s_waitcnt vmcnt(13)
s_waitcnt lgkmcnt(8)
v_mfma_f32_16x16x32_bf16 v[64:67], v[224:227], a[240:243], v[64:67]
ds_read_b64_tr_b16 v[244:245], v49 offset:4096
v_mfma_f32_16x16x32_bf16 v[96:99], v[224:227], a[244:247], v[96:99]
ds_read_b64_tr_b16 v[246:247], v49 offset:6144
v_mfma_f32_16x16x32_bf16 v[128:131], v[224:227], a[248:251], v[128:131]
buffer_load_dwordx4 a[32:35], v5, s[32:35], s62 offen offset:2048 sc1
v_mfma_f32_16x16x32_bf16 v[160:163], v[224:227], a[252:255], v[160:163]
s_add_u32 m0, s61, 4096
s_mov_b32 s50, 614400
buffer_load_dwordx4 v21, s[24:27], s50 offen lds
s_waitcnt vmcnt(12)
v_readfirstlane_b32 s52, v61
s_nop 0
s_cmp_ge_u32 s52, 54
s_nop 2
s_cbranch_scc1 L_cok35
s_mov_b32 s50, 10240
v_mov_b32 v60, 0
s_mov_b32 s51, 400000
L_poll36:
buffer_load_dword v61, v60, s[32:35], s50 offen sc1
s_waitcnt vmcnt(0)
v_readfirstlane_b32 s52, v61
s_nop 0
s_cmp_ge_u32 s52, 54
s_nop 2
s_cbranch_scc1 L_pd37
s_sub_u32 s51, s51, 1
s_cmp_lg_u32 s51, 0
s_cbranch_scc1 L_poll36
L_pd37:
L_cok35:
s_waitcnt lgkmcnt(8)
v_mfma_f32_16x16x32_bf16 v[68:71], v[228:231], a[240:243], v[68:71]
ds_read_b64_tr_b16 v[224:225], v50 offset:4096
v_mfma_f32_16x16x32_bf16 v[100:103], v[228:231], a[244:247], v[100:103]
ds_read_b64_tr_b16 v[226:227], v50 offset:6144
v_mfma_f32_16x16x32_bf16 v[132:135], v[228:231], a[248:251], v[132:135]
buffer_load_dwordx4 v[192:195], v59, s[32:35], s56 offen offset:0 sc1
v_mfma_f32_16x16x32_bf16 v[164:167], v[228:231], a[252:255], v[164:167]
v_mov_b32 v9, v7
s_waitcnt lgkmcnt(8)
v_mfma_f32_16x16x32_bf16 v[72:75], v[232:235], a[240:243], v[72:75]
ds_read_b64_tr_b16 v[228:229], v51 offset:4096
v_mfma_f32_16x16x32_bf16 v[104:107], v[232:235], a[244:247], v[104:107]
ds_read_b64_tr_b16 v[230:231], v51 offset:6144
v_mfma_f32_16x16x32_bf16 v[136:139], v[232:235], a[248:251], v[136:139]
buffer_load_dwordx4 a[36:39], v20, s[32:35], s62 offen offset:2048 sc1
v_mfma_f32_16x16x32_bf16 v[168:171], v[232:235], a[252:255], v[168:171]
v_mov_b32 v18, v16
s_waitcnt lgkmcnt(8)
v_mfma_f32_16x16x32_bf16 v[76:79], v[236:239], a[240:243], v[76:79]
buffer_load_dwordx4 v[196:199], v59, s[32:35], s56 offen offset:64 sc1
s_barrier
ds_read_b64_tr_b16 v[232:233], v48 offset:8192
v_mov_b32 v19, v17
v_mfma_f32_16x16x32_bf16 v[108:111], v[236:239], a[244:247], v[108:111]
ds_read_b64_tr_b16 v[234:235], v48 offset:10240
v_mov_b32 v34, v32
v_mfma_f32_16x16x32_bf16 v[140:143], v[236:239], a[248:251], v[140:143]
v_mov_b32 v35, v33
v_mov_b32 v44, v42
v_mfma_f32_16x16x32_bf16 v[172:175], v[236:239], a[252:255], v[172:175]
v_mov_b32 v45, v43
s_waitcnt lgkmcnt(8)
v_mfma_f32_16x16x32_bf16 v[80:83], v[240:243], a[240:243], v[80:83]
ds_read_b64_tr_b16 v[236:237], v49 offset:8192
v_mfma_f32_16x16x32_bf16 v[112:115], v[240:243], a[244:247], v[112:115]
ds_read_b64_tr_b16 v[238:239], v49 offset:10240
v_mfma_f32_16x16x32_bf16 v[144:147], v[240:243], a[248:251], v[144:147]
buffer_load_dwordx4 a[40:43], v23, s[32:35], s62 offen offset:2048 sc1
v_mfma_f32_16x16x32_bf16 v[176:179], v[240:243], a[252:255], v[176:179]
s_add_u32 m0, s61, 8192
s_waitcnt lgkmcnt(8)
v_mfma_f32_16x16x32_bf16 v[84:87], v[244:247], a[240:243], v[84:87]
ds_read_b64_tr_b16 v[240:241], v50 offset:8192
s_mov_b32 s50, 655360
v_mfma_f32_16x16x32_bf16 v[116:119], v[244:247], a[244:247], v[116:119]
ds_read_b64_tr_b16 v[242:243], v50 offset:10240
v_mfma_f32_16x16x32_bf16 v[148:151], v[244:247], a[248:251], v[148:151]
buffer_load_dwordx4 v21, s[24:27], s50 offen lds
v_mfma_f32_16x16x32_bf16 v[180:183], v[244:247], a[252:255], v[180:183]
buffer_load_dwordx4 v[200:203], v59, s[32:35], s56 offen offset:128 sc1
s_waitcnt lgkmcnt(8)
v_mfma_f32_16x16x32_bf16 v[88:91], v[224:227], a[240:243], v[88:91]
ds_read_b64_tr_b16 v[244:245], v51 offset:8192
v_mfma_f32_16x16x32_bf16 v[120:123], v[224:227], a[244:247], v[120:123]
ds_read_b64_tr_b16 v[246:247], v51 offset:10240
v_mfma_f32_16x16x32_bf16 v[152:155], v[224:227], a[248:251], v[152:155]
buffer_load_dwordx4 a[44:47], v24, s[32:35], s62 offen offset:2048 sc1
v_mfma_f32_16x16x32_bf16 v[184:187], v[224:227], a[252:255], v[184:187]
v_permlane16_swap_b32 v6, v8
s_waitcnt lgkmcnt(8)
v_mfma_f32_16x16x32_bf16 v[92:95], v[228:231], a[240:243], v[92:95]
ds_read_b64_tr_b16 v[224:225], v48 offset:12288
v_mfma_f32_16x16x32_bf16 v[124:127], v[228:231], a[244:247], v[124:127]
ds_read_b64_tr_b16 v[226:227], v48 offset:14336
v_mfma_f32_16x16x32_bf16 v[156:159], v[228:231], a[248:251], v[156:159]
buffer_load_dwordx4 v[204:207], v59, s[32:35], s56 offen offset:192 sc1
v_mfma_f32_16x16x32_bf16 v[188:191], v[228:231], a[252:255], v[188:191]
v_permlane16_swap_b32 v7, v9
s_waitcnt vmcnt(16)
s_waitcnt lgkmcnt(8)
v_mfma_f32_16x16x32_bf16 v[64:67], v[232:235], a[0:3], v[64:67]
ds_read_b64_tr_b16 v[228:229], v49 offset:12288
v_mfma_f32_16x16x32_bf16 v[96:99], v[232:235], a[4:7], v[96:99]
ds_read_b64_tr_b16 v[230:231], v49 offset:14336
v_mfma_f32_16x16x32_bf16 v[128:131], v[232:235], a[8:11], v[128:131]
buffer_load_dwordx4 a[48:51], v5, s[32:35], s62 offen offset:3072 sc1
v_mfma_f32_16x16x32_bf16 v[160:163], v[232:235], a[12:15], v[160:163]
s_add_u32 m0, s61, 12288
s_mov_b32 s50, 696320
buffer_load_dwordx4 v21, s[24:27], s50 offen lds
s_waitcnt lgkmcnt(8)
v_mfma_f32_16x16x32_bf16 v[68:71], v[236:239], a[0:3], v[68:71]
ds_read_b64_tr_b16 v[232:233], v50 offset:12288
v_mfma_f32_16x16x32_bf16 v[100:103], v[236:239], a[4:7], v[100:103]
ds_read_b64_tr_b16 v[234:235], v50 offset:14336
v_mfma_f32_16x16x32_bf16 v[132:135], v[236:239], a[8:11], v[132:135]
buffer_load_dwordx4 v[208:211], v59, s[32:35], s57 offen offset:0 sc1
v_mfma_f32_16x16x32_bf16 v[164:167], v[236:239], a[12:15], v[164:167]
v_permlane16_swap_b32 v16, v18
s_waitcnt lgkmcnt(8)
v_mfma_f32_16x16x32_bf16 v[72:75], v[240:243], a[0:3], v[72:75]
ds_read_b64_tr_b16 v[236:237], v51 offset:12288
v_mfma_f32_16x16x32_bf16 v[104:107], v[240:243], a[4:7], v[104:107]
ds_read_b64_tr_b16 v[238:239], v51 offset:14336
v_mfma_f32_16x16x32_bf16 v[136:139], v[240:243], a[8:11], v[136:139]
buffer_load_dwordx4 a[52:55], v20, s[32:35], s62 offen offset:3072 sc1
v_mfma_f32_16x16x32_bf16 v[168:171], v[240:243], a[12:15], v[168:171]
v_permlane16_swap_b32 v17, v19
s_waitcnt lgkmcnt(8)
v_mfma_f32_16x16x32_bf16 v[76:79], v[244:247], a[0:3], v[76:79]
ds_read_b64_tr_b16 v[240:241], v48 offset:16384
v_mfma_f32_16x16x32_bf16 v[108:111], v[244:247], a[4:7], v[108:111]
ds_read_b64_tr_b16 v[242:243], v48 offset:18432
v_mfma_f32_16x16x32_bf16 v[140:143], v[244:247], a[8:11], v[140:143]
buffer_load_dwordx4 v[212:215], v59, s[32:35], s57 offen offset:64 sc1
v_mfma_f32_16x16x32_bf16 v[172:175], v[244:247], a[12:15], v[172:175]
v_permlane16_swap_b32 v32, v34
s_waitcnt lgkmcnt(8)
v_mfma_f32_16x16x32_bf16 v[80:83], v[224:227], a[0:3], v[80:83]
ds_read_b64_tr_b16 v[244:245], v49 offset:16384
v_mfma_f32_16x16x32_bf16 v[112:115], v[224:227], a[4:7], v[112:115]
ds_read_b64_tr_b16 v[246:247], v49 offset:18432
v_mfma_f32_16x16x32_bf16 v[144:147], v[224:227], a[8:11], v[144:147]
buffer_load_dwordx4 a[56:59], v23, s[32:35], s62 offen offset:3072 sc1
v_mfma_f32_16x16x32_bf16 v[176:179], v[224:227], a[12:15], v[176:179]
s_add_u32 m0, s61, 16384
s_waitcnt lgkmcnt(8)
v_mfma_f32_16x16x32_bf16 v[84:87], v[228:231], a[0:3], v[84:87]
ds_read_b64_tr_b16 v[224:225], v50 offset:16384
s_mov_b32 s50, 737280
v_mfma_f32_16x16x32_bf16 v[116:119], v[228:231], a[4:7], v[116:119]
ds_read_b64_tr_b16 v[226:227], v50 offset:18432
v_mfma_f32_16x16x32_bf16 v[148:151], v[228:231], a[8:11], v[148:151]
buffer_load_dwordx4 v21, s[24:27], s50 offen lds
v_mfma_f32_16x16x32_bf16 v[180:183], v[228:231], a[12:15], v[180:183]
buffer_load_dwordx4 v[216:219], v59, s[32:35], s57 offen offset:128 sc1
s_waitcnt lgkmcnt(8)
v_mfma_f32_16x16x32_bf16 v[88:91], v[232:235], a[0:3], v[88:91]
ds_read_b64_tr_b16 v[228:229], v51 offset:16384
v_mfma_f32_16x16x32_bf16 v[120:123], v[232:235], a[4:7], v[120:123]
ds_read_b64_tr_b16 v[230:231], v51 offset:18432
v_mfma_f32_16x16x32_bf16 v[152:155], v[232:235], a[8:11], v[152:155]
buffer_load_dwordx4 a[60:63], v24, s[32:35], s62 offen offset:3072 sc1
v_mfma_f32_16x16x32_bf16 v[184:187], v[232:235], a[12:15], v[184:187]
v_permlane16_swap_b32 v33, v35
s_waitcnt lgkmcnt(8)
v_mfma_f32_16x16x32_bf16 v[92:95], v[236:239], a[0:3], v[92:95]
ds_read_b64_tr_b16 v[232:233], v48 offset:20480
v_mfma_f32_16x16x32_bf16 v[124:127], v[236:239], a[4:7], v[124:127]
ds_read_b64_tr_b16 v[234:235], v48 offset:22528
v_mfma_f32_16x16x32_bf16 v[156:159], v[236:239], a[8:11], v[156:159]
buffer_load_dwordx4 v[220:223], v59, s[32:35], s57 offen offset:192 sc1
v_mfma_f32_16x16x32_bf16 v[188:191], v[236:239], a[12:15], v[188:191]
v_permlane16_swap_b32 v42, v44
s_waitcnt vmcnt(20)
s_waitcnt lgkmcnt(8)
v_mfma_f32_16x16x32_bf16 v[64:67], v[240:243], a[16:19], v[64:67]
ds_read_b64_tr_b16 v[236:237], v49 offset:20480
s_add_u32 m0, s61, 20480
v_mfma_f32_16x16x32_bf16 v[96:99], v[240:243], a[20:23], v[96:99]
ds_read_b64_tr_b16 v[238:239], v49 offset:22528
s_mov_b32 s50, 778240
v_mfma_f32_16x16x32_bf16 v[128:131], v[240:243], a[24:27], v[128:131]
buffer_load_dwordx4 v21, s[24:27], s50 offen lds
v_mfma_f32_16x16x32_bf16 v[160:163], v[240:243], a[28:31], v[160:163]
v_permlane16_swap_b32 v43, v45
s_waitcnt lgkmcnt(8)
v_mfma_f32_16x16x32_bf16 v[68:71], v[244:247], a[16:19], v[68:71]
ds_read_b64_tr_b16 v[240:241], v50 offset:20480
v_mfma_f32_16x16x32_bf16 v[100:103], v[244:247], a[20:23], v[100:103]
ds_read_b64_tr_b16 v[242:243], v50 offset:22528
v_mfma_f32_16x16x32_bf16 v[132:135], v[244:247], a[24:27], v[132:135]
v_pk_add_f32 v[6:7], v[6:7], v[8:9]
v_mfma_f32_16x16x32_bf16 v[164:167], v[244:247], a[28:31], v[164:167]
v_pk_add_f32 v[16:17], v[16:17], v[18:19]
s_waitcnt lgkmcnt(8)
v_mfma_f32_16x16x32_bf16 v[72:75], v[224:227], a[16:19], v[72:75]
ds_read_b64_tr_b16 v[244:245], v51 offset:20480
v_mfma_f32_16x16x32_bf16 v[104:107], v[224:227], a[20:23], v[104:107]
ds_read_b64_tr_b16 v[246:247], v51 offset:22528
v_mfma_f32_16x16x32_bf16 v[136:139], v[224:227], a[24:27], v[136:139]
v_pk_add_f32 v[32:33], v[32:33], v[34:35]
v_mfma_f32_16x16x32_bf16 v[168:171], v[224:227], a[28:31], v[168:171]
v_pk_add_f32 v[42:43], v[42:43], v[44:45]
s_waitcnt lgkmcnt(8)
v_mfma_f32_16x16x32_bf16 v[76:79], v[228:231], a[16:19], v[76:79]
ds_read_b64_tr_b16 v[224:225], v48 offset:24576
v_mov_b32 v8, v6
v_mfma_f32_16x16x32_bf16 v[108:111], v[228:231], a[20:23], v[108:111]
ds_read_b64_tr_b16 v[226:227], v48 offset:26624
v_mov_b32 v9, v7
v_mfma_f32_16x16x32_bf16 v[140:143], v[228:231], a[24:27], v[140:143]
v_mov_b32 v18, v16
v_mov_b32 v19, v17
v_mfma_f32_16x16x32_bf16 v[172:175], v[228:231], a[28:31], v[172:175]
v_mov_b32 v34, v32
s_waitcnt lgkmcnt(8)
v_mfma_f32_16x16x32_bf16 v[80:83], v[232:235], a[16:19], v[80:83]
ds_read_b64_tr_b16 v[228:229], v49 offset:24576
s_add_u32 m0, s61, 24576
v_mfma_f32_16x16x32_bf16 v[112:115], v[232:235], a[20:23], v[112:115]
ds_read_b64_tr_b16 v[230:231], v49 offset:26624
s_mov_b32 s50, 819200
v_mfma_f32_16x16x32_bf16 v[144:147], v[232:235], a[24:27], v[144:147]
buffer_load_dwordx4 v21, s[24:27], s50 offen lds
v_mfma_f32_16x16x32_bf16 v[176:179], v[232:235], a[28:31], v[176:179]
v_mov_b32 v35, v33
s_waitcnt lgkmcnt(8)
v_mfma_f32_16x16x32_bf16 v[84:87], v[236:239], a[16:19], v[84:87]
ds_read_b64_tr_b16 v[232:233], v50 offset:24576
v_mov_b32 v44, v42
v_mfma_f32_16x16x32_bf16 v[116:119], v[236:239], a[20:23], v[116:119]
ds_read_b64_tr_b16 v[234:235], v50 offset:26624
v_mov_b32 v45, v43
v_mfma_f32_16x16x32_bf16 v[148:151], v[236:239], a[24:27], v[148:151]
v_permlane32_swap_b32 v6, v8
v_permlane32_swap_b32 v7, v9
v_mfma_f32_16x16x32_bf16 v[180:183], v[236:239], a[28:31], v[180:183]
v_permlane32_swap_b32 v16, v18
s_waitcnt lgkmcnt(8)
v_mfma_f32_16x16x32_bf16 v[88:91], v[240:243], a[16:19], v[88:91]
ds_read_b64_tr_b16 v[236:237], v51 offset:24576
v_permlane32_swap_b32 v17, v19
v_mfma_f32_16x16x32_bf16 v[120:123], v[240:243], a[20:23], v[120:123]
ds_read_b64_tr_b16 v[238:239], v51 offset:26624
v_permlane32_swap_b32 v32, v34
v_mfma_f32_16x16x32_bf16 v[152:155], v[240:243], a[24:27], v[152:155]
v_permlane32_swap_b32 v33, v35
v_permlane32_swap_b32 v42, v44
v_mfma_f32_16x16x32_bf16 v[184:187], v[240:243], a[28:31], v[184:187]
v_permlane32_swap_b32 v43, v45
s_waitcnt lgkmcnt(8)
v_mfma_f32_16x16x32_bf16 v[92:95], v[244:247], a[16:19], v[92:95]
ds_read_b64_tr_b16 v[240:241], v48 offset:28672
v_mfma_f32_16x16x32_bf16 v[124:127], v[244:247], a[20:23], v[124:127]
ds_read_b64_tr_b16 v[242:243], v48 offset:30720
v_mfma_f32_16x16x32_bf16 v[156:159], v[244:247], a[24:27], v[156:159]
v_pk_add_f32 v[6:7], v[6:7], v[8:9]
v_mfma_f32_16x16x32_bf16 v[188:191], v[244:247], a[28:31], v[188:191]
v_pk_add_f32 v[16:17], v[16:17], v[18:19]
s_waitcnt vmcnt(13)
s_waitcnt lgkmcnt(8)
v_mfma_f32_16x16x32_bf16 v[64:67], v[224:227], a[32:35], v[64:67]
ds_read_b64_tr_b16 v[244:245], v49 offset:28672
s_add_u32 m0, s61, 28672
v_mfma_f32_16x16x32_bf16 v[96:99], v[224:227], a[36:39], v[96:99]
ds_read_b64_tr_b16 v[246:247], v49 offset:30720
s_mov_b32 s50, 860160
v_mfma_f32_16x16x32_bf16 v[128:131], v[224:227], a[40:43], v[128:131]
buffer_load_dwordx4 v21, s[24:27], s50 offen lds
v_mfma_f32_16x16x32_bf16 v[160:163], v[224:227], a[44:47], v[160:163]
v_pk_add_f32 v[32:33], v[32:33], v[34:35]
s_waitcnt lgkmcnt(8)
v_mfma_f32_16x16x32_bf16 v[68:71], v[228:231], a[32:35], v[68:71]
ds_read_b64_tr_b16 v[224:225], v50 offset:28672
v_mfma_f32_16x16x32_bf16 v[100:103], v[228:231], a[36:39], v[100:103]
ds_read_b64_tr_b16 v[226:227], v50 offset:30720
v_mfma_f32_16x16x32_bf16 v[132:135], v[228:231], a[40:43], v[132:135]
v_pk_add_f32 v[42:43], v[42:43], v[44:45]
v_mfma_f32_16x16x32_bf16 v[164:167], v[228:231], a[44:47], v[164:167]
v_pk_mul_f32 v[8:9], v[6:7], s[82:83]
s_waitcnt lgkmcnt(8)
v_mfma_f32_16x16x32_bf16 v[72:75], v[232:235], a[32:35], v[72:75]
ds_read_b64_tr_b16 v[228:229], v51 offset:28672
v_mfma_f32_16x16x32_bf16 v[104:107], v[232:235], a[36:39], v[104:107]
ds_read_b64_tr_b16 v[230:231], v51 offset:30720
v_mfma_f32_16x16x32_bf16 v[136:139], v[232:235], a[40:43], v[136:139]
v_pk_mul_f32 v[18:19], v[16:17], s[82:83]
v_mfma_f32_16x16x32_bf16 v[168:171], v[232:235], a[44:47], v[168:171]
v_pk_mul_f32 v[34:35], v[32:33], s[82:83]
s_waitcnt lgkmcnt(8)
v_mfma_f32_16x16x32_bf16 v[76:79], v[236:239], a[32:35], v[76:79]
s_barrier
ds_read_b64_tr_b16 v[232:233], v48 offset:32768
v_mfma_f32_16x16x32_bf16 v[108:111], v[236:239], a[36:39], v[108:111]
ds_read_b64_tr_b16 v[234:235], v48 offset:34816
v_mfma_f32_16x16x32_bf16 v[140:143], v[236:239], a[40:43], v[140:143]
v_pk_mul_f32 v[44:45], v[42:43], s[82:83]
v_mfma_f32_16x16x32_bf16 v[172:175], v[236:239], a[44:47], v[172:175]
v_fma_f32 v10, -v8, v8, v9
s_waitcnt lgkmcnt(8)
v_mfma_f32_16x16x32_bf16 v[80:83], v[240:243], a[32:35], v[80:83]
ds_read_b64_tr_b16 v[236:237], v49 offset:32768
s_add_u32 m0, s61, 32768
v_mfma_f32_16x16x32_bf16 v[112:115], v[240:243], a[36:39], v[112:115]
ds_read_b64_tr_b16 v[238:239], v49 offset:34816
s_mov_b32 s50, 901120
v_mfma_f32_16x16x32_bf16 v[144:147], v[240:243], a[40:43], v[144:147]
buffer_load_dwordx4 v21, s[24:27], s50 offen lds
v_mfma_f32_16x16x32_bf16 v[176:179], v[240:243], a[44:47], v[176:179]
v_fma_f32 v26, -v18, v18, v19
s_waitcnt lgkmcnt(8)
v_mfma_f32_16x16x32_bf16 v[84:87], v[244:247], a[32:35], v[84:87]
ds_read_b64_tr_b16 v[240:241], v50 offset:32768
v_fma_f32 v36, -v34, v34, v35
v_mfma_f32_16x16x32_bf16 v[116:119], v[244:247], a[36:39], v[116:119]
ds_read_b64_tr_b16 v[242:243], v50 offset:34816
v_fma_f32 v52, -v44, v44, v45
v_mfma_f32_16x16x32_bf16 v[148:151], v[244:247], a[40:43], v[148:151]
v_max_f32 v10, 0, v10
v_max_f32 v26, 0, v26
v_mfma_f32_16x16x32_bf16 v[180:183], v[244:247], a[44:47], v[180:183]
v_max_f32 v36, 0, v36
s_waitcnt lgkmcnt(8)
v_mfma_f32_16x16x32_bf16 v[88:91], v[224:227], a[32:35], v[88:91]
ds_read_b64_tr_b16 v[244:245], v51 offset:32768
v_max_f32 v52, 0, v52
v_mfma_f32_16x16x32_bf16 v[120:123], v[224:227], a[36:39], v[120:123]
ds_read_b64_tr_b16 v[246:247], v51 offset:34816
v_add_f32 v10, 0x3727c5ac, v10
v_mfma_f32_16x16x32_bf16 v[152:155], v[224:227], a[40:43], v[152:155]
v_add_f32 v26, 0x3727c5ac, v26
v_add_f32 v36, 0x3727c5ac, v36
v_mfma_f32_16x16x32_bf16 v[184:187], v[224:227], a[44:47], v[184:187]
v_add_f32 v52, 0x3727c5ac, v52
s_waitcnt lgkmcnt(8)
v_mfma_f32_16x16x32_bf16 v[92:95], v[228:231], a[32:35], v[92:95]
ds_read_b64_tr_b16 v[224:225], v48 offset:36864
v_mfma_f32_16x16x32_bf16 v[124:127], v[228:231], a[36:39], v[124:127]
ds_read_b64_tr_b16 v[226:227], v48 offset:38912
v_mfma_f32_16x16x32_bf16 v[156:159], v[228:231], a[40:43], v[156:159]
v_rsq_f32 v11, v10
v_mfma_f32_16x16x32_bf16 v[188:191], v[228:231], a[44:47], v[188:191]
v_rsq_f32 v27, v26
s_waitcnt vmcnt(5)
s_waitcnt lgkmcnt(8)
v_mfma_f32_16x16x32_bf16 v[64:67], v[232:235], a[48:51], v[64:67]
ds_read_b64_tr_b16 v[228:229], v49 offset:36864
s_add_u32 m0, s61, 36864
v_mfma_f32_16x16x32_bf16 v[96:99], v[232:235], a[52:55], v[96:99]
ds_read_b64_tr_b16 v[230:231], v49 offset:38912
s_mov_b32 s50, 942080
v_mfma_f32_16x16x32_bf16 v[128:131], v[232:235], a[56:59], v[128:131]
buffer_load_dwordx4 v21, s[24:27], s50 offen lds
v_mfma_f32_16x16x32_bf16 v[160:163], v[232:235], a[60:63], v[160:163]
v_rsq_f32 v37, v36
s_waitcnt lgkmcnt(8)
v_mfma_f32_16x16x32_bf16 v[68:71], v[236:239], a[48:51], v[68:71]
ds_read_b64_tr_b16 v[232:233], v50 offset:36864
v_mfma_f32_16x16x32_bf16 v[100:103], v[236:239], a[52:55], v[100:103]
ds_read_b64_tr_b16 v[234:235], v50 offset:38912
v_mfma_f32_16x16x32_bf16 v[132:135], v[236:239], a[56:59], v[132:135]
v_rsq_f32 v53, v52
v_mfma_f32_16x16x32_bf16 v[164:167], v[236:239], a[60:63], v[164:167]
v_mul_f32 v12, 0xc0135761, v11
s_waitcnt lgkmcnt(8)
v_mfma_f32_16x16x32_bf16 v[72:75], v[240:243], a[48:51], v[72:75]
ds_read_b64_tr_b16 v[236:237], v51 offset:36864
v_mul_f32 v28, 0xc0135761, v27
v_mfma_f32_16x16x32_bf16 v[104:107], v[240:243], a[52:55], v[104:107]
ds_read_b64_tr_b16 v[238:239], v51 offset:38912
v_mul_f32 v38, 0xc0135761, v37
v_mfma_f32_16x16x32_bf16 v[136:139], v[240:243], a[56:59], v[136:139]
v_mul_f32 v54, 0xc0135761, v53
v_mul_f32 v14, v11, v11
v_mfma_f32_16x16x32_bf16 v[168:171], v[240:243], a[60:63], v[168:171]
v_mul_f32 v30, v27, v27
s_waitcnt lgkmcnt(8)
v_mfma_f32_16x16x32_bf16 v[76:79], v[244:247], a[48:51], v[76:79]
v_mul_f32 v40, v37, v37
v_mul_f32 v56, v53, v53
v_mfma_f32_16x16x32_bf16 v[108:111], v[244:247], a[52:55], v[108:111]
v_mul_f32 v14, v14, v12
v_mul_f32 v30, v30, v28
v_mfma_f32_16x16x32_bf16 v[140:143], v[244:247], a[56:59], v[140:143]
v_mul_f32 v40, v40, v38
v_mul_f32 v56, v56, v54
v_mfma_f32_16x16x32_bf16 v[172:175], v[244:247], a[60:63], v[172:175]
v_mul_f32 v14, 0x3d372713, v14
s_waitcnt lgkmcnt(6)
v_mfma_f32_16x16x32_bf16 v[80:83], v[224:227], a[48:51], v[80:83]
v_mul_f32 v30, 0x3d372713, v30
v_mul_f32 v40, 0x3d372713, v40
v_mfma_f32_16x16x32_bf16 v[112:115], v[224:227], a[52:55], v[112:115]
v_mul_f32 v56, 0x3d372713, v56
v_mfma_f32_16x16x32_bf16 v[144:147], v[224:227], a[56:59], v[144:147]
v_mfma_f32_16x16x32_bf16 v[176:179], v[224:227], a[60:63], v[176:179]
s_waitcnt lgkmcnt(4)
v_mfma_f32_16x16x32_bf16 v[84:87], v[228:231], a[48:51], v[84:87]
v_mfma_f32_16x16x32_bf16 v[116:119], v[228:231], a[52:55], v[116:119]
v_mfma_f32_16x16x32_bf16 v[148:151], v[228:231], a[56:59], v[148:151]
v_mfma_f32_16x16x32_bf16 v[180:183], v[228:231], a[60:63], v[180:183]
s_waitcnt lgkmcnt(2)
v_mfma_f32_16x16x32_bf16 v[88:91], v[232:235], a[48:51], v[88:91]
v_mfma_f32_16x16x32_bf16 v[120:123], v[232:235], a[52:55], v[120:123]
v_mfma_f32_16x16x32_bf16 v[152:155], v[232:235], a[56:59], v[152:155]
v_mfma_f32_16x16x32_bf16 v[184:187], v[232:235], a[60:63], v[184:187]
s_waitcnt lgkmcnt(0)
v_mfma_f32_16x16x32_bf16 v[92:95], v[236:239], a[48:51], v[92:95]
v_mfma_f32_16x16x32_bf16 v[124:127], v[236:239], a[52:55], v[124:127]
v_mfma_f32_16x16x32_bf16 v[156:159], v[236:239], a[56:59], v[156:159]
v_mfma_f32_16x16x32_bf16 v[188:191], v[236:239], a[60:63], v[188:191]
s_waitcnt vmcnt(5)
s_barrier
s_mul_i32 s56, s54, 55296
s_lshl_b32 s57, s42, 11
s_add_u32 s56, s56, s57
s_add_u32 s56, s56, 696320
s_add_u32 s56, s56, s101
v_pk_fma_f32 v[64:65], v[8:9], v[192:193], v[64:65] op_sel_hi:[0,1,1] neg_lo:[1,0,0] neg_hi:[1,0,0]
v_pk_fma_f32 v[66:67], v[8:9], v[194:195], v[66:67] op_sel_hi:[0,1,1] neg_lo:[1,0,0] neg_hi:[1,0,0]
v_pk_fma_f32 v[68:69], v[8:9], v[196:197], v[68:69] op_sel_hi:[0,1,1] neg_lo:[1,0,0] neg_hi:[1,0,0]
v_pk_fma_f32 v[70:71], v[8:9], v[198:199], v[70:71] op_sel_hi:[0,1,1] neg_lo:[1,0,0] neg_hi:[1,0,0]
v_pk_mul_f32 v[224:225], v[64:65], v[64:65]
v_pk_mul_f32 v[226:227], v[66:67], v[66:67]
s_add_u32 m0, s61, 40960
s_mov_b32 s50, 983040
buffer_load_dwordx4 v21, s[24:27], s50 offen lds
v_pk_mul_f32 v[228:229], v[68:69], v[68:69]
v_pk_mul_f32 v[230:231], v[70:71], v[70:71]
v_pk_fma_f32 v[224:225], v[224:225], v[14:15], v[12:13] op_sel_hi:[1,0,0]
v_pk_fma_f32 v[226:227], v[226:227], v[14:15], v[12:13] op_sel_hi:[1,0,0]
v_pk_fma_f32 v[228:229], v[228:229], v[14:15], v[12:13] op_sel_hi:[1,0,0]
v_pk_fma_f32 v[230:231], v[230:231], v[14:15], v[12:13] op_sel_hi:[1,0,0]
v_pk_mul_f32 v[224:225], v[224:225], v[64:65]
v_pk_mul_f32 v[226:227], v[226:227], v[66:67]
v_pk_mul_f32 v[228:229], v[228:229], v[68:69]
v_pk_mul_f32 v[230:231], v[230:231], v[70:71]
v_exp_f32 v224, v224
v_exp_f32 v225, v225
v_pk_fma_f32 v[80:81], v[8:9], v[208:209], v[80:81] op_sel_hi:[0,1,1] neg_lo:[1,0,0] neg_hi:[1,0,0]
v_exp_f32 v226, v226
v_exp_f32 v227, v227
v_pk_fma_f32 v[82:83], v[8:9], v[210:211], v[82:83] op_sel_hi:[0,1,1] neg_lo:[1,0,0] neg_hi:[1,0,0]
v_exp_f32 v228, v228
v_exp_f32 v229, v229
v_pk_fma_f32 v[84:85], v[8:9], v[212:213], v[84:85] op_sel_hi:[0,1,1] neg_lo:[1,0,0] neg_hi:[1,0,0]
v_exp_f32 v230, v230
v_exp_f32 v231, v231
v_pk_fma_f32 v[86:87], v[8:9], v[214:215], v[86:87] op_sel_hi:[0,1,1] neg_lo:[1,0,0] neg_hi:[1,0,0]
s_add_u32 m0, s61, 45056
s_mov_b32 s50, 1024000
buffer_load_dwordx4 v21, s[24:27], s50 offen lds
v_pk_fma_f32 v[224:225], v[224:225], v[10:11], v[10:11] op_sel_hi:[1,0,0]
v_pk_fma_f32 v[226:227], v[226:227], v[10:11], v[10:11] op_sel_hi:[1,0,0]
v_pk_fma_f32 v[228:229], v[228:229], v[10:11], v[10:11] op_sel_hi:[1,0,0]
v_pk_fma_f32 v[230:231], v[230:231], v[10:11], v[10:11] op_sel_hi:[1,0,0]
v_rcp_f32 v224, v224
v_rcp_f32 v225, v225
v_pk_mul_f32 v[64:65], v[64:65], v[80:81]
v_rcp_f32 v226, v226
v_rcp_f32 v227, v227
v_pk_mul_f32 v[66:67], v[66:67], v[82:83]
v_rcp_f32 v228, v228
v_rcp_f32 v229, v229
v_pk_mul_f32 v[68:69], v[68:69], v[84:85]
v_rcp_f32 v230, v230
v_rcp_f32 v231, v231
v_pk_mul_f32 v[70:71], v[70:71], v[86:87]
v_pk_mul_f32 v[64:65], v[64:65], v[224:225]
v_pk_mul_f32 v[66:67], v[66:67], v[226:227]
v_pk_mul_f32 v[68:69], v[68:69], v[228:229]
v_pk_mul_f32 v[70:71], v[70:71], v[230:231]
v_cvt_pk_bf16_f32 v240, v64, v65
v_cvt_pk_bf16_f32 v241, v66, v67
s_add_u32 m0, s61, 49152
s_mov_b32 s50, 1064960
buffer_load_dwordx4 v21, s[24:27], s50 offen lds
v_cvt_pk_bf16_f32 v242, v68, v69
v_cvt_pk_bf16_f32 v243, v70, v71
s_add_u32 s57, s56, 0
buffer_store_dwordx4 v[240:243], v4, s[32:35], s57 offen sc1
v_pk_fma_f32 v[72:73], v[8:9], v[200:201], v[72:73] op_sel_hi:[0,1,1] neg_lo:[1,0,0] neg_hi:[1,0,0]
v_pk_fma_f32 v[74:75], v[8:9], v[202:203], v[74:75] op_sel_hi:[0,1,1] neg_lo:[1,0,0] neg_hi:[1,0,0]
v_pk_fma_f32 v[76:77], v[8:9], v[204:205], v[76:77] op_sel_hi:[0,1,1] neg_lo:[1,0,0] neg_hi:[1,0,0]
v_pk_fma_f32 v[78:79], v[8:9], v[206:207], v[78:79] op_sel_hi:[0,1,1] neg_lo:[1,0,0] neg_hi:[1,0,0]
v_pk_mul_f32 v[232:233], v[72:73], v[72:73]
v_pk_mul_f32 v[234:235], v[74:75], v[74:75]
v_pk_mul_f32 v[236:237], v[76:77], v[76:77]
v_pk_mul_f32 v[238:239], v[78:79], v[78:79]
v_pk_fma_f32 v[232:233], v[232:233], v[14:15], v[12:13] op_sel_hi:[1,0,0]
v_pk_fma_f32 v[234:235], v[234:235], v[14:15], v[12:13] op_sel_hi:[1,0,0]
v_pk_fma_f32 v[236:237], v[236:237], v[14:15], v[12:13] op_sel_hi:[1,0,0]
v_pk_fma_f32 v[238:239], v[238:239], v[14:15], v[12:13] op_sel_hi:[1,0,0]
v_pk_mul_f32 v[232:233], v[232:233], v[72:73]
v_pk_mul_f32 v[234:235], v[234:235], v[74:75]
v_pk_mul_f32 v[236:237], v[236:237], v[76:77]
v_pk_mul_f32 v[238:239], v[238:239], v[78:79]
v_exp_f32 v232, v232
v_exp_f32 v233, v233
s_add_u32 m0, s61, 53248
s_mov_b32 s50, 1105920
buffer_load_dwordx4 v21, s[24:27], s50 offen lds
v_pk_fma_f32 v[88:89], v[8:9], v[216:217], v[88:89] op_sel_hi:[0,1,1] neg_lo:[1,0,0] neg_hi:[1,0,0]
v_exp_f32 v234, v234
v_exp_f32 v235, v235
v_pk_fma_f32 v[90:91], v[8:9], v[218:219], v[90:91] op_sel_hi:[0,1,1] neg_lo:[1,0,0] neg_hi:[1,0,0]
v_exp_f32 v236, v236
v_exp_f32 v237, v237
v_pk_fma_f32 v[92:93], v[8:9], v[220:221], v[92:93] op_sel_hi:[0,1,1] neg_lo:[1,0,0] neg_hi:[1,0,0]
v_exp_f32 v238, v238
v_exp_f32 v239, v239
v_pk_fma_f32 v[94:95], v[8:9], v[222:223], v[94:95] op_sel_hi:[0,1,1] neg_lo:[1,0,0] neg_hi:[1,0,0]
v_pk_fma_f32 v[232:233], v[232:233], v[10:11], v[10:11] op_sel_hi:[1,0,0]
v_pk_fma_f32 v[234:235], v[234:235], v[10:11], v[10:11] op_sel_hi:[1,0,0]
v_pk_fma_f32 v[236:237], v[236:237], v[10:11], v[10:11] op_sel_hi:[1,0,0]
v_pk_fma_f32 v[238:239], v[238:239], v[10:11], v[10:11] op_sel_hi:[1,0,0]
v_rcp_f32 v232, v232
v_rcp_f32 v233, v233
v_pk_mul_f32 v[72:73], v[72:73], v[88:89]
v_rcp_f32 v234, v234
v_rcp_f32 v235, v235
v_pk_mul_f32 v[74:75], v[74:75], v[90:91]
v_rcp_f32 v236, v236
v_rcp_f32 v237, v237
s_add_u32 m0, s61, 57344
s_mov_b32 s50, 1146880
buffer_load_dwordx4 v21, s[24:27], s50 offen lds
v_pk_mul_f32 v[76:77], v[76:77], v[92:93]
v_rcp_f32 v238, v238
v_rcp_f32 v239, v239
v_pk_mul_f32 v[78:79], v[78:79], v[94:95]
v_pk_mul_f32 v[72:73], v[72:73], v[232:233]
v_pk_mul_f32 v[74:75], v[74:75], v[234:235]
v_pk_mul_f32 v[76:77], v[76:77], v[236:237]
v_pk_mul_f32 v[78:79], v[78:79], v[238:239]
v_cvt_pk_bf16_f32 v244, v72, v73
v_cvt_pk_bf16_f32 v245, v74, v75
v_cvt_pk_bf16_f32 v246, v76, v77
v_cvt_pk_bf16_f32 v247, v78, v79
s_add_u32 s57, s56, 1024
buffer_store_dwordx4 v[244:247], v4, s[32:35], s57 offen sc1
v_pk_fma_f32 v[96:97], v[18:19], v[192:193], v[96:97] op_sel_hi:[0,1,1] neg_lo:[1,0,0] neg_hi:[1,0,0]
v_pk_fma_f32 v[98:99], v[18:19], v[194:195], v[98:99] op_sel_hi:[0,1,1] neg_lo:[1,0,0] neg_hi:[1,0,0]
v_pk_fma_f32 v[100:101], v[18:19], v[196:197], v[100:101] op_sel_hi:[0,1,1] neg_lo:[1,0,0] neg_hi:[1,0,0]
v_pk_fma_f32 v[102:103], v[18:19], v[198:199], v[102:103] op_sel_hi:[0,1,1] neg_lo:[1,0,0] neg_hi:[1,0,0]
v_pk_mul_f32 v[224:225], v[96:97], v[96:97]
v_pk_mul_f32 v[226:227], v[98:99], v[98:99]
v_pk_mul_f32 v[228:229], v[100:101], v[100:101]
v_pk_mul_f32 v[230:231], v[102:103], v[102:103]
s_add_u32 m0, s61, 61440
s_mov_b32 s50, 1187840
buffer_load_dwordx4 v21, s[24:27], s50 offen lds
v_pk_fma_f32 v[224:225], v[224:225], v[30:31], v[28:29] op_sel_hi:[1,0,0]
v_pk_fma_f32 v[226:227], v[226:227], v[30:31], v[28:29] op_sel_hi:[1,0,0]
v_pk_fma_f32 v[228:229], v[228:229], v[30:31], v[28:29] op_sel_hi:[1,0,0]
v_pk_fma_f32 v[230:231], v[230:231], v[30:31], v[28:29] op_sel_hi:[1,0,0]
v_pk_mul_f32 v[224:225], v[224:225], v[96:97]
v_pk_mul_f32 v[226:227], v[226:227], v[98:99]
v_pk_mul_f32 v[228:229], v[228:229], v[100:101]
v_pk_mul_f32 v[230:231], v[230:231], v[102:103]
v_exp_f32 v224, v224
v_exp_f32 v225, v225
v_pk_fma_f32 v[112:113], v[18:19], v[208:209], v[112:113] op_sel_hi:[0,1,1] neg_lo:[1,0,0] neg_hi:[1,0,0]
v_exp_f32 v226, v226
v_exp_f32 v227, v227
v_pk_fma_f32 v[114:115], v[18:19], v[210:211], v[114:115] op_sel_hi:[0,1,1] neg_lo:[1,0,0] neg_hi:[1,0,0]
v_exp_f32 v228, v228
v_exp_f32 v229, v229
v_pk_fma_f32 v[116:117], v[18:19], v[212:213], v[116:117] op_sel_hi:[0,1,1] neg_lo:[1,0,0] neg_hi:[1,0,0]
v_exp_f32 v230, v230
v_exp_f32 v231, v231
v_pk_fma_f32 v[118:119], v[18:19], v[214:215], v[118:119] op_sel_hi:[0,1,1] neg_lo:[1,0,0] neg_hi:[1,0,0]
v_pk_fma_f32 v[224:225], v[224:225], v[26:27], v[26:27] op_sel_hi:[1,0,0]
v_pk_fma_f32 v[226:227], v[226:227], v[26:27], v[26:27] op_sel_hi:[1,0,0]
s_add_u32 m0, s61, 65536
s_mov_b32 s50, 1228800
buffer_load_dwordx4 v21, s[24:27], s50 offen lds
v_pk_fma_f32 v[228:229], v[228:229], v[26:27], v[26:27] op_sel_hi:[1,0,0]
v_pk_fma_f32 v[230:231], v[230:231], v[26:27], v[26:27] op_sel_hi:[1,0,0]
v_rcp_f32 v224, v224
v_rcp_f32 v225, v225
v_pk_mul_f32 v[96:97], v[96:97], v[112:113]
v_rcp_f32 v226, v226
v_rcp_f32 v227, v227
v_pk_mul_f32 v[98:99], v[98:99], v[114:115]
v_rcp_f32 v228, v228
v_rcp_f32 v229, v229
v_pk_mul_f32 v[100:101], v[100:101], v[116:117]
v_rcp_f32 v230, v230
v_rcp_f32 v231, v231
v_pk_mul_f32 v[102:103], v[102:103], v[118:119]
v_pk_mul_f32 v[96:97], v[96:97], v[224:225]
v_pk_mul_f32 v[98:99], v[98:99], v[226:227]
v_pk_mul_f32 v[100:101], v[100:101], v[228:229]
v_pk_mul_f32 v[102:103], v[102:103], v[230:231]
v_cvt_pk_bf16_f32 v240, v96, v97
v_cvt_pk_bf16_f32 v241, v98, v99
v_cvt_pk_bf16_f32 v242, v100, v101
s_add_u32 m0, s61, 69632
s_mov_b32 s50, 1269760
buffer_load_dwordx4 v21, s[24:27], s50 offen lds
v_cvt_pk_bf16_f32 v243, v102, v103
s_add_u32 s57, s56, 55296
buffer_store_dwordx4 v[240:243], v4, s[32:35], s57 offen sc1
v_pk_fma_f32 v[104:105], v[18:19], v[200:201], v[104:105] op_sel_hi:[0,1,1] neg_lo:[1,0,0] neg_hi:[1,0,0]
v_pk_fma_f32 v[106:107], v[18:19], v[202:203], v[106:107] op_sel_hi:[0,1,1] neg_lo:[1,0,0] neg_hi:[1,0,0]
v_pk_fma_f32 v[108:109], v[18:19], v[204:205], v[108:109] op_sel_hi:[0,1,1] neg_lo:[1,0,0] neg_hi:[1,0,0]
v_pk_fma_f32 v[110:111], v[18:19], v[206:207], v[110:111] op_sel_hi:[0,1,1] neg_lo:[1,0,0] neg_hi:[1,0,0]
v_pk_mul_f32 v[232:233], v[104:105], v[104:105]
v_pk_mul_f32 v[234:235], v[106:107], v[106:107]
v_pk_mul_f32 v[236:237], v[108:109], v[108:109]
v_pk_mul_f32 v[238:239], v[110:111], v[110:111]
v_pk_fma_f32 v[232:233], v[232:233], v[30:31], v[28:29] op_sel_hi:[1,0,0]
v_pk_fma_f32 v[234:235], v[234:235], v[30:31], v[28:29] op_sel_hi:[1,0,0]
v_pk_fma_f32 v[236:237], v[236:237], v[30:31], v[28:29] op_sel_hi:[1,0,0]
v_pk_fma_f32 v[238:239], v[238:239], v[30:31], v[28:29] op_sel_hi:[1,0,0]
v_pk_mul_f32 v[232:233], v[232:233], v[104:105]
v_pk_mul_f32 v[234:235], v[234:235], v[106:107]
v_pk_mul_f32 v[236:237], v[236:237], v[108:109]
v_pk_mul_f32 v[238:239], v[238:239], v[110:111]
v_exp_f32 v232, v232
v_exp_f32 v233, v233
v_pk_fma_f32 v[120:121], v[18:19], v[216:217], v[120:121] op_sel_hi:[0,1,1] neg_lo:[1,0,0] neg_hi:[1,0,0]
s_add_u32 m0, s61, 73728
s_mov_b32 s50, 1310720
buffer_load_dwordx4 v21, s[24:27], s50 offen lds
v_exp_f32 v234, v234
v_exp_f32 v235, v235
v_pk_fma_f32 v[122:123], v[18:19], v[218:219], v[122:123] op_sel_hi:[0,1,1] neg_lo:[1,0,0] neg_hi:[1,0,0]
v_exp_f32 v236, v236
v_exp_f32 v237, v237
v_pk_fma_f32 v[124:125], v[18:19], v[220:221], v[124:125] op_sel_hi:[0,1,1] neg_lo:[1,0,0] neg_hi:[1,0,0]
v_exp_f32 v238, v238
v_exp_f32 v239, v239
v_pk_fma_f32 v[126:127], v[18:19], v[222:223], v[126:127] op_sel_hi:[0,1,1] neg_lo:[1,0,0] neg_hi:[1,0,0]
v_pk_fma_f32 v[232:233], v[232:233], v[26:27], v[26:27] op_sel_hi:[1,0,0]
v_pk_fma_f32 v[234:235], v[234:235], v[26:27], v[26:27] op_sel_hi:[1,0,0]
v_pk_fma_f32 v[236:237], v[236:237], v[26:27], v[26:27] op_sel_hi:[1,0,0]
v_pk_fma_f32 v[238:239], v[238:239], v[26:27], v[26:27] op_sel_hi:[1,0,0]
v_rcp_f32 v232, v232
v_rcp_f32 v233, v233
v_pk_mul_f32 v[104:105], v[104:105], v[120:121]
v_rcp_f32 v234, v234
v_rcp_f32 v235, v235
v_pk_mul_f32 v[106:107], v[106:107], v[122:123]
v_rcp_f32 v236, v236
v_rcp_f32 v237, v237
v_pk_mul_f32 v[108:109], v[108:109], v[124:125]
s_add_u32 m0, s61, 77824
s_mov_b32 s50, 1351680
buffer_load_dwordx4 v21, s[24:27], s50 offen lds
v_rcp_f32 v238, v238
v_rcp_f32 v239, v239
v_pk_mul_f32 v[110:111], v[110:111], v[126:127]
v_pk_mul_f32 v[104:105], v[104:105], v[232:233]
v_pk_mul_f32 v[106:107], v[106:107], v[234:235]
v_pk_mul_f32 v[108:109], v[108:109], v[236:237]
v_pk_mul_f32 v[110:111], v[110:111], v[238:239]
v_cvt_pk_bf16_f32 v244, v104, v105
v_cvt_pk_bf16_f32 v245, v106, v107
v_cvt_pk_bf16_f32 v246, v108, v109
v_cvt_pk_bf16_f32 v247, v110, v111
s_add_u32 s57, s56, 56320
buffer_store_dwordx4 v[244:247], v4, s[32:35], s57 offen sc1
v_pk_fma_f32 v[128:129], v[34:35], v[192:193], v[128:129] op_sel_hi:[0,1,1] neg_lo:[1,0,0] neg_hi:[1,0,0]
v_pk_fma_f32 v[130:131], v[34:35], v[194:195], v[130:131] op_sel_hi:[0,1,1] neg_lo:[1,0,0] neg_hi:[1,0,0]
v_pk_fma_f32 v[132:133], v[34:35], v[196:197], v[132:133] op_sel_hi:[0,1,1] neg_lo:[1,0,0] neg_hi:[1,0,0]
v_pk_fma_f32 v[134:135], v[34:35], v[198:199], v[134:135] op_sel_hi:[0,1,1] neg_lo:[1,0,0] neg_hi:[1,0,0]
v_pk_mul_f32 v[224:225], v[128:129], v[128:129]
v_pk_mul_f32 v[226:227], v[130:131], v[130:131]
v_pk_mul_f32 v[228:229], v[132:133], v[132:133]
v_pk_mul_f32 v[230:231], v[134:135], v[134:135]
v_pk_fma_f32 v[224:225], v[224:225], v[40:41], v[38:39] op_sel_hi:[1,0,0]
s_add_u32 m0, s61, 81920
s_mov_b32 s50, 1392640
buffer_load_dwordx4 v21, s[24:27], s50 offen lds
v_pk_fma_f32 v[226:227], v[226:227], v[40:41], v[38:39] op_sel_hi:[1,0,0]
v_pk_fma_f32 v[228:229], v[228:229], v[40:41], v[38:39] op_sel_hi:[1,0,0]
v_pk_fma_f32 v[230:231], v[230:231], v[40:41], v[38:39] op_sel_hi:[1,0,0]
v_pk_mul_f32 v[224:225], v[224:225], v[128:129]
v_pk_mul_f32 v[226:227], v[226:227], v[130:131]
v_pk_mul_f32 v[228:229], v[228:229], v[132:133]
v_pk_mul_f32 v[230:231], v[230:231], v[134:135]
v_exp_f32 v224, v224
v_exp_f32 v225, v225
v_pk_fma_f32 v[144:145], v[34:35], v[208:209], v[144:145] op_sel_hi:[0,1,1] neg_lo:[1,0,0] neg_hi:[1,0,0]
v_exp_f32 v226, v226
v_exp_f32 v227, v227
v_pk_fma_f32 v[146:147], v[34:35], v[210:211], v[146:147] op_sel_hi:[0,1,1] neg_lo:[1,0,0] neg_hi:[1,0,0]
v_exp_f32 v228, v228
v_exp_f32 v229, v229
v_pk_fma_f32 v[148:149], v[34:35], v[212:213], v[148:149] op_sel_hi:[0,1,1] neg_lo:[1,0,0] neg_hi:[1,0,0]
v_exp_f32 v230, v230
v_exp_f32 v231, v231
v_pk_fma_f32 v[150:151], v[34:35], v[214:215], v[150:151] op_sel_hi:[0,1,1] neg_lo:[1,0,0] neg_hi:[1,0,0]
v_pk_fma_f32 v[224:225], v[224:225], v[36:37], v[36:37] op_sel_hi:[1,0,0]
v_pk_fma_f32 v[226:227], v[226:227], v[36:37], v[36:37] op_sel_hi:[1,0,0]
v_pk_fma_f32 v[228:229], v[228:229], v[36:37], v[36:37] op_sel_hi:[1,0,0]
s_add_u32 m0, s61, 86016
s_mov_b32 s50, 1433600
buffer_load_dwordx4 v21, s[24:27], s50 offen lds
v_pk_fma_f32 v[230:231], v[230:231], v[36:37], v[36:37] op_sel_hi:[1,0,0]
v_rcp_f32 v224, v224
v_rcp_f32 v225, v225
v_pk_mul_f32 v[128:129], v[128:129], v[144:145]
v_rcp_f32 v226, v226
v_rcp_f32 v227, v227
v_pk_mul_f32 v[130:131], v[130:131], v[146:147]
v_rcp_f32 v228, v228
v_rcp_f32 v229, v229
v_pk_mul_f32 v[132:133], v[132:133], v[148:149]
v_rcp_f32 v230, v230
v_rcp_f32 v231, v231
v_pk_mul_f32 v[134:135], v[134:135], v[150:151]
v_pk_mul_f32 v[128:129], v[128:129], v[224:225]
v_pk_mul_f32 v[130:131], v[130:131], v[226:227]
v_pk_mul_f32 v[132:133], v[132:133], v[228:229]
v_pk_mul_f32 v[134:135], v[134:135], v[230:231]
v_cvt_pk_bf16_f32 v240, v128, v129
v_cvt_pk_bf16_f32 v241, v130, v131
v_cvt_pk_bf16_f32 v242, v132, v133
v_cvt_pk_bf16_f32 v243, v134, v135
s_add_u32 s57, s56, 110592
s_add_u32 m0, s61, 90112
s_mov_b32 s50, 1474560
buffer_load_dwordx4 v21, s[24:27], s50 offen lds
buffer_store_dwordx4 v[240:243], v4, s[32:35], s57 offen sc1
v_pk_fma_f32 v[136:137], v[34:35], v[200:201], v[136:137] op_sel_hi:[0,1,1] neg_lo:[1,0,0] neg_hi:[1,0,0]
v_pk_fma_f32 v[138:139], v[34:35], v[202:203], v[138:139] op_sel_hi:[0,1,1] neg_lo:[1,0,0] neg_hi:[1,0,0]
v_pk_fma_f32 v[140:141], v[34:35], v[204:205], v[140:141] op_sel_hi:[0,1,1] neg_lo:[1,0,0] neg_hi:[1,0,0]
v_pk_fma_f32 v[142:143], v[34:35], v[206:207], v[142:143] op_sel_hi:[0,1,1] neg_lo:[1,0,0] neg_hi:[1,0,0]
v_pk_mul_f32 v[232:233], v[136:137], v[136:137]
v_pk_mul_f32 v[234:235], v[138:139], v[138:139]
v_pk_mul_f32 v[236:237], v[140:141], v[140:141]
v_pk_mul_f32 v[238:239], v[142:143], v[142:143]
v_pk_fma_f32 v[232:233], v[232:233], v[40:41], v[38:39] op_sel_hi:[1,0,0]
v_pk_fma_f32 v[234:235], v[234:235], v[40:41], v[38:39] op_sel_hi:[1,0,0]
v_pk_fma_f32 v[236:237], v[236:237], v[40:41], v[38:39] op_sel_hi:[1,0,0]
v_pk_fma_f32 v[238:239], v[238:239], v[40:41], v[38:39] op_sel_hi:[1,0,0]
v_pk_mul_f32 v[232:233], v[232:233], v[136:137]
v_pk_mul_f32 v[234:235], v[234:235], v[138:139]
v_pk_mul_f32 v[236:237], v[236:237], v[140:141]
v_pk_mul_f32 v[238:239], v[238:239], v[142:143]
v_exp_f32 v232, v232
v_exp_f32 v233, v233
v_pk_fma_f32 v[152:153], v[34:35], v[216:217], v[152:153] op_sel_hi:[0,1,1] neg_lo:[1,0,0] neg_hi:[1,0,0]
v_exp_f32 v234, v234
s_add_u32 m0, s61, 94208
s_mov_b32 s50, 1515520
buffer_load_dwordx4 v21, s[24:27], s50 offen lds
v_exp_f32 v235, v235
v_pk_fma_f32 v[154:155], v[34:35], v[218:219], v[154:155] op_sel_hi:[0,1,1] neg_lo:[1,0,0] neg_hi:[1,0,0]
v_exp_f32 v236, v236
v_exp_f32 v237, v237
v_pk_fma_f32 v[156:157], v[34:35], v[220:221], v[156:157] op_sel_hi:[0,1,1] neg_lo:[1,0,0] neg_hi:[1,0,0]
v_exp_f32 v238, v238
v_exp_f32 v239, v239
v_pk_fma_f32 v[158:159], v[34:35], v[222:223], v[158:159] op_sel_hi:[0,1,1] neg_lo:[1,0,0] neg_hi:[1,0,0]
v_pk_fma_f32 v[232:233], v[232:233], v[36:37], v[36:37] op_sel_hi:[1,0,0]
v_pk_fma_f32 v[234:235], v[234:235], v[36:37], v[36:37] op_sel_hi:[1,0,0]
v_pk_fma_f32 v[236:237], v[236:237], v[36:37], v[36:37] op_sel_hi:[1,0,0]
v_pk_fma_f32 v[238:239], v[238:239], v[36:37], v[36:37] op_sel_hi:[1,0,0]
v_rcp_f32 v232, v232
v_rcp_f32 v233, v233
v_pk_mul_f32 v[136:137], v[136:137], v[152:153]
v_rcp_f32 v234, v234
v_rcp_f32 v235, v235
v_pk_mul_f32 v[138:139], v[138:139], v[154:155]
v_rcp_f32 v236, v236
v_rcp_f32 v237, v237
v_pk_mul_f32 v[140:141], v[140:141], v[156:157]
v_rcp_f32 v238, v238
s_add_u32 m0, s61, 98304
s_mov_b32 s50, 1556480
buffer_load_dwordx4 v21, s[24:27], s50 offen lds
v_rcp_f32 v239, v239
v_pk_mul_f32 v[142:143], v[142:143], v[158:159]
v_pk_mul_f32 v[136:137], v[136:137], v[232:233]
v_pk_mul_f32 v[138:139], v[138:139], v[234:235]
v_pk_mul_f32 v[140:141], v[140:141], v[236:237]
v_pk_mul_f32 v[142:143], v[142:143], v[238:239]
v_cvt_pk_bf16_f32 v244, v136, v137
v_cvt_pk_bf16_f32 v245, v138, v139
v_cvt_pk_bf16_f32 v246, v140, v141
v_cvt_pk_bf16_f32 v247, v142, v143
s_add_u32 s57, s56, 111616
buffer_store_dwordx4 v[244:247], v4, s[32:35], s57 offen sc1
v_pk_fma_f32 v[160:161], v[44:45], v[192:193], v[160:161] op_sel_hi:[0,1,1] neg_lo:[1,0,0] neg_hi:[1,0,0]
v_pk_fma_f32 v[162:163], v[44:45], v[194:195], v[162:163] op_sel_hi:[0,1,1] neg_lo:[1,0,0] neg_hi:[1,0,0]
v_pk_fma_f32 v[164:165], v[44:45], v[196:197], v[164:165] op_sel_hi:[0,1,1] neg_lo:[1,0,0] neg_hi:[1,0,0]
v_pk_fma_f32 v[166:167], v[44:45], v[198:199], v[166:167] op_sel_hi:[0,1,1] neg_lo:[1,0,0] neg_hi:[1,0,0]
v_pk_mul_f32 v[224:225], v[160:161], v[160:161]
v_pk_mul_f32 v[226:227], v[162:163], v[162:163]
v_pk_mul_f32 v[228:229], v[164:165], v[164:165]
v_pk_mul_f32 v[230:231], v[166:167], v[166:167]
v_pk_fma_f32 v[224:225], v[224:225], v[56:57], v[54:55] op_sel_hi:[1,0,0]
v_pk_fma_f32 v[226:227], v[226:227], v[56:57], v[54:55] op_sel_hi:[1,0,0]
s_add_u32 m0, s61, 102400
s_mov_b32 s50, 1597440
buffer_load_dwordx4 v21, s[24:27], s50 offen lds
v_pk_fma_f32 v[228:229], v[228:229], v[56:57], v[54:55] op_sel_hi:[1,0,0]
v_pk_fma_f32 v[230:231], v[230:231], v[56:57], v[54:55] op_sel_hi:[1,0,0]
v_pk_mul_f32 v[224:225], v[224:225], v[160:161]
v_pk_mul_f32 v[226:227], v[226:227], v[162:163]
v_pk_mul_f32 v[228:229], v[228:229], v[164:165]
v_pk_mul_f32 v[230:231], v[230:231], v[166:167]
v_exp_f32 v224, v224
v_exp_f32 v225, v225
v_pk_fma_f32 v[176:177], v[44:45], v[208:209], v[176:177] op_sel_hi:[0,1,1] neg_lo:[1,0,0] neg_hi:[1,0,0]
v_exp_f32 v226, v226
v_exp_f32 v227, v227
v_pk_fma_f32 v[178:179], v[44:45], v[210:211], v[178:179] op_sel_hi:[0,1,1] neg_lo:[1,0,0] neg_hi:[1,0,0]
v_exp_f32 v228, v228
v_exp_f32 v229, v229
v_pk_fma_f32 v[180:181], v[44:45], v[212:213], v[180:181] op_sel_hi:[0,1,1] neg_lo:[1,0,0] neg_hi:[1,0,0]
v_exp_f32 v230, v230
v_exp_f32 v231, v231
v_pk_fma_f32 v[182:183], v[44:45], v[214:215], v[182:183] op_sel_hi:[0,1,1] neg_lo:[1,0,0] neg_hi:[1,0,0]
v_pk_fma_f32 v[224:225], v[224:225], v[52:53], v[52:53] op_sel_hi:[1,0,0]
v_pk_fma_f32 v[226:227], v[226:227], v[52:53], v[52:53] op_sel_hi:[1,0,0]
v_pk_fma_f32 v[228:229], v[228:229], v[52:53], v[52:53] op_sel_hi:[1,0,0]
v_pk_fma_f32 v[230:231], v[230:231], v[52:53], v[52:53] op_sel_hi:[1,0,0]
v_rcp_f32 v224, v224
v_rcp_f32 v225, v225
v_pk_mul_f32 v[160:161], v[160:161], v[176:177]
v_rcp_f32 v226, v226
v_rcp_f32 v227, v227
v_pk_mul_f32 v[162:163], v[162:163], v[178:179]
v_rcp_f32 v228, v228
v_rcp_f32 v229, v229
v_pk_mul_f32 v[164:165], v[164:165], v[180:181]
v_rcp_f32 v230, v230
v_rcp_f32 v231, v231
v_pk_mul_f32 v[166:167], v[166:167], v[182:183]
v_pk_mul_f32 v[160:161], v[160:161], v[224:225]
v_pk_mul_f32 v[162:163], v[162:163], v[226:227]
v_pk_mul_f32 v[164:165], v[164:165], v[228:229]
v_pk_mul_f32 v[166:167], v[166:167], v[230:231]
v_cvt_pk_bf16_f32 v240, v160, v161
v_cvt_pk_bf16_f32 v241, v162, v163
v_cvt_pk_bf16_f32 v242, v164, v165
v_cvt_pk_bf16_f32 v243, v166, v167
s_add_u32 s57, s56, 165888
buffer_store_dwordx4 v[240:243], v4, s[32:35], s57 offen sc1
v_pk_fma_f32 v[168:169], v[44:45], v[200:201], v[168:169] op_sel_hi:[0,1,1] neg_lo:[1,0,0] neg_hi:[1,0,0]
v_pk_fma_f32 v[170:171], v[44:45], v[202:203], v[170:171] op_sel_hi:[0,1,1] neg_lo:[1,0,0] neg_hi:[1,0,0]
v_pk_fma_f32 v[172:173], v[44:45], v[204:205], v[172:173] op_sel_hi:[0,1,1] neg_lo:[1,0,0] neg_hi:[1,0,0]
v_pk_fma_f32 v[174:175], v[44:45], v[206:207], v[174:175] op_sel_hi:[0,1,1] neg_lo:[1,0,0] neg_hi:[1,0,0]
v_pk_mul_f32 v[232:233], v[168:169], v[168:169]
v_pk_mul_f32 v[234:235], v[170:171], v[170:171]
v_pk_mul_f32 v[236:237], v[172:173], v[172:173]
v_pk_mul_f32 v[238:239], v[174:175], v[174:175]
v_pk_fma_f32 v[232:233], v[232:233], v[56:57], v[54:55] op_sel_hi:[1,0,0]
v_pk_fma_f32 v[234:235], v[234:235], v[56:57], v[54:55] op_sel_hi:[1,0,0]
v_pk_fma_f32 v[236:237], v[236:237], v[56:57], v[54:55] op_sel_hi:[1,0,0]
v_pk_fma_f32 v[238:239], v[238:239], v[56:57], v[54:55] op_sel_hi:[1,0,0]
v_pk_mul_f32 v[232:233], v[232:233], v[168:169]
v_pk_mul_f32 v[234:235], v[234:235], v[170:171]
v_pk_mul_f32 v[236:237], v[236:237], v[172:173]
v_pk_mul_f32 v[238:239], v[238:239], v[174:175]
v_exp_f32 v232, v232
v_exp_f32 v233, v233
v_pk_fma_f32 v[184:185], v[44:45], v[216:217], v[184:185] op_sel_hi:[0,1,1] neg_lo:[1,0,0] neg_hi:[1,0,0]
v_exp_f32 v234, v234
v_exp_f32 v235, v235
v_pk_fma_f32 v[186:187], v[44:45], v[218:219], v[186:187] op_sel_hi:[0,1,1] neg_lo:[1,0,0] neg_hi:[1,0,0]
v_exp_f32 v236, v236
v_exp_f32 v237, v237
v_pk_fma_f32 v[188:189], v[44:45], v[220:221], v[188:189] op_sel_hi:[0,1,1] neg_lo:[1,0,0] neg_hi:[1,0,0]
v_exp_f32 v238, v238
v_exp_f32 v239, v239
v_pk_fma_f32 v[190:191], v[44:45], v[222:223], v[190:191] op_sel_hi:[0,1,1] neg_lo:[1,0,0] neg_hi:[1,0,0]
v_pk_fma_f32 v[232:233], v[232:233], v[52:53], v[52:53] op_sel_hi:[1,0,0]
v_pk_fma_f32 v[234:235], v[234:235], v[52:53], v[52:53] op_sel_hi:[1,0,0]
v_pk_fma_f32 v[236:237], v[236:237], v[52:53], v[52:53] op_sel_hi:[1,0,0]
v_pk_fma_f32 v[238:239], v[238:239], v[52:53], v[52:53] op_sel_hi:[1,0,0]
v_rcp_f32 v232, v232
v_rcp_f32 v233, v233
v_pk_mul_f32 v[168:169], v[168:169], v[184:185]
v_rcp_f32 v234, v234
v_rcp_f32 v235, v235
v_pk_mul_f32 v[170:171], v[170:171], v[186:187]
v_rcp_f32 v236, v236
v_rcp_f32 v237, v237
v_pk_mul_f32 v[172:173], v[172:173], v[188:189]
v_rcp_f32 v238, v238
v_rcp_f32 v239, v239
v_pk_mul_f32 v[174:175], v[174:175], v[190:191]
v_pk_mul_f32 v[168:169], v[168:169], v[232:233]
v_pk_mul_f32 v[170:171], v[170:171], v[234:235]
v_pk_mul_f32 v[172:173], v[172:173], v[236:237]
v_pk_mul_f32 v[174:175], v[174:175], v[238:239]
v_cvt_pk_bf16_f32 v244, v168, v169
v_cvt_pk_bf16_f32 v245, v170, v171
v_cvt_pk_bf16_f32 v246, v172, v173
v_cvt_pk_bf16_f32 v247, v174, v175
s_add_u32 s57, s56, 166912
buffer_store_dwordx4 v[244:247], v4, s[32:35], s57 offen sc1
s_waitcnt vmcnt(0)
s_barrier
s_cmp_lg_u32 s40, 0
s_cbranch_scc1 L_nw38
s_cmp_eq_u32 s84, 0
s_cbranch_scc1 L_as39
v_mov_b32 v60, 0
v_mov_b32 v61, 1
s_lshl_b32 s50, s41, 7
s_lshl_b32 s51, s42, 2
s_add_u32 s50, s50, s51
s_add_u32 s50, s50, 18432
s_mov_b64 exec, 1
buffer_store_dword v61, v60, s[32:35], s50 offen
s_mov_b64 exec, -1
s_branch L_ad40
L_as39:
s_lshl_b32 s50, s41, 8
s_add_u32 s50, s50, 8192
v_mov_b32 v60, 0
v_mov_b32 v61, 1
s_mov_b64 exec, 1
buffer_atomic_add v61, v60, s[32:35], s50 offen sc1
s_mov_b64 exec, -1
L_ad40:
L_nw38:
L_p4:
s_mul_i32 s55, s59, 55296
s_lshl_b32 s50, s48, 10
s_add_u32 s55, s55, s50
s_add_u32 s55, s55, 696320
s_add_u32 s55, s55, s101
v_add_u32 v5, s55, v4
v_add_u32 v6, 55296, v5
v_add_u32 v7, 110592, v5
s_add_u32 s56, s88, 327680
s_lshl_b32 s50, s45, 11
s_add_u32 s56, s56, s50
s_add_u32 s51, s56, 0
buffer_load_dwordx4 v[112:115], v4, s[32:35], s51 offen sc1
s_add_u32 s51, s56, 20480
buffer_load_dwordx4 v[116:119], v4, s[32:35], s51 offen sc1
s_add_u32 s51, s56, 40960
buffer_load_dwordx4 v[120:123], v4, s[32:35], s51 offen sc1
s_lshl_b32 s50, s48, 6
v_xor_b32 v60, s50, v25
s_lshl_b32 s50, s48, 12
s_add_u32 s50, s50, 106496
v_xor_b32 v48, 0, v60
v_xor_b32 v49, 32, v60
v_xor_b32 v50, 64, v60
v_xor_b32 v51, 96, v60
v_add_u32 v48, s50, v48
v_add_u32 v49, s50, v49
v_add_u32 v50, s50, v50
v_add_u32 v51, s50, v51
s_mul_i32 s50, s40, 6144
s_add_u32 s50, s50, 73728
v_add_u32 v56, s50, v4
s_xor_b32 s50, s40, 1
s_mul_i32 s50, s50, 6144
s_add_u32 s50, s50, 73728
v_add_u32 v57, s50, v4
v_mul_u32_u24 v46, 1280, v2
v_and_b32 v60, 1, v3
v_lshl_add_u32 v46, v60, 5, v46
v_lshrrev_b32 v60, 1, v3
v_lshl_add_u32 v46, v60, 4, v46
s_cmp_lg_u32 s40, 0
s_nop 0
s_cbranch_scc1 L_nw41
s_cmp_eq_u32 s84, 0
s_cbranch_scc1 L_ps42
s_lshl_b32 s50, s41, 7
s_add_u32 s50, s50, 18432
v_min_u32 v60, 26, v1
v_lshlrev_b32 v60, 2, v60
s_mov_b32 s51, 400000
L_pf44:
buffer_load_dword v61, v60, s[32:35], s50 offen sc1
s_waitcnt vmcnt(0)
v_cmp_eq_u32 vcc, 0, v61
s_nop 1
s_nop 2
s_cbranch_vccz L_pe43
s_sub_u32 s51, s51, 1
s_cmp_lg_u32 s51, 0
s_cbranch_scc1 L_pf44
s_branch L_pe43
L_ps42:
s_lshl_b32 s50, s41, 8
s_add_u32 s50, s50, 8192
v_mov_b32 v60, 0
s_mov_b32 s51, 400000
L_poll45:
buffer_load_dword v61, v60, s[32:35], s50 offen sc1
s_waitcnt vmcnt(0)
v_readfirstlane_b32 s52, v61
s_nop 0
s_cmp_ge_u32 s52, 27
s_nop 2
s_cbranch_scc1 L_pd46
s_sub_u32 s51, s51, 1
s_cmp_lg_u32 s51, 0
s_cbranch_scc1 L_poll45
L_pd46:
L_pe43:
L_nw41:
s_waitcnt vmcnt(3)
s_barrier
s_mov_b32 s62, 0
buffer_load_dwordx4 a[0:3], v5, s[32:35], s62 offen offset:0 sc1
buffer_load_dwordx4 a[4:7], v6, s[32:35], s62 offen offset:0 sc1
buffer_load_dwordx4 a[8:11], v7, s[32:35], s62 offen offset:0 sc1
buffer_load_dwordx4 a[12:15], v5, s[32:35], s62 offen offset:2048 sc1
buffer_load_dwordx4 a[16:19], v6, s[32:35], s62 offen offset:2048 sc1
buffer_load_dwordx4 a[20:23], v7, s[32:35], s62 offen offset:2048 sc1
s_mov_b32 s62, 4096
buffer_load_dwordx4 a[24:27], v5, s[32:35], s62 offen offset:0 sc1
buffer_load_dwordx4 a[28:31], v6, s[32:35], s62 offen offset:0 sc1
buffer_load_dwordx4 a[32:35], v7, s[32:35], s62 offen offset:0 sc1
buffer_load_dwordx4 a[36:39], v5, s[32:35], s62 offen offset:2048 sc1
buffer_load_dwordx4 a[40:43], v6, s[32:35], s62 offen offset:2048 sc1
buffer_load_dwordx4 a[44:47], v7, s[32:35], s62 offen offset:2048 sc1
ds_read_b64_tr_b16 v[144:145], v48 offset:0
ds_read_b64_tr_b16 v[146:147], v48 offset:2048
ds_read_b64_tr_b16 v[148:149], v49 offset:0
ds_read_b64_tr_b16 v[150:151], v49 offset:2048
ds_read_b64_tr_b16 v[152:153], v50 offset:0
ds_read_b64_tr_b16 v[154:155], v50 offset:2048
ds_read_b64_tr_b16 v[156:157], v51 offset:0
ds_read_b64_tr_b16 v[158:159], v51 offset:2048
s_waitcnt vmcnt(9)
s_waitcnt lgkmcnt(6)
v_mfma_f32_16x16x32_bf16 v[64:67], v[144:147], a[0:3], 0
ds_read_b64_tr_b16 v[160:161], v48 offset:8192
s_mov_b32 s62, 8192
v_mfma_f32_16x16x32_bf16 v[80:83], v[144:147], a[4:7], 0
ds_read_b64_tr_b16 v[162:163], v48 offset:10240
v_mfma_f32_16x16x32_bf16 v[96:99], v[144:147], a[8:11], 0
buffer_load_dwordx4 a[48:51], v5, s[32:35], s62 offen offset:0 sc1
s_waitcnt lgkmcnt(6)
v_mfma_f32_16x16x32_bf16 v[68:71], v[148:151], a[0:3], 0
ds_read_b64_tr_b16 v[144:145], v49 offset:8192
v_mfma_f32_16x16x32_bf16 v[84:87], v[148:151], a[4:7], 0
ds_read_b64_tr_b16 v[146:147], v49 offset:10240
v_mfma_f32_16x16x32_bf16 v[100:103], v[148:151], a[8:11], 0
buffer_load_dwordx4 a[52:55], v6, s[32:35], s62 offen offset:0 sc1
s_waitcnt lgkmcnt(6)
v_mfma_f32_16x16x32_bf16 v[72:75], v[152:155], a[0:3], 0
ds_read_b64_tr_b16 v[148:149], v50 offset:8192
v_mfma_f32_16x16x32_bf16 v[88:91], v[152:155], a[4:7], 0
ds_read_b64_tr_b16 v[150:151], v50 offset:10240
v_mfma_f32_16x16x32_bf16 v[104:107], v[152:155], a[8:11], 0
buffer_load_dwordx4 a[56:59], v7, s[32:35], s62 offen offset:0 sc1
s_waitcnt lgkmcnt(6)
v_mfma_f32_16x16x32_bf16 v[76:79], v[156:159], a[0:3], 0
ds_read_b64_tr_b16 v[152:153], v51 offset:8192
v_mfma_f32_16x16x32_bf16 v[92:95], v[156:159], a[4:7], 0
ds_read_b64_tr_b16 v[154:155], v51 offset:10240
v_mfma_f32_16x16x32_bf16 v[108:111], v[156:159], a[8:11], 0
buffer_load_dwordx4 a[60:63], v5, s[32:35], s62 offen offset:2048 sc1
s_waitcnt vmcnt(10)
s_waitcnt lgkmcnt(6)
v_mfma_f32_16x16x32_bf16 v[64:67], v[160:163], a[12:15], v[64:67]
ds_read_b64_tr_b16 v[156:157], v48 offset:16384
v_mfma_f32_16x16x32_bf16 v[80:83], v[160:163], a[16:19], v[80:83]
ds_read_b64_tr_b16 v[158:159], v48 offset:18432
v_mfma_f32_16x16x32_bf16 v[96:99], v[160:163], a[20:23], v[96:99]
buffer_load_dwordx4 a[64:67], v6, s[32:35], s62 offen offset:2048 sc1
s_waitcnt lgkmcnt(6)
v_mfma_f32_16x16x32_bf16 v[68:71], v[144:147], a[12:15], v[68:71]
ds_read_b64_tr_b16 v[160:161], v49 offset:16384
v_mfma_f32_16x16x32_bf16 v[84:87], v[144:147], a[16:19], v[84:87]
ds_read_b64_tr_b16 v[162:163], v49 offset:18432
v_mfma_f32_16x16x32_bf16 v[100:103], v[144:147], a[20:23], v[100:103]
buffer_load_dwordx4 a[68:71], v7, s[32:35], s62 offen offset:2048 sc1
s_waitcnt lgkmcnt(6)
v_mfma_f32_16x16x32_bf16 v[72:75], v[148:151], a[12:15], v[72:75]
ds_read_b64_tr_b16 v[144:145], v50 offset:16384
s_mov_b32 s62, 12288
v_mfma_f32_16x16x32_bf16 v[88:91], v[148:151], a[16:19], v[88:91]
ds_read_b64_tr_b16 v[146:147], v50 offset:18432
v_mfma_f32_16x16x32_bf16 v[104:107], v[148:151], a[20:23], v[104:107]
buffer_load_dwordx4 a[72:75], v5, s[32:35], s62 offen offset:0 sc1
s_waitcnt lgkmcnt(6)
v_mfma_f32_16x16x32_bf16 v[76:79], v[152:155], a[12:15], v[76:79]
ds_read_b64_tr_b16 v[148:149], v51 offset:16384
v_mfma_f32_16x16x32_bf16 v[92:95], v[152:155], a[16:19], v[92:95]
ds_read_b64_tr_b16 v[150:151], v51 offset:18432
v_mfma_f32_16x16x32_bf16 v[108:111], v[152:155], a[20:23], v[108:111]
buffer_load_dwordx4 a[76:79], v6, s[32:35], s62 offen offset:0 sc1
s_waitcnt vmcnt(11)
s_waitcnt lgkmcnt(6)
v_mfma_f32_16x16x32_bf16 v[64:67], v[156:159], a[24:27], v[64:67]
ds_read_b64_tr_b16 v[152:153], v48 offset:24576
v_mfma_f32_16x16x32_bf16 v[80:83], v[156:159], a[28:31], v[80:83]
ds_read_b64_tr_b16 v[154:155], v48 offset:26624
v_mfma_f32_16x16x32_bf16 v[96:99], v[156:159], a[32:35], v[96:99]
buffer_load_dwordx4 a[80:83], v7, s[32:35], s62 offen offset:0 sc1
s_waitcnt lgkmcnt(6)
v_mfma_f32_16x16x32_bf16 v[68:71], v[160:163], a[24:27], v[68:71]
ds_read_b64_tr_b16 v[156:157], v49 offset:24576
v_mfma_f32_16x16x32_bf16 v[84:87], v[160:163], a[28:31], v[84:87]
ds_read_b64_tr_b16 v[158:159], v49 offset:26624
v_mfma_f32_16x16x32_bf16 v[100:103], v[160:163], a[32:35], v[100:103]
buffer_load_dwordx4 a[84:87], v5, s[32:35], s62 offen offset:2048 sc1
s_waitcnt lgkmcnt(6)
v_mfma_f32_16x16x32_bf16 v[72:75], v[144:147], a[24:27], v[72:75]
ds_read_b64_tr_b16 v[160:161], v50 offset:24576
v_mfma_f32_16x16x32_bf16 v[88:91], v[144:147], a[28:31], v[88:91]
ds_read_b64_tr_b16 v[162:163], v50 offset:26624
v_mfma_f32_16x16x32_bf16 v[104:107], v[144:147], a[32:35], v[104:107]
buffer_load_dwordx4 a[88:91], v6, s[32:35], s62 offen offset:2048 sc1
s_waitcnt lgkmcnt(6)
v_mfma_f32_16x16x32_bf16 v[76:79], v[148:151], a[24:27], v[76:79]
ds_read_b64_tr_b16 v[144:145], v51 offset:24576
v_mfma_f32_16x16x32_bf16 v[92:95], v[148:151], a[28:31], v[92:95]
ds_read_b64_tr_b16 v[146:147], v51 offset:26624
v_mfma_f32_16x16x32_bf16 v[108:111], v[148:151], a[32:35], v[108:111]
buffer_load_dwordx4 a[92:95], v7, s[32:35], s62 offen offset:2048 sc1
s_waitcnt vmcnt(12)
s_waitcnt lgkmcnt(6)
v_mfma_f32_16x16x32_bf16 v[64:67], v[152:155], a[36:39], v[64:67]
ds_read_b64_tr_b16 v[148:149], v48 offset:32768
s_mov_b32 s62, 16384
v_mfma_f32_16x16x32_bf16 v[80:83], v[152:155], a[40:43], v[80:83]
ds_read_b64_tr_b16 v[150:151], v48 offset:34816
v_mfma_f32_16x16x32_bf16 v[96:99], v[152:155], a[44:47], v[96:99]
buffer_load_dwordx4 a[96:99], v5, s[32:35], s62 offen offset:0 sc1
s_waitcnt lgkmcnt(6)
v_mfma_f32_16x16x32_bf16 v[68:71], v[156:159], a[36:39], v[68:71]
ds_read_b64_tr_b16 v[152:153], v49 offset:32768
v_mfma_f32_16x16x32_bf16 v[84:87], v[156:159], a[40:43], v[84:87]
ds_read_b64_tr_b16 v[154:155], v49 offset:34816
v_mfma_f32_16x16x32_bf16 v[100:103], v[156:159], a[44:47], v[100:103]
buffer_load_dwordx4 a[100:103], v6, s[32:35], s62 offen offset:0 sc1
s_waitcnt lgkmcnt(6)
v_mfma_f32_16x16x32_bf16 v[72:75], v[160:163], a[36:39], v[72:75]
ds_read_b64_tr_b16 v[156:157], v50 offset:32768
v_mfma_f32_16x16x32_bf16 v[88:91], v[160:163], a[40:43], v[88:91]
ds_read_b64_tr_b16 v[158:159], v50 offset:34816
v_mfma_f32_16x16x32_bf16 v[104:107], v[160:163], a[44:47], v[104:107]
buffer_load_dwordx4 a[104:107], v7, s[32:35], s62 offen offset:0 sc1
s_waitcnt lgkmcnt(6)
v_mfma_f32_16x16x32_bf16 v[76:79], v[144:147], a[36:39], v[76:79]
ds_read_b64_tr_b16 v[160:161], v51 offset:32768
v_mfma_f32_16x16x32_bf16 v[92:95], v[144:147], a[40:43], v[92:95]
ds_read_b64_tr_b16 v[162:163], v51 offset:34816
v_mfma_f32_16x16x32_bf16 v[108:111], v[144:147], a[44:47], v[108:111]
buffer_load_dwordx4 a[108:111], v5, s[32:35], s62 offen offset:2048 sc1
s_waitcnt vmcnt(13)
s_waitcnt lgkmcnt(6)
v_mfma_f32_16x16x32_bf16 v[64:67], v[148:151], a[48:51], v[64:67]
ds_read_b64_tr_b16 v[144:145], v48 offset:40960
v_mfma_f32_16x16x32_bf16 v[80:83], v[148:151], a[52:55], v[80:83]
ds_read_b64_tr_b16 v[146:147], v48 offset:43008
v_mfma_f32_16x16x32_bf16 v[96:99], v[148:151], a[56:59], v[96:99]
buffer_load_dwordx4 a[112:115], v6, s[32:35], s62 offen offset:2048 sc1
s_waitcnt lgkmcnt(6)
v_mfma_f32_16x16x32_bf16 v[68:71], v[152:155], a[48:51], v[68:71]
ds_read_b64_tr_b16 v[148:149], v49 offset:40960
v_mfma_f32_16x16x32_bf16 v[84:87], v[152:155], a[52:55], v[84:87]
ds_read_b64_tr_b16 v[150:151], v49 offset:43008
v_mfma_f32_16x16x32_bf16 v[100:103], v[152:155], a[56:59], v[100:103]
buffer_load_dwordx4 a[116:119], v7, s[32:35], s62 offen offset:2048 sc1
s_waitcnt lgkmcnt(6)
v_mfma_f32_16x16x32_bf16 v[72:75], v[156:159], a[48:51], v[72:75]
ds_read_b64_tr_b16 v[152:153], v50 offset:40960
s_mov_b32 s62, 20480
v_mfma_f32_16x16x32_bf16 v[88:91], v[156:159], a[52:55], v[88:91]
ds_read_b64_tr_b16 v[154:155], v50 offset:43008
v_mfma_f32_16x16x32_bf16 v[104:107], v[156:159], a[56:59], v[104:107]
buffer_load_dwordx4 a[120:123], v5, s[32:35], s62 offen offset:0 sc1
s_waitcnt lgkmcnt(6)
v_mfma_f32_16x16x32_bf16 v[76:79], v[160:163], a[48:51], v[76:79]
ds_read_b64_tr_b16 v[156:157], v51 offset:40960
v_mfma_f32_16x16x32_bf16 v[92:95], v[160:163], a[52:55], v[92:95]
ds_read_b64_tr_b16 v[158:159], v51 offset:43008
v_mfma_f32_16x16x32_bf16 v[108:111], v[160:163], a[56:59], v[108:111]
buffer_load_dwordx4 a[124:127], v6, s[32:35], s62 offen offset:0 sc1
s_waitcnt vmcnt(14)
s_waitcnt lgkmcnt(6)
v_mfma_f32_16x16x32_bf16 v[64:67], v[144:147], a[60:63], v[64:67]
ds_read_b64_tr_b16 v[160:161], v48 offset:49152
v_mfma_f32_16x16x32_bf16 v[80:83], v[144:147], a[64:67], v[80:83]
ds_read_b64_tr_b16 v[162:163], v48 offset:51200
v_mfma_f32_16x16x32_bf16 v[96:99], v[144:147], a[68:71], v[96:99]
buffer_load_dwordx4 a[128:131], v7, s[32:35], s62 offen offset:0 sc1
s_waitcnt lgkmcnt(6)
v_mfma_f32_16x16x32_bf16 v[68:71], v[148:151], a[60:63], v[68:71]
ds_read_b64_tr_b16 v[144:145], v49 offset:49152
v_mfma_f32_16x16x32_bf16 v[84:87], v[148:151], a[64:67], v[84:87]
ds_read_b64_tr_b16 v[146:147], v49 offset:51200
v_mfma_f32_16x16x32_bf16 v[100:103], v[148:151], a[68:71], v[100:103]
buffer_load_dwordx4 a[132:135], v5, s[32:35], s62 offen offset:2048 sc1
s_waitcnt lgkmcnt(6)
v_mfma_f32_16x16x32_bf16 v[72:75], v[152:155], a[60:63], v[72:75]
ds_read_b64_tr_b16 v[148:149], v50 offset:49152
v_mfma_f32_16x16x32_bf16 v[88:91], v[152:155], a[64:67], v[88:91]
ds_read_b64_tr_b16 v[150:151], v50 offset:51200
v_mfma_f32_16x16x32_bf16 v[104:107], v[152:155], a[68:71], v[104:107]
buffer_load_dwordx4 a[136:139], v6, s[32:35], s62 offen offset:2048 sc1
s_waitcnt lgkmcnt(6)
v_mfma_f32_16x16x32_bf16 v[76:79], v[156:159], a[60:63], v[76:79]
ds_read_b64_tr_b16 v[152:153], v51 offset:49152
v_mfma_f32_16x16x32_bf16 v[92:95], v[156:159], a[64:67], v[92:95]
ds_read_b64_tr_b16 v[154:155], v51 offset:51200
v_mfma_f32_16x16x32_bf16 v[108:111], v[156:159], a[68:71], v[108:111]
buffer_load_dwordx4 a[140:143], v7, s[32:35], s62 offen offset:2048 sc1
s_waitcnt vmcnt(15)
s_waitcnt lgkmcnt(6)
v_mfma_f32_16x16x32_bf16 v[64:67], v[160:163], a[72:75], v[64:67]
v_add_u32 v48, 0xfffe6000, v48
v_add_u32 v49, 0xfffe6000, v49
v_add_u32 v50, 0xfffe6000, v50
v_add_u32 v51, 0xfffe6000, v51
ds_read_b64_tr_b16 v[156:157], v48 offset:0
s_mov_b32 s62, 24576
v_mfma_f32_16x16x32_bf16 v[80:83], v[160:163], a[76:79], v[80:83]
ds_read_b64_tr_b16 v[158:159], v48 offset:2048
v_mfma_f32_16x16x32_bf16 v[96:99], v[160:163], a[80:83], v[96:99]
buffer_load_dwordx4 a[144:147], v5, s[32:35], s62 offen offset:0 sc1
s_waitcnt lgkmcnt(6)
v_mfma_f32_16x16x32_bf16 v[68:71], v[144:147], a[72:75], v[68:71]
ds_read_b64_tr_b16 v[160:161], v49 offset:0
v_mfma_f32_16x16x32_bf16 v[84:87], v[144:147], a[76:79], v[84:87]
ds_read_b64_tr_b16 v[162:163], v49 offset:2048
v_mfma_f32_16x16x32_bf16 v[100:103], v[144:147], a[80:83], v[100:103]
buffer_load_dwordx4 a[148:151], v6, s[32:35], s62 offen offset:0 sc1
s_waitcnt lgkmcnt(6)
v_mfma_f32_16x16x32_bf16 v[72:75], v[148:151], a[72:75], v[72:75]
ds_read_b64_tr_b16 v[144:145], v50 offset:0
v_mfma_f32_16x16x32_bf16 v[88:91], v[148:151], a[76:79], v[88:91]
ds_read_b64_tr_b16 v[146:147], v50 offset:2048
v_mfma_f32_16x16x32_bf16 v[104:107], v[148:151], a[80:83], v[104:107]
buffer_load_dwordx4 a[152:155], v7, s[32:35], s62 offen offset:0 sc1
s_waitcnt lgkmcnt(6)
v_mfma_f32_16x16x32_bf16 v[76:79], v[152:155], a[72:75], v[76:79]
ds_read_b64_tr_b16 v[148:149], v51 offset:0
v_mfma_f32_16x16x32_bf16 v[92:95], v[152:155], a[76:79], v[92:95]
ds_read_b64_tr_b16 v[150:151], v51 offset:2048
v_mfma_f32_16x16x32_bf16 v[108:111], v[152:155], a[80:83], v[108:111]
buffer_load_dwordx4 a[156:159], v5, s[32:35], s62 offen offset:2048 sc1
s_waitcnt vmcnt(16)
s_waitcnt lgkmcnt(6)
v_mfma_f32_16x16x32_bf16 v[64:67], v[156:159], a[84:87], v[64:67]
ds_read_b64_tr_b16 v[152:153], v48 offset:8192
v_mfma_f32_16x16x32_bf16 v[80:83], v[156:159], a[88:91], v[80:83]
ds_read_b64_tr_b16 v[154:155], v48 offset:10240
v_mfma_f32_16x16x32_bf16 v[96:99], v[156:159], a[92:95], v[96:99]
buffer_load_dwordx4 a[160:163], v6, s[32:35], s62 offen offset:2048 sc1
s_barrier
s_waitcnt lgkmcnt(6)
v_mfma_f32_16x16x32_bf16 v[68:71], v[160:163], a[84:87], v[68:71]
ds_read_b64_tr_b16 v[156:157], v49 offset:8192
v_mfma_f32_16x16x32_bf16 v[84:87], v[160:163], a[88:91], v[84:87]
ds_read_b64_tr_b16 v[158:159], v49 offset:10240
v_mfma_f32_16x16x32_bf16 v[100:103], v[160:163], a[92:95], v[100:103]
buffer_load_dwordx4 a[164:167], v7, s[32:35], s62 offen offset:2048 sc1
s_waitcnt lgkmcnt(6)
v_mfma_f32_16x16x32_bf16 v[72:75], v[144:147], a[84:87], v[72:75]
ds_read_b64_tr_b16 v[160:161], v50 offset:8192
s_add_u32 m0, s61, 106496
v_mfma_f32_16x16x32_bf16 v[88:91], v[144:147], a[88:91], v[88:91]
ds_read_b64_tr_b16 v[162:163], v50 offset:10240
s_mov_b32 s50, 1638400
v_mfma_f32_16x16x32_bf16 v[104:107], v[144:147], a[92:95], v[104:107]
buffer_load_dwordx4 v21, s[24:27], s50 offen lds
s_waitcnt lgkmcnt(6)
v_mfma_f32_16x16x32_bf16 v[76:79], v[148:151], a[84:87], v[76:79]
ds_read_b64_tr_b16 v[144:145], v51 offset:8192
s_add_u32 m0, s61, 110592
v_mfma_f32_16x16x32_bf16 v[92:95], v[148:151], a[88:91], v[92:95]
ds_read_b64_tr_b16 v[146:147], v51 offset:10240
s_mov_b32 s50, 1679360
v_mfma_f32_16x16x32_bf16 v[108:111], v[148:151], a[92:95], v[108:111]
buffer_load_dwordx4 v21, s[24:27], s50 offen lds
s_waitcnt vmcnt(17)
s_waitcnt lgkmcnt(6)
v_mfma_f32_16x16x32_bf16 v[64:67], v[152:155], a[96:99], v[64:67]
ds_read_b64_tr_b16 v[148:149], v48 offset:16384
s_add_u32 m0, s61, 114688
v_mfma_f32_16x16x32_bf16 v[80:83], v[152:155], a[100:103], v[80:83]
ds_read_b64_tr_b16 v[150:151], v48 offset:18432
s_mov_b32 s50, 1720320
v_mfma_f32_16x16x32_bf16 v[96:99], v[152:155], a[104:107], v[96:99]
buffer_load_dwordx4 v21, s[24:27], s50 offen lds
s_waitcnt lgkmcnt(6)
v_mfma_f32_16x16x32_bf16 v[68:71], v[156:159], a[96:99], v[68:71]
ds_read_b64_tr_b16 v[152:153], v49 offset:16384
s_add_u32 m0, s61, 118784
v_mfma_f32_16x16x32_bf16 v[84:87], v[156:159], a[100:103], v[84:87]
ds_read_b64_tr_b16 v[154:155], v49 offset:18432
s_mov_b32 s50, 1761280
v_mfma_f32_16x16x32_bf16 v[100:103], v[156:159], a[104:107], v[100:103]
buffer_load_dwordx4 v21, s[24:27], s50 offen lds
s_waitcnt lgkmcnt(6)
v_mfma_f32_16x16x32_bf16 v[72:75], v[160:163], a[96:99], v[72:75]
ds_read_b64_tr_b16 v[156:157], v50 offset:16384
s_add_u32 m0, s61, 122880
v_mfma_f32_16x16x32_bf16 v[88:91], v[160:163], a[100:103], v[88:91]
ds_read_b64_tr_b16 v[158:159], v50 offset:18432
s_mov_b32 s50, 1802240
v_mfma_f32_16x16x32_bf16 v[104:107], v[160:163], a[104:107], v[104:107]
buffer_load_dwordx4 v21, s[24:27], s50 offen lds
s_waitcnt lgkmcnt(6)
v_mfma_f32_16x16x32_bf16 v[76:79], v[144:147], a[96:99], v[76:79]
ds_read_b64_tr_b16 v[160:161], v51 offset:16384
s_add_u32 m0, s61, 126976
v_mfma_f32_16x16x32_bf16 v[92:95], v[144:147], a[100:103], v[92:95]
ds_read_b64_tr_b16 v[162:163], v51 offset:18432
s_mov_b32 s50, 1843200
v_mfma_f32_16x16x32_bf16 v[108:111], v[144:147], a[104:107], v[108:111]
buffer_load_dwordx4 v21, s[24:27], s50 offen lds
s_waitcnt vmcnt(18)
s_waitcnt lgkmcnt(6)
v_mfma_f32_16x16x32_bf16 v[64:67], v[148:151], a[108:111], v[64:67]
ds_read_b64_tr_b16 v[144:145], v48 offset:24576
s_add_u32 m0, s61, 131072
v_mfma_f32_16x16x32_bf16 v[80:83], v[148:151], a[112:115], v[80:83]
ds_read_b64_tr_b16 v[146:147], v48 offset:26624
s_mov_b32 s50, 1884160
v_mfma_f32_16x16x32_bf16 v[96:99], v[148:151], a[116:119], v[96:99]
buffer_load_dwordx4 v21, s[24:27], s50 offen lds
s_waitcnt lgkmcnt(6)
v_mfma_f32_16x16x32_bf16 v[68:71], v[152:155], a[108:111], v[68:71]
ds_read_b64_tr_b16 v[148:149], v49 offset:24576
s_add_u32 m0, s61, 135168
v_mfma_f32_16x16x32_bf16 v[84:87], v[152:155], a[112:115], v[84:87]
ds_read_b64_tr_b16 v[150:151], v49 offset:26624
s_mov_b32 s50, 1925120
v_mfma_f32_16x16x32_bf16 v[100:103], v[152:155], a[116:119], v[100:103]
buffer_load_dwordx4 v21, s[24:27], s50 offen lds
s_waitcnt lgkmcnt(6)
v_mfma_f32_16x16x32_bf16 v[72:75], v[156:159], a[108:111], v[72:75]
ds_read_b64_tr_b16 v[152:153], v50 offset:24576
s_add_u32 m0, s61, 139264
v_mfma_f32_16x16x32_bf16 v[88:91], v[156:159], a[112:115], v[88:91]
ds_read_b64_tr_b16 v[154:155], v50 offset:26624
s_mov_b32 s50, 1966080
v_mfma_f32_16x16x32_bf16 v[104:107], v[156:159], a[116:119], v[104:107]
buffer_load_dwordx4 v21, s[24:27], s50 offen lds
s_waitcnt lgkmcnt(6)
v_mfma_f32_16x16x32_bf16 v[76:79], v[160:163], a[108:111], v[76:79]
ds_read_b64_tr_b16 v[156:157], v51 offset:24576
s_add_u32 m0, s61, 143360
v_mfma_f32_16x16x32_bf16 v[92:95], v[160:163], a[112:115], v[92:95]
ds_read_b64_tr_b16 v[158:159], v51 offset:26624
s_mov_b32 s50, 2007040
v_mfma_f32_16x16x32_bf16 v[108:111], v[160:163], a[116:119], v[108:111]
buffer_load_dwordx4 v21, s[24:27], s50 offen lds
s_waitcnt vmcnt(19)
s_waitcnt lgkmcnt(6)
v_mfma_f32_16x16x32_bf16 v[64:67], v[144:147], a[120:123], v[64:67]
ds_read_b64_tr_b16 v[160:161], v48 offset:32768
s_add_u32 m0, s61, 147456
v_mfma_f32_16x16x32_bf16 v[80:83], v[144:147], a[124:127], v[80:83]
ds_read_b64_tr_b16 v[162:163], v48 offset:34816
s_mov_b32 s50, 2048000
v_mfma_f32_16x16x32_bf16 v[96:99], v[144:147], a[128:131], v[96:99]
buffer_load_dwordx4 v21, s[24:27], s50 offen lds
s_waitcnt lgkmcnt(6)
v_mfma_f32_16x16x32_bf16 v[68:71], v[148:151], a[120:123], v[68:71]
ds_read_b64_tr_b16 v[144:145], v49 offset:32768
s_add_u32 m0, s61, 151552
v_mfma_f32_16x16x32_bf16 v[84:87], v[148:151], a[124:127], v[84:87]
ds_read_b64_tr_b16 v[146:147], v49 offset:34816
s_mov_b32 s50, 2088960
v_mfma_f32_16x16x32_bf16 v[100:103], v[148:151], a[128:131], v[100:103]
buffer_load_dwordx4 v21, s[24:27], s50 offen lds
s_waitcnt lgkmcnt(6)
v_mfma_f32_16x16x32_bf16 v[72:75], v[152:155], a[120:123], v[72:75]
ds_read_b64_tr_b16 v[148:149], v50 offset:32768
s_add_u32 m0, s61, 155648
v_mfma_f32_16x16x32_bf16 v[88:91], v[152:155], a[124:127], v[88:91]
ds_read_b64_tr_b16 v[150:151], v50 offset:34816
s_mov_b32 s50, 2129920
v_mfma_f32_16x16x32_bf16 v[104:107], v[152:155], a[128:131], v[104:107]
buffer_load_dwordx4 v21, s[24:27], s50 offen lds
s_waitcnt lgkmcnt(6)
v_mfma_f32_16x16x32_bf16 v[76:79], v[156:159], a[120:123], v[76:79]
ds_read_b64_tr_b16 v[152:153], v51 offset:32768
s_add_u32 m0, s61, 159744
v_mfma_f32_16x16x32_bf16 v[92:95], v[156:159], a[124:127], v[92:95]
ds_read_b64_tr_b16 v[154:155], v51 offset:34816
s_mov_b32 s50, 2170880
v_mfma_f32_16x16x32_bf16 v[108:111], v[156:159], a[128:131], v[108:111]
buffer_load_dwordx4 v21, s[24:27], s50 offen lds
s_waitcnt vmcnt(20)
s_waitcnt lgkmcnt(6)
v_mfma_f32_16x16x32_bf16 v[64:67], v[160:163], a[132:135], v[64:67]
ds_read_b64_tr_b16 v[156:157], v48 offset:40960
s_mov_b32 s62, 28672
v_mfma_f32_16x16x32_bf16 v[80:83], v[160:163], a[136:139], v[80:83]
ds_read_b64_tr_b16 v[158:159], v48 offset:43008
v_mfma_f32_16x16x32_bf16 v[96:99], v[160:163], a[140:143], v[96:99]
buffer_load_dwordx4 a[168:171], v5, s[32:35], s62 offen offset:0 sc1
s_waitcnt lgkmcnt(6)
v_mfma_f32_16x16x32_bf16 v[68:71], v[144:147], a[132:135], v[68:71]
ds_read_b64_tr_b16 v[160:161], v49 offset:40960
v_mfma_f32_16x16x32_bf16 v[84:87], v[144:147], a[136:139], v[84:87]
ds_read_b64_tr_b16 v[162:163], v49 offset:43008
v_mfma_f32_16x16x32_bf16 v[100:103], v[144:147], a[140:143], v[100:103]
buffer_load_dwordx4 a[172:175], v6, s[32:35], s62 offen offset:0 sc1
s_waitcnt lgkmcnt(6)
v_mfma_f32_16x16x32_bf16 v[72:75], v[148:151], a[132:135], v[72:75]
ds_read_b64_tr_b16 v[144:145], v50 offset:40960
v_mfma_f32_16x16x32_bf16 v[88:91], v[148:151], a[136:139], v[88:91]
ds_read_b64_tr_b16 v[146:147], v50 offset:43008
v_mfma_f32_16x16x32_bf16 v[104:107], v[148:151], a[140:143], v[104:107]
buffer_load_dwordx4 a[176:179], v7, s[32:35], s62 offen offset:0 sc1
s_waitcnt lgkmcnt(6)
v_mfma_f32_16x16x32_bf16 v[76:79], v[152:155], a[132:135], v[76:79]
ds_read_b64_tr_b16 v[148:149], v51 offset:40960
v_mfma_f32_16x16x32_bf16 v[92:95], v[152:155], a[136:139], v[92:95]
ds_read_b64_tr_b16 v[150:151], v51 offset:43008
v_mfma_f32_16x16x32_bf16 v[108:111], v[152:155], a[140:143], v[108:111]
buffer_load_dwordx4 a[180:183], v5, s[32:35], s62 offen offset:2048 sc1
s_waitcnt vmcnt(21)
s_waitcnt lgkmcnt(6)
v_mfma_f32_16x16x32_bf16 v[64:67], v[156:159], a[144:147], v[64:67]
ds_read_b64_tr_b16 v[152:153], v48 offset:49152
v_mfma_f32_16x16x32_bf16 v[80:83], v[156:159], a[148:151], v[80:83]
ds_read_b64_tr_b16 v[154:155], v48 offset:51200
v_mfma_f32_16x16x32_bf16 v[96:99], v[156:159], a[152:155], v[96:99]
buffer_load_dwordx4 a[184:187], v6, s[32:35], s62 offen offset:2048 sc1
s_waitcnt lgkmcnt(6)
v_mfma_f32_16x16x32_bf16 v[68:71], v[160:163], a[144:147], v[68:71]
ds_read_b64_tr_b16 v[156:157], v49 offset:49152
v_mfma_f32_16x16x32_bf16 v[84:87], v[160:163], a[148:151], v[84:87]
ds_read_b64_tr_b16 v[158:159], v49 offset:51200
v_mfma_f32_16x16x32_bf16 v[100:103], v[160:163], a[152:155], v[100:103]
buffer_load_dwordx4 a[188:191], v7, s[32:35], s62 offen offset:2048 sc1
s_waitcnt lgkmcnt(6)
v_mfma_f32_16x16x32_bf16 v[72:75], v[144:147], a[144:147], v[72:75]
ds_read_b64_tr_b16 v[160:161], v50 offset:49152
s_mov_b32 s62, 32768
v_mfma_f32_16x16x32_bf16 v[88:91], v[144:147], a[148:151], v[88:91]
ds_read_b64_tr_b16 v[162:163], v50 offset:51200
v_mfma_f32_16x16x32_bf16 v[104:107], v[144:147], a[152:155], v[104:107]
buffer_load_dwordx4 a[192:195], v5, s[32:35], s62 offen offset:0 sc1
s_waitcnt lgkmcnt(6)
v_mfma_f32_16x16x32_bf16 v[76:79], v[148:151], a[144:147], v[76:79]
ds_read_b64_tr_b16 v[144:145], v51 offset:49152
v_mfma_f32_16x16x32_bf16 v[92:95], v[148:151], a[148:151], v[92:95]
ds_read_b64_tr_b16 v[146:147], v51 offset:51200
v_mfma_f32_16x16x32_bf16 v[108:111], v[148:151], a[152:155], v[108:111]
buffer_load_dwordx4 a[196:199], v6, s[32:35], s62 offen offset:0 sc1
s_waitcnt vmcnt(22)
s_waitcnt lgkmcnt(6)
v_mfma_f32_16x16x32_bf16 v[64:67], v[152:155], a[156:159], v[64:67]
ds_read_b64_tr_b16 v[148:149], v48 offset:57344
v_mfma_f32_16x16x32_bf16 v[80:83], v[152:155], a[160:163], v[80:83]
ds_read_b64_tr_b16 v[150:151], v48 offset:59392
v_mfma_f32_16x16x32_bf16 v[96:99], v[152:155], a[164:167], v[96:99]
buffer_load_dwordx4 a[200:203], v7, s[32:35], s62 offen offset:0 sc1
s_waitcnt lgkmcnt(6)
v_mfma_f32_16x16x32_bf16 v[68:71], v[156:159], a[156:159], v[68:71]
ds_read_b64_tr_b16 v[152:153], v49 offset:57344
v_mfma_f32_16x16x32_bf16 v[84:87], v[156:159], a[160:163], v[84:87]
ds_read_b64_tr_b16 v[154:155], v49 offset:59392
v_mfma_f32_16x16x32_bf16 v[100:103], v[156:159], a[164:167], v[100:103]
buffer_load_dwordx4 a[204:207], v5, s[32:35], s62 offen offset:2048 sc1
s_waitcnt lgkmcnt(6)
v_mfma_f32_16x16x32_bf16 v[72:75], v[160:163], a[156:159], v[72:75]
ds_read_b64_tr_b16 v[156:157], v50 offset:57344
v_mfma_f32_16x16x32_bf16 v[88:91], v[160:163], a[160:163], v[88:91]
ds_read_b64_tr_b16 v[158:159], v50 offset:59392
v_mfma_f32_16x16x32_bf16 v[104:107], v[160:163], a[164:167], v[104:107]
buffer_load_dwordx4 a[208:211], v6, s[32:35], s62 offen offset:2048 sc1
s_waitcnt lgkmcnt(6)
v_mfma_f32_16x16x32_bf16 v[76:79], v[144:147], a[156:159], v[76:79]
ds_read_b64_tr_b16 v[160:161], v51 offset:57344
v_mfma_f32_16x16x32_bf16 v[92:95], v[144:147], a[160:163], v[92:95]
ds_read_b64_tr_b16 v[162:163], v51 offset:59392
v_mfma_f32_16x16x32_bf16 v[108:111], v[144:147], a[164:167], v[108:111]
buffer_load_dwordx4 a[212:215], v7, s[32:35], s62 offen offset:2048 sc1
s_waitcnt vmcnt(9)
s_waitcnt lgkmcnt(6)
v_mfma_f32_16x16x32_bf16 v[64:67], v[148:151], a[168:171], v[64:67]
v_add_u32 v48, 0x10000, v48
v_add_u32 v49, 0x10000, v49
v_add_u32 v50, 0x10000, v50
v_add_u32 v51, 0x10000, v51
ds_read_b64_tr_b16 v[144:145], v48 offset:0
s_mov_b32 s62, 36864
v_mfma_f32_16x16x32_bf16 v[80:83], v[148:151], a[172:175], v[80:83]
ds_read_b64_tr_b16 v[146:147], v48 offset:2048
v_mfma_f32_16x16x32_bf16 v[96:99], v[148:151], a[176:179], v[96:99]
buffer_load_dwordx4 a[216:219], v5, s[32:35], s62 offen offset:0 sc1
s_waitcnt lgkmcnt(6)
v_mfma_f32_16x16x32_bf16 v[68:71], v[152:155], a[168:171], v[68:71]
ds_read_b64_tr_b16 v[148:149], v49 offset:0
v_mfma_f32_16x16x32_bf16 v[84:87], v[152:155], a[172:175], v[84:87]
ds_read_b64_tr_b16 v[150:151], v49 offset:2048
v_mfma_f32_16x16x32_bf16 v[100:103], v[152:155], a[176:179], v[100:103]
buffer_load_dwordx4 a[220:223], v6, s[32:35], s62 offen offset:0 sc1
s_waitcnt lgkmcnt(6)
v_mfma_f32_16x16x32_bf16 v[72:75], v[156:159], a[168:171], v[72:75]
ds_read_b64_tr_b16 v[152:153], v50 offset:0
v_mfma_f32_16x16x32_bf16 v[88:91], v[156:159], a[172:175], v[88:91]
ds_read_b64_tr_b16 v[154:155], v50 offset:2048
v_mfma_f32_16x16x32_bf16 v[104:107], v[156:159], a[176:179], v[104:107]
buffer_load_dwordx4 a[224:227], v7, s[32:35], s62 offen offset:0 sc1
s_waitcnt lgkmcnt(6)
v_mfma_f32_16x16x32_bf16 v[76:79], v[160:163], a[168:171], v[76:79]
ds_read_b64_tr_b16 v[156:157], v51 offset:0
v_mfma_f32_16x16x32_bf16 v[92:95], v[160:163], a[172:175], v[92:95]
ds_read_b64_tr_b16 v[158:159], v51 offset:2048
v_mfma_f32_16x16x32_bf16 v[108:111], v[160:163], a[176:179], v[108:111]
buffer_load_dwordx4 a[228:231], v5, s[32:35], s62 offen offset:2048 sc1
s_waitcnt vmcnt(10)
s_waitcnt lgkmcnt(6)
v_mfma_f32_16x16x32_bf16 v[64:67], v[144:147], a[180:183], v[64:67]
ds_read_b64_tr_b16 v[160:161], v48 offset:8192
v_mfma_f32_16x16x32_bf16 v[80:83], v[144:147], a[184:187], v[80:83]
ds_read_b64_tr_b16 v[162:163], v48 offset:10240
v_mfma_f32_16x16x32_bf16 v[96:99], v[144:147], a[188:191], v[96:99]
buffer_load_dwordx4 a[232:235], v6, s[32:35], s62 offen offset:2048 sc1
s_waitcnt lgkmcnt(6)
v_mfma_f32_16x16x32_bf16 v[68:71], v[148:151], a[180:183], v[68:71]
ds_read_b64_tr_b16 v[144:145], v49 offset:8192
v_mfma_f32_16x16x32_bf16 v[84:87], v[148:151], a[184:187], v[84:87]
ds_read_b64_tr_b16 v[146:147], v49 offset:10240
v_mfma_f32_16x16x32_bf16 v[100:103], v[148:151], a[188:191], v[100:103]
buffer_load_dwordx4 a[236:239], v7, s[32:35], s62 offen offset:2048 sc1
s_waitcnt lgkmcnt(6)
v_mfma_f32_16x16x32_bf16 v[72:75], v[152:155], a[180:183], v[72:75]
ds_read_b64_tr_b16 v[148:149], v50 offset:8192
s_mov_b32 s62, 40960
v_mfma_f32_16x16x32_bf16 v[88:91], v[152:155], a[184:187], v[88:91]
ds_read_b64_tr_b16 v[150:151], v50 offset:10240
v_mfma_f32_16x16x32_bf16 v[104:107], v[152:155], a[188:191], v[104:107]
buffer_load_dwordx4 a[240:243], v5, s[32:35], s62 offen offset:0 sc1
s_waitcnt lgkmcnt(6)
v_mfma_f32_16x16x32_bf16 v[76:79], v[156:159], a[180:183], v[76:79]
ds_read_b64_tr_b16 v[152:153], v51 offset:8192
v_mfma_f32_16x16x32_bf16 v[92:95], v[156:159], a[184:187], v[92:95]
ds_read_b64_tr_b16 v[154:155], v51 offset:10240
v_mfma_f32_16x16x32_bf16 v[108:111], v[156:159], a[188:191], v[108:111]
buffer_load_dwordx4 a[244:247], v6, s[32:35], s62 offen offset:0 sc1
s_waitcnt vmcnt(11)
s_waitcnt lgkmcnt(6)
v_mfma_f32_16x16x32_bf16 v[64:67], v[160:163], a[192:195], v[64:67]
ds_read_b64_tr_b16 v[156:157], v48 offset:16384
v_mfma_f32_16x16x32_bf16 v[80:83], v[160:163], a[196:199], v[80:83]
ds_read_b64_tr_b16 v[158:159], v48 offset:18432
v_mfma_f32_16x16x32_bf16 v[96:99], v[160:163], a[200:203], v[96:99]
buffer_load_dwordx4 a[248:251], v7, s[32:35], s62 offen offset:0 sc1
s_waitcnt lgkmcnt(6)
v_mfma_f32_16x16x32_bf16 v[68:71], v[144:147], a[192:195], v[68:71]
ds_read_b64_tr_b16 v[160:161], v49 offset:16384
v_mfma_f32_16x16x32_bf16 v[84:87], v[144:147], a[196:199], v[84:87]
ds_read_b64_tr_b16 v[162:163], v49 offset:18432
v_mfma_f32_16x16x32_bf16 v[100:103], v[144:147], a[200:203], v[100:103]
buffer_load_dwordx4 v[168:171], v5, s[32:35], s62 offen offset:2048 sc1
s_waitcnt lgkmcnt(6)
v_mfma_f32_16x16x32_bf16 v[72:75], v[148:151], a[192:195], v[72:75]
ds_read_b64_tr_b16 v[144:145], v50 offset:16384
v_mfma_f32_16x16x32_bf16 v[88:91], v[148:151], a[196:199], v[88:91]
ds_read_b64_tr_b16 v[146:147], v50 offset:18432
v_mfma_f32_16x16x32_bf16 v[104:107], v[148:151], a[200:203], v[104:107]
buffer_load_dwordx4 v[172:175], v6, s[32:35], s62 offen offset:2048 sc1
s_waitcnt lgkmcnt(6)
v_mfma_f32_16x16x32_bf16 v[76:79], v[152:155], a[192:195], v[76:79]
ds_read_b64_tr_b16 v[148:149], v51 offset:16384
v_mfma_f32_16x16x32_bf16 v[92:95], v[152:155], a[196:199], v[92:95]
ds_read_b64_tr_b16 v[150:151], v51 offset:18432
v_mfma_f32_16x16x32_bf16 v[108:111], v[152:155], a[200:203], v[108:111]
buffer_load_dwordx4 v[176:179], v7, s[32:35], s62 offen offset:2048 sc1
s_waitcnt vmcnt(12)
s_waitcnt lgkmcnt(6)
v_mfma_f32_16x16x32_bf16 v[64:67], v[156:159], a[204:207], v[64:67]
ds_read_b64_tr_b16 v[152:153], v48 offset:24576
s_mov_b32 s62, 45056
v_mfma_f32_16x16x32_bf16 v[80:83], v[156:159], a[208:211], v[80:83]
ds_read_b64_tr_b16 v[154:155], v48 offset:26624
v_mfma_f32_16x16x32_bf16 v[96:99], v[156:159], a[212:215], v[96:99]
buffer_load_dwordx4 v[180:183], v5, s[32:35], s62 offen offset:0 sc1
s_waitcnt lgkmcnt(6)
v_mfma_f32_16x16x32_bf16 v[68:71], v[160:163], a[204:207], v[68:71]
ds_read_b64_tr_b16 v[156:157], v49 offset:24576
v_mfma_f32_16x16x32_bf16 v[84:87], v[160:163], a[208:211], v[84:87]
ds_read_b64_tr_b16 v[158:159], v49 offset:26624
v_mfma_f32_16x16x32_bf16 v[100:103], v[160:163], a[212:215], v[100:103]
buffer_load_dwordx4 v[184:187], v6, s[32:35], s62 offen offset:0 sc1
s_waitcnt lgkmcnt(6)
v_mfma_f32_16x16x32_bf16 v[72:75], v[144:147], a[204:207], v[72:75]
ds_read_b64_tr_b16 v[160:161], v50 offset:24576
v_mfma_f32_16x16x32_bf16 v[88:91], v[144:147], a[208:211], v[88:91]
ds_read_b64_tr_b16 v[162:163], v50 offset:26624
v_mfma_f32_16x16x32_bf16 v[104:107], v[144:147], a[212:215], v[104:107]
buffer_load_dwordx4 v[188:191], v7, s[32:35], s62 offen offset:0 sc1
s_waitcnt lgkmcnt(6)
v_mfma_f32_16x16x32_bf16 v[76:79], v[148:151], a[204:207], v[76:79]
ds_read_b64_tr_b16 v[144:145], v51 offset:24576
v_mfma_f32_16x16x32_bf16 v[92:95], v[148:151], a[208:211], v[92:95]
ds_read_b64_tr_b16 v[146:147], v51 offset:26624
v_mfma_f32_16x16x32_bf16 v[108:111], v[148:151], a[212:215], v[108:111]
buffer_load_dwordx4 v[192:195], v5, s[32:35], s62 offen offset:2048 sc1
s_waitcnt vmcnt(13)
s_waitcnt lgkmcnt(6)
v_mfma_f32_16x16x32_bf16 v[64:67], v[152:155], a[216:219], v[64:67]
ds_read_b64_tr_b16 v[148:149], v48 offset:32768
v_mfma_f32_16x16x32_bf16 v[80:83], v[152:155], a[220:223], v[80:83]
ds_read_b64_tr_b16 v[150:151], v48 offset:34816
v_mfma_f32_16x16x32_bf16 v[96:99], v[152:155], a[224:227], v[96:99]
buffer_load_dwordx4 v[196:199], v6, s[32:35], s62 offen offset:2048 sc1
s_waitcnt lgkmcnt(6)
v_mfma_f32_16x16x32_bf16 v[68:71], v[156:159], a[216:219], v[68:71]
ds_read_b64_tr_b16 v[152:153], v49 offset:32768
v_mfma_f32_16x16x32_bf16 v[84:87], v[156:159], a[220:223], v[84:87]
ds_read_b64_tr_b16 v[154:155], v49 offset:34816
v_mfma_f32_16x16x32_bf16 v[100:103], v[156:159], a[224:227], v[100:103]
buffer_load_dwordx4 v[200:203], v7, s[32:35], s62 offen offset:2048 sc1
s_waitcnt lgkmcnt(6)
v_mfma_f32_16x16x32_bf16 v[72:75], v[160:163], a[216:219], v[72:75]
ds_read_b64_tr_b16 v[156:157], v50 offset:32768
s_mov_b32 s62, 49152
v_mfma_f32_16x16x32_bf16 v[88:91], v[160:163], a[220:223], v[88:91]
ds_read_b64_tr_b16 v[158:159], v50 offset:34816
v_mfma_f32_16x16x32_bf16 v[104:107], v[160:163], a[224:227], v[104:107]
buffer_load_dwordx4 v[204:207], v5, s[32:35], s62 offen offset:0 sc1
s_waitcnt lgkmcnt(6)
v_mfma_f32_16x16x32_bf16 v[76:79], v[144:147], a[216:219], v[76:79]
ds_read_b64_tr_b16 v[160:161], v51 offset:32768
v_mfma_f32_16x16x32_bf16 v[92:95], v[144:147], a[220:223], v[92:95]
ds_read_b64_tr_b16 v[162:163], v51 offset:34816
v_mfma_f32_16x16x32_bf16 v[108:111], v[144:147], a[224:227], v[108:111]
buffer_load_dwordx4 v[208:211], v6, s[32:35], s62 offen offset:0 sc1
s_waitcnt vmcnt(14)
s_waitcnt lgkmcnt(6)
v_mfma_f32_16x16x32_bf16 v[64:67], v[148:151], a[228:231], v[64:67]
buffer_load_dwordx4 v[212:215], v7, s[32:35], s62 offen offset:0 sc1
s_barrier
ds_read_b64_tr_b16 v[144:145], v48 offset:40960
v_mfma_f32_16x16x32_bf16 v[80:83], v[148:151], a[232:235], v[80:83]
ds_read_b64_tr_b16 v[146:147], v48 offset:43008
v_mfma_f32_16x16x32_bf16 v[96:99], v[148:151], a[236:239], v[96:99]
s_waitcnt lgkmcnt(6)
v_mfma_f32_16x16x32_bf16 v[68:71], v[152:155], a[228:231], v[68:71]
ds_read_b64_tr_b16 v[148:149], v49 offset:40960
v_mfma_f32_16x16x32_bf16 v[84:87], v[152:155], a[232:235], v[84:87]
ds_read_b64_tr_b16 v[150:151], v49 offset:43008
v_mfma_f32_16x16x32_bf16 v[100:103], v[152:155], a[236:239], v[100:103]
buffer_load_dwordx4 v[216:219], v5, s[32:35], s62 offen offset:2048 sc1
s_waitcnt lgkmcnt(6)
v_mfma_f32_16x16x32_bf16 v[72:75], v[156:159], a[228:231], v[72:75]
ds_read_b64_tr_b16 v[152:153], v50 offset:40960
v_mfma_f32_16x16x32_bf16 v[88:91], v[156:159], a[232:235], v[88:91]
ds_read_b64_tr_b16 v[154:155], v50 offset:43008
v_mfma_f32_16x16x32_bf16 v[104:107], v[156:159], a[236:239], v[104:107]
buffer_load_dwordx4 v[220:223], v6, s[32:35], s62 offen offset:2048 sc1
s_waitcnt lgkmcnt(6)
v_mfma_f32_16x16x32_bf16 v[76:79], v[160:163], a[228:231], v[76:79]
ds_read_b64_tr_b16 v[156:157], v51 offset:40960
v_mfma_f32_16x16x32_bf16 v[92:95], v[160:163], a[232:235], v[92:95]
ds_read_b64_tr_b16 v[158:159], v51 offset:43008
v_mfma_f32_16x16x32_bf16 v[108:111], v[160:163], a[236:239], v[108:111]
buffer_load_dwordx4 v[224:227], v7, s[32:35], s62 offen offset:2048 sc1
s_waitcnt vmcnt(15)
s_waitcnt lgkmcnt(6)
v_mfma_f32_16x16x32_bf16 v[64:67], v[144:147], a[240:243], v[64:67]
ds_read_b64_tr_b16 v[160:161], v48 offset:49152
s_mov_b32 s62, 53248
v_mfma_f32_16x16x32_bf16 v[80:83], v[144:147], a[244:247], v[80:83]
ds_read_b64_tr_b16 v[162:163], v48 offset:51200
v_mfma_f32_16x16x32_bf16 v[96:99], v[144:147], a[248:251], v[96:99]
buffer_load_dwordx4 v[228:231], v5, s[32:35], s62 offen offset:0 sc1
s_waitcnt lgkmcnt(6)
v_mfma_f32_16x16x32_bf16 v[68:71], v[148:151], a[240:243], v[68:71]
ds_read_b64_tr_b16 v[144:145], v49 offset:49152
v_mfma_f32_16x16x32_bf16 v[84:87], v[148:151], a[244:247], v[84:87]
ds_read_b64_tr_b16 v[146:147], v49 offset:51200
v_mfma_f32_16x16x32_bf16 v[100:103], v[148:151], a[248:251], v[100:103]
buffer_load_dwordx4 v[232:235], v6, s[32:35], s62 offen offset:0 sc1
s_waitcnt lgkmcnt(6)
v_mfma_f32_16x16x32_bf16 v[72:75], v[152:155], a[240:243], v[72:75]
ds_read_b64_tr_b16 v[148:149], v50 offset:49152
v_mfma_f32_16x16x32_bf16 v[88:91], v[152:155], a[244:247], v[88:91]
ds_read_b64_tr_b16 v[150:151], v50 offset:51200
v_mfma_f32_16x16x32_bf16 v[104:107], v[152:155], a[248:251], v[104:107]
buffer_load_dwordx4 v[236:239], v7, s[32:35], s62 offen offset:0 sc1
s_waitcnt lgkmcnt(6)
v_mfma_f32_16x16x32_bf16 v[76:79], v[156:159], a[240:243], v[76:79]
ds_read_b64_tr_b16 v[152:153], v51 offset:49152
v_mfma_f32_16x16x32_bf16 v[92:95], v[156:159], a[244:247], v[92:95]
ds_read_b64_tr_b16 v[154:155], v51 offset:51200
v_mfma_f32_16x16x32_bf16 v[108:111], v[156:159], a[248:251], v[108:111]
s_waitcnt vmcnt(15)
s_waitcnt lgkmcnt(6)
v_mfma_f32_16x16x32_bf16 v[64:67], v[160:163], v[168:171], v[64:67]
ds_read_b64_tr_b16 v[156:157], v48 offset:57344
v_mfma_f32_16x16x32_bf16 v[80:83], v[160:163], v[172:175], v[80:83]
ds_read_b64_tr_b16 v[158:159], v48 offset:59392
v_mfma_f32_16x16x32_bf16 v[96:99], v[160:163], v[176:179], v[96:99]
s_waitcnt lgkmcnt(6)
v_mfma_f32_16x16x32_bf16 v[68:71], v[144:147], v[168:171], v[68:71]
ds_read_b64_tr_b16 v[160:161], v49 offset:57344
v_mfma_f32_16x16x32_bf16 v[84:87], v[144:147], v[172:175], v[84:87]
ds_read_b64_tr_b16 v[162:163], v49 offset:59392
v_mfma_f32_16x16x32_bf16 v[100:103], v[144:147], v[176:179], v[100:103]
s_waitcnt lgkmcnt(6)
v_mfma_f32_16x16x32_bf16 v[72:75], v[148:151], v[168:171], v[72:75]
ds_read_b64_tr_b16 v[144:145], v50 offset:57344
v_mfma_f32_16x16x32_bf16 v[88:91], v[148:151], v[172:175], v[88:91]
ds_read_b64_tr_b16 v[146:147], v50 offset:59392
v_mfma_f32_16x16x32_bf16 v[104:107], v[148:151], v[176:179], v[104:107]
s_waitcnt lgkmcnt(6)
v_mfma_f32_16x16x32_bf16 v[76:79], v[152:155], v[168:171], v[76:79]
ds_read_b64_tr_b16 v[148:149], v51 offset:57344
v_mfma_f32_16x16x32_bf16 v[92:95], v[152:155], v[172:175], v[92:95]
ds_read_b64_tr_b16 v[150:151], v51 offset:59392
v_mfma_f32_16x16x32_bf16 v[108:111], v[152:155], v[176:179], v[108:111]
s_waitcnt vmcnt(12)
s_waitcnt lgkmcnt(6)
v_mfma_f32_16x16x32_bf16 v[64:67], v[156:159], v[180:183], v[64:67]
v_add_u32 v48, 0x10000, v48
v_add_u32 v49, 0x10000, v49
v_add_u32 v50, 0x10000, v50
v_add_u32 v51, 0x10000, v51
ds_read_b64_tr_b16 v[152:153], v48 offset:0
v_mfma_f32_16x16x32_bf16 v[80:83], v[156:159], v[184:187], v[80:83]
ds_read_b64_tr_b16 v[154:155], v48 offset:2048
v_mfma_f32_16x16x32_bf16 v[96:99], v[156:159], v[188:191], v[96:99]
s_waitcnt lgkmcnt(6)
v_mfma_f32_16x16x32_bf16 v[68:71], v[160:163], v[180:183], v[68:71]
ds_read_b64_tr_b16 v[156:157], v49 offset:0
v_mfma_f32_16x16x32_bf16 v[84:87], v[160:163], v[184:187], v[84:87]
ds_read_b64_tr_b16 v[158:159], v49 offset:2048
v_mfma_f32_16x16x32_bf16 v[100:103], v[160:163], v[188:191], v[100:103]
s_waitcnt lgkmcnt(6)
v_mfma_f32_16x16x32_bf16 v[72:75], v[144:147], v[180:183], v[72:75]
ds_read_b64_tr_b16 v[160:161], v50 offset:0
v_mfma_f32_16x16x32_bf16 v[88:91], v[144:147], v[184:187], v[88:91]
ds_read_b64_tr_b16 v[162:163], v50 offset:2048
v_mfma_f32_16x16x32_bf16 v[104:107], v[144:147], v[188:191], v[104:107]
s_waitcnt lgkmcnt(6)
v_mfma_f32_16x16x32_bf16 v[76:79], v[148:151], v[180:183], v[76:79]
ds_read_b64_tr_b16 v[144:145], v51 offset:0
v_mfma_f32_16x16x32_bf16 v[92:95], v[148:151], v[184:187], v[92:95]
ds_read_b64_tr_b16 v[146:147], v51 offset:2048
v_mfma_f32_16x16x32_bf16 v[108:111], v[148:151], v[188:191], v[108:111]
s_waitcnt vmcnt(9)
s_waitcnt lgkmcnt(6)
v_mfma_f32_16x16x32_bf16 v[64:67], v[152:155], v[192:195], v[64:67]
ds_read_b64_tr_b16 v[148:149], v48 offset:8192
v_mfma_f32_16x16x32_bf16 v[80:83], v[152:155], v[196:199], v[80:83]
ds_read_b64_tr_b16 v[150:151], v48 offset:10240
v_mfma_f32_16x16x32_bf16 v[96:99], v[152:155], v[200:203], v[96:99]
s_waitcnt lgkmcnt(6)
v_mfma_f32_16x16x32_bf16 v[68:71], v[156:159], v[192:195], v[68:71]
ds_read_b64_tr_b16 v[152:153], v49 offset:8192
v_mfma_f32_16x16x32_bf16 v[84:87], v[156:159], v[196:199], v[84:87]
ds_read_b64_tr_b16 v[154:155], v49 offset:10240
v_mfma_f32_16x16x32_bf16 v[100:103], v[156:159], v[200:203], v[100:103]
s_waitcnt lgkmcnt(6)
v_mfma_f32_16x16x32_bf16 v[72:75], v[160:163], v[192:195], v[72:75]
ds_read_b64_tr_b16 v[156:157], v50 offset:8192
v_mfma_f32_16x16x32_bf16 v[88:91], v[160:163], v[196:199], v[88:91]
ds_read_b64_tr_b16 v[158:159], v50 offset:10240
v_mfma_f32_16x16x32_bf16 v[104:107], v[160:163], v[200:203], v[104:107]
s_waitcnt lgkmcnt(6)
v_mfma_f32_16x16x32_bf16 v[76:79], v[144:147], v[192:195], v[76:79]
ds_read_b64_tr_b16 v[160:161], v51 offset:8192
v_mfma_f32_16x16x32_bf16 v[92:95], v[144:147], v[196:199], v[92:95]
ds_read_b64_tr_b16 v[162:163], v51 offset:10240
v_mfma_f32_16x16x32_bf16 v[108:111], v[144:147], v[200:203], v[108:111]
s_waitcnt vmcnt(6)
s_waitcnt lgkmcnt(6)
v_mfma_f32_16x16x32_bf16 v[64:67], v[148:151], v[204:207], v[64:67]
ds_read_b64_tr_b16 v[144:145], v48 offset:16384
v_mfma_f32_16x16x32_bf16 v[80:83], v[148:151], v[208:211], v[80:83]
ds_read_b64_tr_b16 v[146:147], v48 offset:18432
v_mfma_f32_16x16x32_bf16 v[96:99], v[148:151], v[212:215], v[96:99]
s_waitcnt lgkmcnt(6)
v_mfma_f32_16x16x32_bf16 v[68:71], v[152:155], v[204:207], v[68:71]
ds_read_b64_tr_b16 v[148:149], v49 offset:16384
v_mfma_f32_16x16x32_bf16 v[84:87], v[152:155], v[208:211], v[84:87]
ds_read_b64_tr_b16 v[150:151], v49 offset:18432
v_mfma_f32_16x16x32_bf16 v[100:103], v[152:155], v[212:215], v[100:103]
s_waitcnt lgkmcnt(6)
v_mfma_f32_16x16x32_bf16 v[72:75], v[156:159], v[204:207], v[72:75]
ds_read_b64_tr_b16 v[152:153], v50 offset:16384
v_mfma_f32_16x16x32_bf16 v[88:91], v[156:159], v[208:211], v[88:91]
ds_read_b64_tr_b16 v[154:155], v50 offset:18432
v_mfma_f32_16x16x32_bf16 v[104:107], v[156:159], v[212:215], v[104:107]
s_waitcnt lgkmcnt(6)
v_mfma_f32_16x16x32_bf16 v[76:79], v[160:163], v[204:207], v[76:79]
ds_read_b64_tr_b16 v[156:157], v51 offset:16384
v_mfma_f32_16x16x32_bf16 v[92:95], v[160:163], v[208:211], v[92:95]
ds_read_b64_tr_b16 v[158:159], v51 offset:18432
v_mfma_f32_16x16x32_bf16 v[108:111], v[160:163], v[212:215], v[108:111]
s_waitcnt vmcnt(3)
s_waitcnt lgkmcnt(6)
v_mfma_f32_16x16x32_bf16 v[64:67], v[144:147], v[216:219], v[64:67]
ds_read_b64_tr_b16 v[160:161], v48 offset:24576
v_mfma_f32_16x16x32_bf16 v[80:83], v[144:147], v[220:223], v[80:83]
ds_read_b64_tr_b16 v[162:163], v48 offset:26624
v_mfma_f32_16x16x32_bf16 v[96:99], v[144:147], v[224:227], v[96:99]
s_waitcnt lgkmcnt(6)
v_mfma_f32_16x16x32_bf16 v[68:71], v[148:151], v[216:219], v[68:71]
ds_read_b64_tr_b16 v[144:145], v49 offset:24576
v_mfma_f32_16x16x32_bf16 v[84:87], v[148:151], v[220:223], v[84:87]
ds_read_b64_tr_b16 v[146:147], v49 offset:26624
v_mfma_f32_16x16x32_bf16 v[100:103], v[148:151], v[224:227], v[100:103]
s_waitcnt lgkmcnt(6)
v_mfma_f32_16x16x32_bf16 v[72:75], v[152:155], v[216:219], v[72:75]
ds_read_b64_tr_b16 v[148:149], v50 offset:24576
v_mfma_f32_16x16x32_bf16 v[88:91], v[152:155], v[220:223], v[88:91]
ds_read_b64_tr_b16 v[150:151], v50 offset:26624
v_mfma_f32_16x16x32_bf16 v[104:107], v[152:155], v[224:227], v[104:107]
s_waitcnt lgkmcnt(6)
v_mfma_f32_16x16x32_bf16 v[76:79], v[156:159], v[216:219], v[76:79]
ds_read_b64_tr_b16 v[152:153], v51 offset:24576
v_mfma_f32_16x16x32_bf16 v[92:95], v[156:159], v[220:223], v[92:95]
ds_read_b64_tr_b16 v[154:155], v51 offset:26624
v_mfma_f32_16x16x32_bf16 v[108:111], v[156:159], v[224:227], v[108:111]
s_waitcnt vmcnt(0)
s_waitcnt lgkmcnt(6)
v_mfma_f32_16x16x32_bf16 v[64:67], v[160:163], v[228:231], v[64:67]
v_mfma_f32_16x16x32_bf16 v[80:83], v[160:163], v[232:235], v[80:83]
v_mfma_f32_16x16x32_bf16 v[96:99], v[160:163], v[236:239], v[96:99]
s_waitcnt lgkmcnt(4)
v_mfma_f32_16x16x32_bf16 v[68:71], v[144:147], v[228:231], v[68:71]
v_mfma_f32_16x16x32_bf16 v[84:87], v[144:147], v[232:235], v[84:87]
v_mfma_f32_16x16x32_bf16 v[100:103], v[144:147], v[236:239], v[100:103]
s_waitcnt lgkmcnt(2)
v_mfma_f32_16x16x32_bf16 v[72:75], v[148:151], v[228:231], v[72:75]
v_mfma_f32_16x16x32_bf16 v[88:91], v[148:151], v[232:235], v[88:91]
v_mfma_f32_16x16x32_bf16 v[104:107], v[148:151], v[236:239], v[104:107]
s_waitcnt lgkmcnt(0)
v_mfma_f32_16x16x32_bf16 v[76:79], v[152:155], v[228:231], v[76:79]
v_mfma_f32_16x16x32_bf16 v[92:95], v[152:155], v[232:235], v[92:95]
v_mfma_f32_16x16x32_bf16 v[108:111], v[152:155], v[236:239], v[108:111]
s_nop 1
ds_write_b128 v56, v[72:75] offset:0
s_nop 2
ds_write_b128 v56, v[76:79] offset:1024
ds_write_b128 v56, v[88:91] offset:2048
ds_write_b128 v56, v[92:95] offset:3072
ds_write_b128 v56, v[104:107] offset:4096
ds_write_b128 v56, v[108:111] offset:5120
v_lshlrev_b32 v124, 16, v112
v_and_b32 v125, 0xffff0000, v112
v_lshlrev_b32 v126, 16, v113
v_and_b32 v127, 0xffff0000, v113
v_lshlrev_b32 v128, 16, v114
v_and_b32 v129, 0xffff0000, v114
v_lshlrev_b32 v130, 16, v115
v_and_b32 v131, 0xffff0000, v115
v_lshlrev_b32 v132, 16, v116
v_and_b32 v133, 0xffff0000, v116
v_lshlrev_b32 v134, 16, v117
v_and_b32 v135, 0xffff0000, v117
v_lshlrev_b32 v136, 16, v118
v_and_b32 v137, 0xffff0000, v118
v_lshlrev_b32 v138, 16, v119
v_and_b32 v139, 0xffff0000, v119
v_lshlrev_b32 v140, 16, v120
v_and_b32 v141, 0xffff0000, v120
v_lshlrev_b32 v142, 16, v121
v_and_b32 v143, 0xffff0000, v121
v_lshlrev_b32 v144, 16, v122
v_and_b32 v145, 0xffff0000, v122
v_lshlrev_b32 v146, 16, v123
v_and_b32 v147, 0xffff0000, v123
v_pk_add_f32 v[64:65], v[64:65], v[124:125]
v_pk_add_f32 v[66:67], v[66:67], v[126:127]
v_pk_add_f32 v[68:69], v[68:69], v[128:129]
v_pk_add_f32 v[70:71], v[70:71], v[130:131]
v_pk_add_f32 v[80:81], v[80:81], v[132:133]
v_pk_add_f32 v[82:83], v[82:83], v[134:135]
v_pk_add_f32 v[84:85], v[84:85], v[136:137]
v_pk_add_f32 v[86:87], v[86:87], v[138:139]
v_pk_add_f32 v[96:97], v[96:97], v[140:141]
v_pk_add_f32 v[98:99], v[98:99], v[142:143]
v_pk_add_f32 v[100:101], v[100:101], v[144:145]
v_pk_add_f32 v[102:103], v[102:103], v[146:147]
s_waitcnt lgkmcnt(0)
s_barrier
ds_read_b128 v[72:75], v57 offset:0
ds_read_b128 v[76:79], v57 offset:1024
ds_read_b128 v[88:91], v57 offset:2048
ds_read_b128 v[92:95], v57 offset:3072
ds_read_b128 v[104:107], v57 offset:4096
ds_read_b128 v[108:111], v57 offset:5120
s_waitcnt lgkmcnt(4)
v_pk_add_f32 v[64:65], v[64:65], v[72:73]
v_pk_add_f32 v[66:67], v[66:67], v[74:75]
v_pk_add_f32 v[68:69], v[68:69], v[76:77]
v_pk_add_f32 v[70:71], v[70:71], v[78:79]
v_cvt_pk_bf16_f32 v164, v64, v65
v_cvt_pk_bf16_f32 v165, v66, v67
v_cvt_pk_bf16_f32 v166, v68, v69
v_cvt_pk_bf16_f32 v167, v70, v71
s_add_u32 s50, s60, 0
v_permlane16_swap_b32 v164, v166
v_permlane16_swap_b32 v165, v167
buffer_store_dwordx4 v[164:167], v46, s[28:31], s50 offen sc1
s_waitcnt lgkmcnt(2)
v_pk_add_f32 v[80:81], v[80:81], v[88:89]
v_pk_add_f32 v[82:83], v[82:83], v[90:91]
v_pk_add_f32 v[84:85], v[84:85], v[92:93]
v_pk_add_f32 v[86:87], v[86:87], v[94:95]
v_cvt_pk_bf16_f32 v168, v80, v81
v_cvt_pk_bf16_f32 v169, v82, v83
v_cvt_pk_bf16_f32 v170, v84, v85
v_cvt_pk_bf16_f32 v171, v86, v87
s_add_u32 s50, s60, 20480
v_permlane16_swap_b32 v168, v170
v_permlane16_swap_b32 v169, v171
buffer_store_dwordx4 v[168:171], v46, s[28:31], s50 offen sc1
s_waitcnt lgkmcnt(0)
v_pk_add_f32 v[96:97], v[96:97], v[104:105]
v_pk_add_f32 v[98:99], v[98:99], v[106:107]
v_pk_add_f32 v[100:101], v[100:101], v[108:109]
v_pk_add_f32 v[102:103], v[102:103], v[110:111]
v_cvt_pk_bf16_f32 v172, v96, v97
v_cvt_pk_bf16_f32 v173, v98, v99
v_cvt_pk_bf16_f32 v174, v100, v101
v_cvt_pk_bf16_f32 v175, v102, v103
s_add_u32 s50, s60, 40960
v_permlane16_swap_b32 v172, v174
v_permlane16_swap_b32 v173, v175
buffer_store_dwordx4 v[172:175], v46, s[28:31], s50 offen sc1
s_nop 1
s_branch L_fin
L_cs:
s_lshl_b32 s50, s41, 1
s_add_u32 s50, s50, s42
s_sub_u32 s50, s50, 30
s_lshl_b32 s50, s50, 2
s_add_u32 s53, s50, s40
s_cmp_ge_u32 s53, 54
s_cbranch_scc1 L_fin
s_cmp_lt_u32 s53, 27
s_cselect_b32 s84, s16, s20
s_cselect_b32 s85, s17, s21
s_mov_b32 s86, 2211840
s_mov_b32 s87, 0x20000
s_cselect_b32 s50, 0, 27
s_sub_u32 s54, s53, s50
s_lshl_b32 s54, s54, 7
v_lshrrev_b32 v60, 3, v1
v_mul_u32_u24 v5, 3456, v60
v_and_b32 v60, 7, v1
v_lshl_add_u32 v5, v60, 4, v5
v_mov_b32 v64, 0
v_mov_b32 v65, 0
v_mov_b32 v66, 0
v_mov_b32 v67, 0
v_mov_b32 v68, 0
v_mov_b32 v69, 0
v_mov_b32 v70, 0
v_mov_b32 v71, 0
buffer_load_dwordx4 v[80:83], v5, s[84:87], s54 offen
s_add_u32 s54, s54, 27648
buffer_load_dwordx4 v[84:87], v5, s[84:87], s54 offen
s_add_u32 s54, s54, 27648
buffer_load_dwordx4 v[88:91], v5, s[84:87], s54 offen
s_add_u32 s54, s54, 27648
buffer_load_dwordx4 v[92:95], v5, s[84:87], s54 offen
s_add_u32 s54, s54, 27648
buffer_load_dwordx4 v[96:99], v5, s[84:87], s54 offen
s_add_u32 s54, s54, 27648
buffer_load_dwordx4 v[100:103], v5, s[84:87], s54 offen
s_add_u32 s54, s54, 27648
buffer_load_dwordx4 v[104:107], v5, s[84:87], s54 offen
s_add_u32 s54, s54, 27648
buffer_load_dwordx4 v[108:111], v5, s[84:87], s54 offen
s_add_u32 s54, s54, 27648
buffer_load_dwordx4 v[112:115], v5, s[84:87], s54 offen
s_add_u32 s54, s54, 27648
buffer_load_dwordx4 v[116:119], v5, s[84:87], s54 offen
s_add_u32 s54, s54, 27648
buffer_load_dwordx4 v[120:123], v5, s[84:87], s54 offen
s_add_u32 s54, s54, 27648
buffer_load_dwordx4 v[124:127], v5, s[84:87], s54 offen
s_add_u32 s54, s54, 27648
buffer_load_dwordx4 v[128:131], v5, s[84:87], s54 offen
s_add_u32 s54, s54, 27648
buffer_load_dwordx4 v[132:135], v5, s[84:87], s54 offen
s_add_u32 s54, s54, 27648
buffer_load_dwordx4 v[136:139], v5, s[84:87], s54 offen
s_add_u32 s54, s54, 27648
buffer_load_dwordx4 v[140:143], v5, s[84:87], s54 offen
s_add_u32 s54, s54, 27648
buffer_load_dwordx4 v[144:147], v5, s[84:87], s54 offen
s_add_u32 s54, s54, 27648
buffer_load_dwordx4 v[148:151], v5, s[84:87], s54 offen
s_add_u32 s54, s54, 27648
buffer_load_dwordx4 v[152:155], v5, s[84:87], s54 offen
s_add_u32 s54, s54, 27648
buffer_load_dwordx4 v[156:159], v5, s[84:87], s54 offen
s_add_u32 s54, s54, 27648
s_mov_b32 s55, 4
L_csl:
s_waitcnt vmcnt(19)
v_lshlrev_b32 v72, 16, v80
v_and_b32 v73, 0xffff0000, v80
v_lshlrev_b32 v74, 16, v81
v_and_b32 v75, 0xffff0000, v81
v_lshlrev_b32 v76, 16, v82
v_and_b32 v77, 0xffff0000, v82
v_lshlrev_b32 v78, 16, v83
v_and_b32 v79, 0xffff0000, v83
buffer_load_dwordx4 v[80:83], v5, s[84:87], s54 offen
s_add_u32 s54, s54, 27648
v_pk_add_f32 v[64:65], v[64:65], v[72:73]
v_pk_add_f32 v[66:67], v[66:67], v[74:75]
v_pk_add_f32 v[68:69], v[68:69], v[76:77]
v_pk_add_f32 v[70:71], v[70:71], v[78:79]
s_waitcnt vmcnt(19)
v_lshlrev_b32 v72, 16, v84
v_and_b32 v73, 0xffff0000, v84
v_lshlrev_b32 v74, 16, v85
v_and_b32 v75, 0xffff0000, v85
v_lshlrev_b32 v76, 16, v86
v_and_b32 v77, 0xffff0000, v86
v_lshlrev_b32 v78, 16, v87
v_and_b32 v79, 0xffff0000, v87
buffer_load_dwordx4 v[84:87], v5, s[84:87], s54 offen
s_add_u32 s54, s54, 27648
v_pk_add_f32 v[64:65], v[64:65], v[72:73]
v_pk_add_f32 v[66:67], v[66:67], v[74:75]
v_pk_add_f32 v[68:69], v[68:69], v[76:77]
v_pk_add_f32 v[70:71], v[70:71], v[78:79]
s_waitcnt vmcnt(19)
v_lshlrev_b32 v72, 16, v88
v_and_b32 v73, 0xffff0000, v88
v_lshlrev_b32 v74, 16, v89
v_and_b32 v75, 0xffff0000, v89
v_lshlrev_b32 v76, 16, v90
v_and_b32 v77, 0xffff0000, v90
v_lshlrev_b32 v78, 16, v91
v_and_b32 v79, 0xffff0000, v91
buffer_load_dwordx4 v[88:91], v5, s[84:87], s54 offen
s_add_u32 s54, s54, 27648
v_pk_add_f32 v[64:65], v[64:65], v[72:73]
v_pk_add_f32 v[66:67], v[66:67], v[74:75]
v_pk_add_f32 v[68:69], v[68:69], v[76:77]
v_pk_add_f32 v[70:71], v[70:71], v[78:79]
s_waitcnt vmcnt(19)
v_lshlrev_b32 v72, 16, v92
v_and_b32 v73, 0xffff0000, v92
v_lshlrev_b32 v74, 16, v93
v_and_b32 v75, 0xffff0000, v93
v_lshlrev_b32 v76, 16, v94
v_and_b32 v77, 0xffff0000, v94
v_lshlrev_b32 v78, 16, v95
v_and_b32 v79, 0xffff0000, v95
buffer_load_dwordx4 v[92:95], v5, s[84:87], s54 offen
s_add_u32 s54, s54, 27648
v_pk_add_f32 v[64:65], v[64:65], v[72:73]
v_pk_add_f32 v[66:67], v[66:67], v[74:75]
v_pk_add_f32 v[68:69], v[68:69], v[76:77]
v_pk_add_f32 v[70:71], v[70:71], v[78:79]
s_waitcnt vmcnt(19)
v_lshlrev_b32 v72, 16, v96
v_and_b32 v73, 0xffff0000, v96
v_lshlrev_b32 v74, 16, v97
v_and_b32 v75, 0xffff0000, v97
v_lshlrev_b32 v76, 16, v98
v_and_b32 v77, 0xffff0000, v98
v_lshlrev_b32 v78, 16, v99
v_and_b32 v79, 0xffff0000, v99
buffer_load_dwordx4 v[96:99], v5, s[84:87], s54 offen
s_add_u32 s54, s54, 27648
v_pk_add_f32 v[64:65], v[64:65], v[72:73]
v_pk_add_f32 v[66:67], v[66:67], v[74:75]
v_pk_add_f32 v[68:69], v[68:69], v[76:77]
v_pk_add_f32 v[70:71], v[70:71], v[78:79]
s_waitcnt vmcnt(19)
v_lshlrev_b32 v72, 16, v100
v_and_b32 v73, 0xffff0000, v100
v_lshlrev_b32 v74, 16, v101
v_and_b32 v75, 0xffff0000, v101
v_lshlrev_b32 v76, 16, v102
v_and_b32 v77, 0xffff0000, v102
v_lshlrev_b32 v78, 16, v103
v_and_b32 v79, 0xffff0000, v103
buffer_load_dwordx4 v[100:103], v5, s[84:87], s54 offen
s_add_u32 s54, s54, 27648
v_pk_add_f32 v[64:65], v[64:65], v[72:73]
v_pk_add_f32 v[66:67], v[66:67], v[74:75]
v_pk_add_f32 v[68:69], v[68:69], v[76:77]
v_pk_add_f32 v[70:71], v[70:71], v[78:79]
s_waitcnt vmcnt(19)
v_lshlrev_b32 v72, 16, v104
v_and_b32 v73, 0xffff0000, v104
v_lshlrev_b32 v74, 16, v105
v_and_b32 v75, 0xffff0000, v105
v_lshlrev_b32 v76, 16, v106
v_and_b32 v77, 0xffff0000, v106
v_lshlrev_b32 v78, 16, v107
v_and_b32 v79, 0xffff0000, v107
buffer_load_dwordx4 v[104:107], v5, s[84:87], s54 offen
s_add_u32 s54, s54, 27648
v_pk_add_f32 v[64:65], v[64:65], v[72:73]
v_pk_add_f32 v[66:67], v[66:67], v[74:75]
v_pk_add_f32 v[68:69], v[68:69], v[76:77]
v_pk_add_f32 v[70:71], v[70:71], v[78:79]
s_waitcnt vmcnt(19)
v_lshlrev_b32 v72, 16, v108
v_and_b32 v73, 0xffff0000, v108
v_lshlrev_b32 v74, 16, v109
v_and_b32 v75, 0xffff0000, v109
v_lshlrev_b32 v76, 16, v110
v_and_b32 v77, 0xffff0000, v110
v_lshlrev_b32 v78, 16, v111
v_and_b32 v79, 0xffff0000, v111
buffer_load_dwordx4 v[108:111], v5, s[84:87], s54 offen
s_add_u32 s54, s54, 27648
v_pk_add_f32 v[64:65], v[64:65], v[72:73]
v_pk_add_f32 v[66:67], v[66:67], v[74:75]
v_pk_add_f32 v[68:69], v[68:69], v[76:77]
v_pk_add_f32 v[70:71], v[70:71], v[78:79]
s_waitcnt vmcnt(19)
v_lshlrev_b32 v72, 16, v112
v_and_b32 v73, 0xffff0000, v112
v_lshlrev_b32 v74, 16, v113
v_and_b32 v75, 0xffff0000, v113
v_lshlrev_b32 v76, 16, v114
v_and_b32 v77, 0xffff0000, v114
v_lshlrev_b32 v78, 16, v115
v_and_b32 v79, 0xffff0000, v115
buffer_load_dwordx4 v[112:115], v5, s[84:87], s54 offen
s_add_u32 s54, s54, 27648
v_pk_add_f32 v[64:65], v[64:65], v[72:73]
v_pk_add_f32 v[66:67], v[66:67], v[74:75]
v_pk_add_f32 v[68:69], v[68:69], v[76:77]
v_pk_add_f32 v[70:71], v[70:71], v[78:79]
s_waitcnt vmcnt(19)
v_lshlrev_b32 v72, 16, v116
v_and_b32 v73, 0xffff0000, v116
v_lshlrev_b32 v74, 16, v117
v_and_b32 v75, 0xffff0000, v117
v_lshlrev_b32 v76, 16, v118
v_and_b32 v77, 0xffff0000, v118
v_lshlrev_b32 v78, 16, v119
v_and_b32 v79, 0xffff0000, v119
buffer_load_dwordx4 v[116:119], v5, s[84:87], s54 offen
s_add_u32 s54, s54, 27648
v_pk_add_f32 v[64:65], v[64:65], v[72:73]
v_pk_add_f32 v[66:67], v[66:67], v[74:75]
v_pk_add_f32 v[68:69], v[68:69], v[76:77]
v_pk_add_f32 v[70:71], v[70:71], v[78:79]
s_waitcnt vmcnt(19)
v_lshlrev_b32 v72, 16, v120
v_and_b32 v73, 0xffff0000, v120
v_lshlrev_b32 v74, 16, v121
v_and_b32 v75, 0xffff0000, v121
v_lshlrev_b32 v76, 16, v122
v_and_b32 v77, 0xffff0000, v122
v_lshlrev_b32 v78, 16, v123
v_and_b32 v79, 0xffff0000, v123
buffer_load_dwordx4 v[120:123], v5, s[84:87], s54 offen
s_add_u32 s54, s54, 27648
v_pk_add_f32 v[64:65], v[64:65], v[72:73]
v_pk_add_f32 v[66:67], v[66:67], v[74:75]
v_pk_add_f32 v[68:69], v[68:69], v[76:77]
v_pk_add_f32 v[70:71], v[70:71], v[78:79]
s_waitcnt vmcnt(19)
v_lshlrev_b32 v72, 16, v124
v_and_b32 v73, 0xffff0000, v124
v_lshlrev_b32 v74, 16, v125
v_and_b32 v75, 0xffff0000, v125
v_lshlrev_b32 v76, 16, v126
v_and_b32 v77, 0xffff0000, v126
v_lshlrev_b32 v78, 16, v127
v_and_b32 v79, 0xffff0000, v127
buffer_load_dwordx4 v[124:127], v5, s[84:87], s54 offen
s_add_u32 s54, s54, 27648
v_pk_add_f32 v[64:65], v[64:65], v[72:73]
v_pk_add_f32 v[66:67], v[66:67], v[74:75]
v_pk_add_f32 v[68:69], v[68:69], v[76:77]
v_pk_add_f32 v[70:71], v[70:71], v[78:79]
s_waitcnt vmcnt(19)
v_lshlrev_b32 v72, 16, v128
v_and_b32 v73, 0xffff0000, v128
v_lshlrev_b32 v74, 16, v129
v_and_b32 v75, 0xffff0000, v129
v_lshlrev_b32 v76, 16, v130
v_and_b32 v77, 0xffff0000, v130
v_lshlrev_b32 v78, 16, v131
v_and_b32 v79, 0xffff0000, v131
buffer_load_dwordx4 v[128:131], v5, s[84:87], s54 offen
s_add_u32 s54, s54, 27648
v_pk_add_f32 v[64:65], v[64:65], v[72:73]
v_pk_add_f32 v[66:67], v[66:67], v[74:75]
v_pk_add_f32 v[68:69], v[68:69], v[76:77]
v_pk_add_f32 v[70:71], v[70:71], v[78:79]
s_waitcnt vmcnt(19)
v_lshlrev_b32 v72, 16, v132
v_and_b32 v73, 0xffff0000, v132
v_lshlrev_b32 v74, 16, v133
v_and_b32 v75, 0xffff0000, v133
v_lshlrev_b32 v76, 16, v134
v_and_b32 v77, 0xffff0000, v134
v_lshlrev_b32 v78, 16, v135
v_and_b32 v79, 0xffff0000, v135
buffer_load_dwordx4 v[132:135], v5, s[84:87], s54 offen
s_add_u32 s54, s54, 27648
v_pk_add_f32 v[64:65], v[64:65], v[72:73]
v_pk_add_f32 v[66:67], v[66:67], v[74:75]
v_pk_add_f32 v[68:69], v[68:69], v[76:77]
v_pk_add_f32 v[70:71], v[70:71], v[78:79]
s_waitcnt vmcnt(19)
v_lshlrev_b32 v72, 16, v136
v_and_b32 v73, 0xffff0000, v136
v_lshlrev_b32 v74, 16, v137
v_and_b32 v75, 0xffff0000, v137
v_lshlrev_b32 v76, 16, v138
v_and_b32 v77, 0xffff0000, v138
v_lshlrev_b32 v78, 16, v139
v_and_b32 v79, 0xffff0000, v139
buffer_load_dwordx4 v[136:139], v5, s[84:87], s54 offen
s_add_u32 s54, s54, 27648
v_pk_add_f32 v[64:65], v[64:65], v[72:73]
v_pk_add_f32 v[66:67], v[66:67], v[74:75]
v_pk_add_f32 v[68:69], v[68:69], v[76:77]
v_pk_add_f32 v[70:71], v[70:71], v[78:79]
s_waitcnt vmcnt(19)
v_lshlrev_b32 v72, 16, v140
v_and_b32 v73, 0xffff0000, v140
v_lshlrev_b32 v74, 16, v141
v_and_b32 v75, 0xffff0000, v141
v_lshlrev_b32 v76, 16, v142
v_and_b32 v77, 0xffff0000, v142
v_lshlrev_b32 v78, 16, v143
v_and_b32 v79, 0xffff0000, v143
buffer_load_dwordx4 v[140:143], v5, s[84:87], s54 offen
s_add_u32 s54, s54, 27648
v_pk_add_f32 v[64:65], v[64:65], v[72:73]
v_pk_add_f32 v[66:67], v[66:67], v[74:75]
v_pk_add_f32 v[68:69], v[68:69], v[76:77]
v_pk_add_f32 v[70:71], v[70:71], v[78:79]
s_waitcnt vmcnt(19)
v_lshlrev_b32 v72, 16, v144
v_and_b32 v73, 0xffff0000, v144
v_lshlrev_b32 v74, 16, v145
v_and_b32 v75, 0xffff0000, v145
v_lshlrev_b32 v76, 16, v146
v_and_b32 v77, 0xffff0000, v146
v_lshlrev_b32 v78, 16, v147
v_and_b32 v79, 0xffff0000, v147
buffer_load_dwordx4 v[144:147], v5, s[84:87], s54 offen
s_add_u32 s54, s54, 27648
v_pk_add_f32 v[64:65], v[64:65], v[72:73]
v_pk_add_f32 v[66:67], v[66:67], v[74:75]
v_pk_add_f32 v[68:69], v[68:69], v[76:77]
v_pk_add_f32 v[70:71], v[70:71], v[78:79]
s_waitcnt vmcnt(19)
v_lshlrev_b32 v72, 16, v148
v_and_b32 v73, 0xffff0000, v148
v_lshlrev_b32 v74, 16, v149
v_and_b32 v75, 0xffff0000, v149
v_lshlrev_b32 v76, 16, v150
v_and_b32 v77, 0xffff0000, v150
v_lshlrev_b32 v78, 16, v151
v_and_b32 v79, 0xffff0000, v151
buffer_load_dwordx4 v[148:151], v5, s[84:87], s54 offen
s_add_u32 s54, s54, 27648
v_pk_add_f32 v[64:65], v[64:65], v[72:73]
v_pk_add_f32 v[66:67], v[66:67], v[74:75]
v_pk_add_f32 v[68:69], v[68:69], v[76:77]
v_pk_add_f32 v[70:71], v[70:71], v[78:79]
s_waitcnt vmcnt(19)
v_lshlrev_b32 v72, 16, v152
v_and_b32 v73, 0xffff0000, v152
v_lshlrev_b32 v74, 16, v153
v_and_b32 v75, 0xffff0000, v153
v_lshlrev_b32 v76, 16, v154
v_and_b32 v77, 0xffff0000, v154
v_lshlrev_b32 v78, 16, v155
v_and_b32 v79, 0xffff0000, v155
buffer_load_dwordx4 v[152:155], v5, s[84:87], s54 offen
s_add_u32 s54, s54, 27648
v_pk_add_f32 v[64:65], v[64:65], v[72:73]
v_pk_add_f32 v[66:67], v[66:67], v[74:75]
v_pk_add_f32 v[68:69], v[68:69], v[76:77]
v_pk_add_f32 v[70:71], v[70:71], v[78:79]
s_waitcnt vmcnt(19)
v_lshlrev_b32 v72, 16, v156
v_and_b32 v73, 0xffff0000, v156
v_lshlrev_b32 v74, 16, v157
v_and_b32 v75, 0xffff0000, v157
v_lshlrev_b32 v76, 16, v158
v_and_b32 v77, 0xffff0000, v158
v_lshlrev_b32 v78, 16, v159
v_and_b32 v79, 0xffff0000, v159
buffer_load_dwordx4 v[156:159], v5, s[84:87], s54 offen
s_add_u32 s54, s54, 27648
v_pk_add_f32 v[64:65], v[64:65], v[72:73]
v_pk_add_f32 v[66:67], v[66:67], v[74:75]
v_pk_add_f32 v[68:69], v[68:69], v[76:77]
v_pk_add_f32 v[70:71], v[70:71], v[78:79]
s_sub_u32 s55, s55, 1
s_cmp_lg_u32 s55, 0
s_cbranch_scc1 L_csl
v_add_f32 v64, v64, v64 row_ror:8 row_mask:0xf bank_mask:0xf
v_add_f32 v65, v65, v65 row_ror:8 row_mask:0xf bank_mask:0xf
v_add_f32 v66, v66, v66 row_ror:8 row_mask:0xf bank_mask:0xf
v_add_f32 v67, v67, v67 row_ror:8 row_mask:0xf bank_mask:0xf
v_add_f32 v68, v68, v68 row_ror:8 row_mask:0xf bank_mask:0xf
v_add_f32 v69, v69, v69 row_ror:8 row_mask:0xf bank_mask:0xf
v_add_f32 v70, v70, v70 row_ror:8 row_mask:0xf bank_mask:0xf
v_add_f32 v71, v71, v71 row_ror:8 row_mask:0xf bank_mask:0xf
v_mov_b32 v72, v64
v_mov_b32 v73, v65
v_mov_b32 v74, v66
v_mov_b32 v75, v67
v_mov_b32 v76, v68
v_mov_b32 v77, v69
v_mov_b32 v78, v70
v_mov_b32 v79, v71
v_permlane16_swap_b32 v64, v72
v_permlane16_swap_b32 v65, v73
v_permlane16_swap_b32 v66, v74
v_permlane16_swap_b32 v67, v75
v_permlane16_swap_b32 v68, v76
v_permlane16_swap_b32 v69, v77
v_permlane16_swap_b32 v70, v78
v_permlane16_swap_b32 v71, v79
v_pk_add_f32 v[64:65], v[64:65], v[72:73]
v_pk_add_f32 v[66:67], v[66:67], v[74:75]
v_pk_add_f32 v[68:69], v[68:69], v[76:77]
v_pk_add_f32 v[70:71], v[70:71], v[78:79]
v_mov_b32 v72, v64
v_mov_b32 v73, v65
v_mov_b32 v74, v66
v_mov_b32 v75, v67
v_mov_b32 v76, v68
v_mov_b32 v77, v69
v_mov_b32 v78, v70
v_mov_b32 v79, v71
v_permlane32_swap_b32 v64, v72
v_permlane32_swap_b32 v65, v73
v_permlane32_swap_b32 v66, v74
v_permlane32_swap_b32 v67, v75
v_permlane32_swap_b32 v68, v76
v_permlane32_swap_b32 v69, v77
v_permlane32_swap_b32 v70, v78
v_permlane32_swap_b32 v71, v79
v_pk_add_f32 v[64:65], v[64:65], v[72:73]
v_pk_add_f32 v[66:67], v[66:67], v[74:75]
v_pk_add_f32 v[68:69], v[68:69], v[76:77]
v_pk_add_f32 v[70:71], v[70:71], v[78:79]
s_lshl_b32 s50, s53, 8
s_add_u32 s50, s50, 32768
v_lshlrev_b32 v60, 5, v1
s_mov_b64 exec, 0xff
buffer_store_dwordx4 v[64:67], v60, s[32:35], s50 offen sc1
buffer_store_dwordx4 v[68:71], v60, s[32:35], s50 offen offset:16 sc1
s_waitcnt vmcnt(0)
s_mov_b32 s50, 10240
v_mov_b32 v60, 0
v_mov_b32 v61, 1
s_mov_b64 exec, 1
buffer_atomic_add v61, v60, s[32:35], s50 offen sc1
s_mov_b64 exec, -1
L_fin:
L_end:
s_endpgm
L_code_end:
.section .rodata,"a"
.p2align 6
.amdhsa_kernel sequential_preLN__linear_attn_block__geglu_ffn__prompt_kernel
  .amdhsa_next_free_vgpr 512
  .amdhsa_next_free_sgpr 102
  .amdhsa_accum_offset 256
  .amdhsa_group_segment_fixed_size 0
  .amdhsa_kernarg_size 80
  .amdhsa_user_sgpr_count 2
  .amdhsa_user_sgpr_kernarg_segment_ptr 1
  .amdhsa_system_sgpr_workgroup_id_x 1
.end_amdhsa_kernel
```
